```python
import torch

def _softmax(x, axis=-1):
    return torch.softmax(x, dim=axis)
def _gelu(x):
    return torch.nn.functional.gelu(x, approximate="tanh")
def _silu(x):
    return torch.nn.functional.silu(x)
def _sigmoid(x):
    return torch.sigmoid(x)
def _layernorm(x, axis=-1, eps=1e-5):
    m = x.mean(dim=axis, keepdim=True)
    v = x.var(dim=axis, keepdim=True, unbiased=False)
    return (x - m) / torch.sqrt(v + eps)
def _scatter_add(tgt, idx, src, axis=0):
    return tgt.clone().index_add_(axis, idx, src)
def _segment_sum(src, seg, n):
    out = torch.zeros((n,) + src.shape[1:], dtype=src.dtype)
    return out.index_add_(0, seg, src)
def _pad(x, pw):
    flat = tuple(v for pair in reversed(pw) for v in pair)
    return torch.nn.functional.pad(x, flat)

kernel_name = 'standalone__hybrid_graph_tf_nagphormer__graph'

def setup_inputs():

    _w = (lambda a: (lambda t: t.to(torch.bfloat16) if t.is_floating_point() else t)(torch.as_tensor(a)))
    N, deg, D = 25000, 16, 128
    E = N * deg
    src = (lambda lo, hi, *s: torch.randint(lo, hi, s))(0, N, E).to(torch.int64)
    dst = (lambda lo, hi, *s: torch.randint(lo, hi, s))(0, N, E).to(torch.int64)
    deg_cnt = torch.bincount(dst, minlength=N).to(float) + 1.0
    sc = 1.0 / D ** 0.5
    return {
        "x": _w((lambda *s: torch.randn(*s, dtype=torch.bfloat16) * 0.1)(N, D)),
        "src": _w(src),
        "dst": _w(dst),
        "deg_inv_sqrt": _w(1.0 / (lambda _x: torch.sqrt(torch.as_tensor(_x)))(deg_cnt)),
        "wq": _w((lambda *s: torch.randn(*s, dtype=torch.bfloat16) * 1.6)(D, D) * sc),
        "wk": _w((lambda *s: torch.randn(*s, dtype=torch.bfloat16) * 1.6)(D, D) * sc),
        "wv": _w((lambda *s: torch.randn(*s, dtype=torch.bfloat16) * 0.1)(D, D) * sc),
        "wo": _w((lambda *s: torch.randn(*s, dtype=torch.bfloat16) * 0.1)(D, D) * sc),
        "w_r": _w((lambda *s: torch.randn(*s, dtype=torch.bfloat16) * 0.1)(D)),
    }

def reference(x, src, dst, deg_inv_sqrt, wq, wk, wv, wo, w_r):
    N, D = x.shape[0], x.shape[1]
    K = 7
    h = x
    toks = [x]
    for _ in range(K):
        msg = h[src] * deg_inv_sqrt[src, None] * deg_inv_sqrt[dst, None]
        h = _segment_sum(msg, dst, N)
        toks.append(h)
    tok = torch.stack(toks, axis=1)
    t = _layernorm(tok, axis=-1)
    q   = torch.einsum('nkd,de->nke', t, wq)
    key = torch.einsum('nkd,de->nke', t, wk)
    v   = torch.einsum('nkd,de->nke', t, wv)
    scale = 1.0 / (D ** 0.5)
    attn = _softmax(torch.einsum('nkd,nld->nkl', q, key) * scale, axis=-1)
    o = torch.einsum('nkl,nld->nkd', attn, v)
    o = tok + torch.einsum('nkd,de->nke', o, wo)
    r = _layernorm(o, axis=-1)
    alpha = _softmax(torch.einsum('nkd,d->nk', r, w_r), axis=-1)
    return torch.einsum('nk,nkd->nd', alpha, o)
```

```asm
; @launch kernel=p1_kernel grid=(454,1,1) block=(512,1,1) lds=40960
; @launch kernel=hop_kernel grid=(256,1,1) block=(1024,1,1) lds=150656
; @launch kernel=att_kernel grid=(256,1,1) block=(256,1,1) lds=143360
.amdgcn_target "amdgcn-amd-amdhsa--gfx950"
.text
.globl p1_kernel
.p2align 8
.type p1_kernel,@function
p1_kernel:
    s_cmp_ge_u32 s2, 454
    s_cbranch_scc1 K1_end
    s_load_dwordx4 s[4:7], s[0:1], 0
    s_load_dwordx4 s[8:11], s[0:1], 16
    s_load_dwordx2 s[14:15], s[0:1], 88
    v_lshlrev_b32 v1, 2, v0
    v_mov_b32 v2, 0
    v_mov_b32 v24, 1
    v_lshrrev_b32 v3, 6, v0
    v_and_b32 v25, 63, v0
    v_readfirstlane_b32 s37, v3
    s_cmp_ge_u32 s2, 446
    s_cbranch_scc1 K1_mm
    s_cmp_ge_u32 s2, 250
    s_cbranch_scc1 K1_win
    v_lshlrev_b32 v3, 4, v0
    s_mul_i32 s38, s2, 6400
    s_waitcnt lgkmcnt(0)
    s_mov_b32 s16, s6
    s_and_b32 s17, s7, 0xffff
    s_mov_b32 s18, 1600000
    s_mov_b32 s19, 0x20000
    s_mov_b32 s20, s8
    s_and_b32 s21, s9, 0xffff
    s_mov_b32 s22, 1600000
    s_mov_b32 s23, 0x20000
    s_mov_b32 s28, s14
    s_and_b32 s29, s15, 0xffff
    s_mov_b32 s30, 268435456
    s_mov_b32 s31, 0x20000
    s_cmp_ge_u32 s37, 7
    s_cbranch_scc1 K1_nl
    v_cmp_gt_u32 vcc, 400, v0
    s_and_saveexec_b64 s[34:35], vcc
    buffer_load_dwordx4 v[4:7], v3, s[16:19], s38 offen
    buffer_load_dwordx4 v[8:11], v3, s[20:23], s38 offen
    s_mov_b64 exec, s[34:35]
K1_nl:
    s_cmp_lg_u32 s2, 64
    s_cbranch_scc1 K1_noy
    s_cmp_ge_u32 s37, 4
    s_cbranch_scc1 K1_noy
    s_mov_b32 s3, 933888
    v_lshlrev_b32 v16, 5, v0
    buffer_store_dword v2, v16, s[28:31], s3 offen
K1_noy:
    s_cmp_ge_u32 s2, 64
    s_cbranch_scc1 K1_noz
    s_cmp_ge_u32 s37, 3
    s_cbranch_scc1 K1_noz
    s_mul_i32 s3, s2, 2176
    s_add_u32 s3, s3, 786432
    v_lshrrev_b32 v16, 3, v0
    v_min_u32 v16, 16, v16
    v_lshlrev_b32 v16, 7, v16
    v_and_b32 v17, 7, v0
    v_lshl_add_u32 v16, v17, 2, v16
    buffer_store_dword v2, v16, s[28:31], s3 offen
K1_noz:
    v_mov_b32 v12, -1
    v_mov_b32 v13, -1
    v_mov_b32 v14, -1
    v_mov_b32 v15, -1
    v_mov_b32 v26, 12544
    v_mov_b32 v27, 25088
    ds_write_b128 v3, v[12:15] offset:1024
    ds_write_b128 v3, v[12:15] offset:9216
    ds_write_b128 v3, v[12:15] offset:17408
    s_cmp_ge_u32 s37, 4
    s_cbranch_scc1 K1_nc
    ds_write_b32 v1, v2
    s_cmp_ge_u32 s37, 1
    s_cbranch_scc1 K1_nc
    ds_write_b128 v3, v[12:15] offset:25600
K1_nc:
    s_waitcnt lgkmcnt(0)
    s_barrier
    s_cmp_ge_u32 s37, 7
    s_cbranch_scc1 K1_ns
    v_cmp_gt_u32 vcc, 400, v0
    s_and_saveexec_b64 s[34:35], vcc
    s_waitcnt vmcnt(0)
    v_lshrrev_b32 v12, 7, v8
    v_and_b32 v16, 127, v8
    v_lshl_or_b32 v4, v16, 16, v4
    v_lshlrev_b32 v16, 2, v12
    ds_add_rtn_u32 v8, v16, v24
    v_lshrrev_b32 v13, 7, v9
    v_and_b32 v16, 127, v9
    v_lshl_or_b32 v5, v16, 16, v5
    v_lshlrev_b32 v16, 2, v13
    ds_add_rtn_u32 v9, v16, v24
    v_lshrrev_b32 v14, 7, v10
    v_and_b32 v16, 127, v10
    v_lshl_or_b32 v6, v16, 16, v6
    v_lshlrev_b32 v16, 2, v14
    ds_add_rtn_u32 v10, v16, v24
    v_lshrrev_b32 v15, 7, v11
    v_and_b32 v16, 127, v11
    v_lshl_or_b32 v7, v16, 16, v7
    v_lshlrev_b32 v16, 2, v15
    ds_add_rtn_u32 v11, v16, v24
    s_waitcnt lgkmcnt(3)
    v_and_b32 v16, 15, v8
    v_lshlrev_b32 v16, 2, v16
    v_lshl_add_u32 v16, v12, 6, v16
    v_lshrrev_b32 v17, 4, v8
    v_mad_u32_u24 v16, v17, v26, v16
    v_cmp_gt_u32 vcc, 32, v8
    s_nop 1
    v_cndmask_b32 v16, v27, v16, vcc
    ds_write_b32 v16, v4 offset:1024
    s_waitcnt lgkmcnt(3)
    v_and_b32 v16, 15, v9
    v_lshlrev_b32 v16, 2, v16
    v_lshl_add_u32 v16, v13, 6, v16
    v_lshrrev_b32 v17, 4, v9
    v_mad_u32_u24 v16, v17, v26, v16
    v_cmp_gt_u32 vcc, 32, v9
    s_nop 1
    v_cndmask_b32 v16, v27, v16, vcc
    ds_write_b32 v16, v5 offset:1024
    s_waitcnt lgkmcnt(3)
    v_and_b32 v16, 15, v10
    v_lshlrev_b32 v16, 2, v16
    v_lshl_add_u32 v16, v14, 6, v16
    v_lshrrev_b32 v17, 4, v10
    v_mad_u32_u24 v16, v17, v26, v16
    v_cmp_gt_u32 vcc, 32, v10
    s_nop 1
    v_cndmask_b32 v16, v27, v16, vcc
    ds_write_b32 v16, v6 offset:1024
    s_waitcnt lgkmcnt(3)
    v_and_b32 v16, 15, v11
    v_lshlrev_b32 v16, 2, v16
    v_lshl_add_u32 v16, v15, 6, v16
    v_lshrrev_b32 v17, 4, v11
    v_mad_u32_u24 v16, v17, v26, v16
    v_cmp_gt_u32 vcc, 32, v11
    s_nop 1
    v_cndmask_b32 v16, v27, v16, vcc
    ds_write_b32 v16, v7 offset:1024
    s_mov_b64 exec, s[34:35]
K1_ns:
    s_waitcnt lgkmcnt(0)
    s_barrier
    s_and_b32 s3, s2, 7
    s_lshl_b32 s3, s3, 5
    s_lshr_b32 s39, s2, 3
    s_add_u32 s3, s3, s39
    s_lshl_b32 s3, s3, 6
    s_add_u32 s39, s3, 1048576
    s_add_u32 s40, s3, 4456448
    v_lshrrev_b32 v16, 2, v0
    v_and_b32 v17, 3, v0
    v_lshlrev_b32 v17, 4, v17
    v_mov_b32 v18, 16512
    v_mad_u32_u24 v17, v16, v18, v17
    v_and_b32 v18, 0xfffffffc, v0
    ds_read_b128 v[4:7], v3 offset:1024
    ds_read_b128 v[8:11], v3 offset:9216
    ds_read_b32 v19, v18
    ds_read_b32 v20, v18 offset:512
    v_add_u32 v21, 2113536, v17
    v_cmp_gt_u32 vcc, 272, v0
    s_mov_b64 s[42:43], vcc
    s_waitcnt lgkmcnt(3)
    buffer_store_dwordx4 v[4:7], v17, s[28:31], s39 offen
    s_waitcnt lgkmcnt(0)
    v_cndmask_b32 v20, 0, v20, s[42:43]
    v_max_u32 v22, v19, v20
    s_mov_b64 exec, s[42:43]
    s_cbranch_execz K1_n2
    buffer_store_dwordx4 v[8:11], v21, s[28:31], s39 offen
K1_n2:
    s_mov_b64 exec, -1
    v_cmp_le_u32 vcc, 16, v22
    s_cbranch_vccz K1_nb
    ds_read_b128 v[4:7], v3 offset:13568
    ds_read_b128 v[8:11], v3 offset:21760
    s_waitcnt lgkmcnt(0)
    v_cmp_le_u32 vcc, 16, v19
    s_mov_b64 exec, vcc
    s_cbranch_execz K1_b1
    buffer_store_dwordx4 v[4:7], v17, s[28:31], s40 offen
K1_b1:
    s_mov_b64 exec, -1
    v_cmp_le_u32 vcc, 16, v20
    s_mov_b64 exec, vcc
    s_cbranch_execz K1_b2
    buffer_store_dwordx4 v[8:11], v21, s[28:31], s40 offen
K1_b2:
    s_mov_b64 exec, -1
K1_nb:
    v_cmp_lt_u32 vcc, 32, v22
    s_cmp_lg_u64 vcc, 0
    s_cselect_b32 s3, 1, 0
    v_mov_b32 v4, s3
    s_lshr_b32 s39, s39, 1
    s_and_b32 s39, s39, 0x1fe0
    s_lshl_b32 s3, s37, 2
    s_add_u32 s39, s39, s3
    s_add_u32 s39, s39, 491520
    s_mov_b64 exec, 1
    buffer_store_dword v4, v2, s[28:31], s39 offen
    s_endpgm
K1_win:
    s_sub_u32 s36, s2, 250
    s_lshl_b32 s38, s36, 7
    s_waitcnt lgkmcnt(0)
    s_mov_b32 s16, s4
    s_and_b32 s17, s5, 0xffff
    s_mov_b32 s18, 6400000
    s_mov_b32 s19, 0x20000
    s_mov_b32 s24, s10
    s_and_b32 s25, s11, 0xffff
    s_mov_b32 s26, 50000
    s_mov_b32 s27, 0x20000
    s_mov_b32 s28, s14
    s_and_b32 s29, s15, 0xffff
    s_mov_b32 s30, 268435456
    s_mov_b32 s31, 0x20000
    v_lshlrev_b32 v3, 4, v25
    s_lshl_b32 s39, s36, 15
    s_lshl_b32 s40, s37, 12
    s_add_u32 s39, s39, s40
    v_add_u32 v5, s38, v0
    v_lshlrev_b32 v6, 1, v5
    s_cmp_ge_u32 s37, 2
    s_cbranch_scc1 K1_w0
    buffer_load_ushort v4, v6, s[24:27], 0 offen
K1_w0:
    buffer_load_dwordx4 v[32:35], v3, s[16:19], s39 offen offset:0 nt
    buffer_load_dwordx4 v[36:39], v3, s[16:19], s39 offen offset:1024 nt
    buffer_load_dwordx4 v[40:43], v3, s[16:19], s39 offen offset:2048 nt
    buffer_load_dwordx4 v[44:47], v3, s[16:19], s39 offen offset:3072 nt
    ds_write_b32 v1, v2 offset:32768
    s_mul_i32 s46, s36, 1338
    s_lshr_b32 s46, s46, 16
    s_mul_i32 s46, s46, 98
    s_lshl_b32 s44, s36, 1
    s_sub_u32 s47, s44, s46
    s_mov_b32 s44, s47
    s_add_u32 s45, s47, 1
    s_cmp_eq_u32 s47, 0
    s_cselect_b32 s44, 85, s44
    s_cmp_eq_u32 s47, 84
    s_cselect_b32 s45, 0, s45
    s_cmp_eq_u32 s47, 6
    s_cselect_b32 s44, 91, s44
    s_cmp_eq_u32 s47, 90
    s_cselect_b32 s45, 6, s45
    s_cmp_eq_u32 s47, 12
    s_cselect_b32 s44, 95, s44
    s_cmp_eq_u32 s47, 94
    s_cselect_b32 s45, 12, s45
    s_add_u32 s44, s44, s46
    s_add_u32 s45, s45, s46
    s_sub_u32 s48, s44, s46
    s_mul_i32 s49, s48, 43
    s_lshr_b32 s49, s49, 8
    s_mul_i32 s49, s49, 6
    s_cmp_ge_u32 s48, 84
    s_cselect_b32 s49, 84, s49
    s_cmp_ge_u32 s48, 91
    s_cselect_b32 s49, 91, s49
    s_sub_u32 s48, s48, s49
    s_cmp_ge_u32 s48, 4
    s_cselect_b32 s51, 1, 2
    s_cselect_b32 s52, 4, 0
    s_cmp_eq_u32 s48, 6
    s_cselect_b32 s51, 0, s51
    s_cselect_b32 s52, 6, s52
    s_sub_u32 s48, s48, s52
    s_sub_u32 s50, s44, s48
    s_lshl_b32 s50, s50, 6
    s_add_u32 s50, s50, s48
    s_sub_u32 s48, s45, s46
    s_mul_i32 s49, s48, 43
    s_lshr_b32 s49, s49, 8
    s_mul_i32 s49, s49, 6
    s_cmp_ge_u32 s48, 84
    s_cselect_b32 s49, 84, s49
    s_cmp_ge_u32 s48, 91
    s_cselect_b32 s49, 91, s49
    s_sub_u32 s48, s48, s49
    s_cmp_ge_u32 s48, 4
    s_cselect_b32 s54, 1, 2
    s_cselect_b32 s55, 4, 0
    s_cmp_eq_u32 s48, 6
    s_cselect_b32 s54, 0, s54
    s_cselect_b32 s55, 6, s55
    s_sub_u32 s48, s48, s55
    s_sub_u32 s53, s45, s48
    s_lshl_b32 s53, s53, 6
    s_add_u32 s53, s53, s48
    s_lshl_b32 s44, s44, 6
    s_lshl_b32 s45, s45, 6
    s_sub_u32 s45, s45, 64
    s_waitcnt lgkmcnt(0)
    s_barrier
    s_cmp_ge_u32 s37, 2
    s_cbranch_scc1 K1_w1
    s_waitcnt vmcnt(4)
    v_lshlrev_b32 v4, 16, v4
    v_mov_b32 v23, 0x2b800000
    v_cmp_eq_f32 vcc, 0, v4
    s_nop 1
    v_cndmask_b32 v4, v4, v23, vcc
    v_mul_f32 v7, v4, v4
    v_rcp_f32 v7, v7
    s_nop 0
    v_rndne_f32 v7, v7
    v_cvt_u32_f32 v7, v7
    v_med3_u32 v7, v7, 1, 63
    v_cmp_gt_u32 vcc, 25000, v5
    s_nop 1
    v_cndmask_b32 v7, 0, v7, vcc
    v_lshlrev_b32 v7, 2, v7
    ds_add_rtn_u32 v8, v7, v24 offset:32768
    s_waitcnt lgkmcnt(0)
K1_w1:
    s_barrier
    s_cmp_ge_u32 s37, 2
    s_cbranch_scc1 K1_w2
    v_lshlrev_b32 v9, 2, v25
    ds_read_b32 v20, v9 offset:32768
    s_waitcnt lgkmcnt(0)
    v_mov_b32 v21, v20
    s_nop 1
    v_add_u32_dpp v21, v21, v21 row_shr:1 row_mask:0xf bank_mask:0xf bound_ctrl:0
    s_nop 1
    v_add_u32_dpp v21, v21, v21 row_shr:2 row_mask:0xf bank_mask:0xf bound_ctrl:0
    s_nop 1
    v_add_u32_dpp v21, v21, v21 row_shr:4 row_mask:0xf bank_mask:0xf bound_ctrl:0
    s_nop 1
    v_add_u32_dpp v21, v21, v21 row_shr:8 row_mask:0xf bank_mask:0xf bound_ctrl:0
    s_nop 1
    v_add_u32_dpp v21, v21, v21 row_bcast:15 row_mask:0xa bank_mask:0xf
    s_nop 1
    v_add_u32_dpp v21, v21, v21 row_bcast:31 row_mask:0xc bank_mask:0xf
    v_sub_u32 v21, v21, v20
    ds_bpermute_b32 v21, v7, v21
    s_waitcnt lgkmcnt(0)
    v_add_u32 v8, v8, v21
    v_lshlrev_b32 v9, 2, v8
    ds_write_b32 v1, v9 offset:33280
    ds_write_b32 v9, v4 offset:33792
    v_lshrrev_b32 v7, 2, v7
    v_sub_u32 v7, v7, v24 clamp
    ds_write_b32 v9, v7 offset:34304
    v_mov_b32 v10, s44
    v_mov_b32 v11, s45
    v_cmp_gt_u32 vcc, 64, v8
    s_nop 1
    v_cndmask_b32 v10, v11, v10, vcc
    v_add_u32 v10, v10, v8
    v_lshlrev_b32 v11, 2, v10
    s_mov_b32 s3, 65536
    buffer_store_short v10, v6, s[28:31], s3 offen
    s_mov_b32 s3, 409600
    buffer_store_short v8, v6, s[28:31], s3 offen
    v_mov_b32 v14, s50
    v_mov_b32 v15, s53
    v_cndmask_b32 v14, v15, v14, vcc
    v_mov_b32 v15, s51
    v_mov_b32 v16, s54
    v_cndmask_b32 v15, v16, v15, vcc
    v_and_b32 v16, 63, v8
    v_lshlrev_b32 v16, v15, v16
    v_add_lshl_u32 v14, v14, v16, 2
    s_mov_b32 s3, 131072
    buffer_store_dword v5, v14, s[28:31], s3 offen
    v_mul_f32 v12, v4, v4
    v_rcp_f32 v13, v4
    s_mov_b32 s3, 262144
    buffer_store_dword v12, v11, s[28:31], s3 offen
    s_mov_b32 s3, 655360
    buffer_store_dword v13, v14, s[28:31], s3 offen
    s_waitcnt lgkmcnt(0)
K1_w2:
    s_barrier
    s_cmp_ge_u32 s37, 2
    s_cbranch_scc1 K1_nt
    ds_read_b32 v6, v1 offset:34304
    s_waitcnt lgkmcnt(0)
    v_mov_b32 v7, v6
    v_max_u32_dpp v6, v6, v6 row_shr:1 row_mask:0xf bank_mask:0xf bound_ctrl:0
    s_nop 0
    v_add_u32_dpp v7, v7, v7 row_shr:1 row_mask:0xf bank_mask:0xf bound_ctrl:0
    v_max_u32_dpp v6, v6, v6 row_shr:2 row_mask:0xf bank_mask:0xf bound_ctrl:0
    s_nop 0
    v_add_u32_dpp v7, v7, v7 row_shr:2 row_mask:0xf bank_mask:0xf bound_ctrl:0
    v_max_u32_dpp v6, v6, v6 row_shr:4 row_mask:0xf bank_mask:0xf bound_ctrl:0
    s_nop 0
    v_add_u32_dpp v7, v7, v7 row_shr:4 row_mask:0xf bank_mask:0xf bound_ctrl:0
    v_max_u32_dpp v6, v6, v6 row_shr:8 row_mask:0xf bank_mask:0xf bound_ctrl:0
    s_nop 0
    v_add_u32_dpp v7, v7, v7 row_shr:8 row_mask:0xf bank_mask:0xf bound_ctrl:0
    v_max_u32_dpp v6, v6, v6 row_bcast:15 row_mask:0xa bank_mask:0xf
    s_nop 0
    v_add_u32_dpp v7, v7, v7 row_bcast:15 row_mask:0xa bank_mask:0xf
    v_max_u32_dpp v6, v6, v6 row_bcast:31 row_mask:0xc bank_mask:0xf
    s_nop 0
    v_add_u32_dpp v7, v7, v7 row_bcast:31 row_mask:0xc bank_mask:0xf
    v_readlane_b32 s40, v6, 63
    v_readlane_b32 s41, v7, 63
    s_mul_i32 s41, s41, 20
    s_lshr_b32 s41, s41, 10
    s_add_u32 s41, s41, 0
    s_max_u32 s41, s41, s40
    s_add_u32 s41, s41, 3
    s_lshr_b32 s41, s41, 2
    s_min_u32 s41, s41, 16
    s_max_u32 s41, s41, 1
    s_add_u32 s3, s45, 64
    s_cmp_eq_u32 s37, 0
    s_cselect_b32 s3, s44, s3
    s_lshr_b32 s3, s3, 4
    s_add_u32 s3, s3, 393216
    v_mov_b32 v6, s41
    s_mov_b64 exec, 1
    buffer_store_dword v6, v2, s[28:31], s3 offen
    s_mov_b64 exec, -1
K1_nt:
    v_lshrrev_b32 v9, 4, v25
    v_lshlrev_b32 v9, 2, v9
    s_lshl_b32 s3, s37, 6
    v_add_u32 v9, s3, v9
    v_and_b32 v12, 15, v25
    v_lshlrev_b32 v13, 4, v12
    v_lshlrev_b32 v12, 11, v12
    ds_read_b32 v16, v9 offset:33280
    ds_read_b32 v17, v9 offset:33296
    ds_read_b32 v18, v9 offset:33312
    ds_read_b32 v19, v9 offset:33328
    v_and_b32 v14, 31, v25
    v_lshlrev_b32 v15, 4, v14
    ds_read_b128 v[28:31], v15 offset:33792
    s_waitcnt lgkmcnt(0)
    v_xor_b32 v16, v16, v13
    v_add_u32 v16, v16, v12
    v_xor_b32 v17, v17, v13
    v_add_u32 v17, v17, v12
    v_xor_b32 v18, v18, v13
    v_add_u32 v18, v18, v12
    v_xor_b32 v19, v19, v13
    v_add_u32 v19, v19, v12
    s_cmp_ge_u32 s37, 2
    s_cbranch_scc1 K1_w3
    s_waitcnt vmcnt(6)
    s_branch K1_w4
K1_w3:
    s_waitcnt vmcnt(0)
K1_w4:
    ds_write_b32 v16, v32 offset:0
    ds_write_b32 v16, v33 offset:512
    ds_write_b32 v16, v34 offset:1024
    ds_write_b32 v16, v35 offset:1536
    ds_write_b32 v17, v36 offset:0
    ds_write_b32 v17, v37 offset:512
    ds_write_b32 v17, v38 offset:1024
    ds_write_b32 v17, v39 offset:1536
    ds_write_b32 v18, v40 offset:0
    ds_write_b32 v18, v41 offset:512
    ds_write_b32 v18, v42 offset:1024
    ds_write_b32 v18, v43 offset:1536
    ds_write_b32 v19, v44 offset:0
    ds_write_b32 v19, v45 offset:512
    ds_write_b32 v19, v46 offset:1024
    ds_write_b32 v19, v47 offset:1536
    v_lshrrev_b32 v20, 5, v25
    s_lshl_b32 s3, s37, 5
    v_xor_b32 v21, s3, v15
    v_lshl_add_u32 v21, v20, 9, v21
    s_lshl_b32 s3, s37, 12
    v_add_u32 v21, s3, v21
    v_xor_b32 v22, 16, v21
    v_mov_b32 v10, s44
    v_mov_b32 v11, s45
    v_cmp_gt_u32 vcc, 16, v14
    s_nop 1
    v_cndmask_b32 v10, v11, v10, vcc
    v_lshl_add_u32 v10, v14, 2, v10
    s_mov_b32 s3, 100352
    v_mul_lo_u32 v20, v20, s3
    v_lshl_add_u32 v10, v10, 2, v20
    s_mul_i32 s42, s37, 802816
    s_add_u32 s42, s42, 11534336
    s_waitcnt lgkmcnt(0)
    s_barrier
    ds_read_b128 v[32:35], v21 offset:0
    ds_read_b128 v[36:39], v21 offset:1024
    ds_read_b128 v[40:43], v22 offset:2048
    ds_read_b128 v[44:47], v22 offset:3072
    s_waitcnt lgkmcnt(3)
    v_lshlrev_b32 v4, 16, v32
    v_and_b32 v5, 0xffff0000, v32
    v_mul_f32 v4, v28, v4
    v_mul_f32 v5, v28, v5
    v_cvt_pk_bf16_f32 v48, v4, v5
    v_lshlrev_b32 v4, 16, v33
    v_and_b32 v5, 0xffff0000, v33
    v_mul_f32 v4, v29, v4
    v_mul_f32 v5, v29, v5
    v_cvt_pk_bf16_f32 v49, v4, v5
    v_lshlrev_b32 v4, 16, v34
    v_and_b32 v5, 0xffff0000, v34
    v_mul_f32 v4, v30, v4
    v_mul_f32 v5, v30, v5
    v_cvt_pk_bf16_f32 v50, v4, v5
    v_lshlrev_b32 v4, 16, v35
    v_and_b32 v5, 0xffff0000, v35
    v_mul_f32 v4, v31, v4
    v_mul_f32 v5, v31, v5
    v_cvt_pk_bf16_f32 v51, v4, v5
    buffer_store_dwordx4 v[48:51], v10, s[28:31], s42 offen sc1
    s_add_u32 s42, s42, 200704
    s_waitcnt lgkmcnt(2)
    v_lshlrev_b32 v4, 16, v36
    v_and_b32 v5, 0xffff0000, v36
    v_mul_f32 v4, v28, v4
    v_mul_f32 v5, v28, v5
    v_cvt_pk_bf16_f32 v52, v4, v5
    v_lshlrev_b32 v4, 16, v37
    v_and_b32 v5, 0xffff0000, v37
    v_mul_f32 v4, v29, v4
    v_mul_f32 v5, v29, v5
    v_cvt_pk_bf16_f32 v53, v4, v5
    v_lshlrev_b32 v4, 16, v38
    v_and_b32 v5, 0xffff0000, v38
    v_mul_f32 v4, v30, v4
    v_mul_f32 v5, v30, v5
    v_cvt_pk_bf16_f32 v54, v4, v5
    v_lshlrev_b32 v4, 16, v39
    v_and_b32 v5, 0xffff0000, v39
    v_mul_f32 v4, v31, v4
    v_mul_f32 v5, v31, v5
    v_cvt_pk_bf16_f32 v55, v4, v5
    buffer_store_dwordx4 v[52:55], v10, s[28:31], s42 offen sc1
    s_add_u32 s42, s42, 200704
    s_waitcnt lgkmcnt(1)
    v_lshlrev_b32 v4, 16, v40
    v_and_b32 v5, 0xffff0000, v40
    v_mul_f32 v4, v28, v4
    v_mul_f32 v5, v28, v5
    v_cvt_pk_bf16_f32 v48, v4, v5
    v_lshlrev_b32 v4, 16, v41
    v_and_b32 v5, 0xffff0000, v41
    v_mul_f32 v4, v29, v4
    v_mul_f32 v5, v29, v5
    v_cvt_pk_bf16_f32 v49, v4, v5
    v_lshlrev_b32 v4, 16, v42
    v_and_b32 v5, 0xffff0000, v42
    v_mul_f32 v4, v30, v4
    v_mul_f32 v5, v30, v5
    v_cvt_pk_bf16_f32 v50, v4, v5
    v_lshlrev_b32 v4, 16, v43
    v_and_b32 v5, 0xffff0000, v43
    v_mul_f32 v4, v31, v4
    v_mul_f32 v5, v31, v5
    v_cvt_pk_bf16_f32 v51, v4, v5
    buffer_store_dwordx4 v[48:51], v10, s[28:31], s42 offen sc1
    s_add_u32 s42, s42, 200704
    s_waitcnt lgkmcnt(0)
    v_lshlrev_b32 v4, 16, v44
    v_and_b32 v5, 0xffff0000, v44
    v_mul_f32 v4, v28, v4
    v_mul_f32 v5, v28, v5
    v_cvt_pk_bf16_f32 v52, v4, v5
    v_lshlrev_b32 v4, 16, v45
    v_and_b32 v5, 0xffff0000, v45
    v_mul_f32 v4, v29, v4
    v_mul_f32 v5, v29, v5
    v_cvt_pk_bf16_f32 v53, v4, v5
    v_lshlrev_b32 v4, 16, v46
    v_and_b32 v5, 0xffff0000, v46
    v_mul_f32 v4, v30, v4
    v_mul_f32 v5, v30, v5
    v_cvt_pk_bf16_f32 v54, v4, v5
    v_lshlrev_b32 v4, 16, v47
    v_and_b32 v5, 0xffff0000, v47
    v_mul_f32 v4, v31, v4
    v_mul_f32 v5, v31, v5
    v_cvt_pk_bf16_f32 v55, v4, v5
    buffer_store_dwordx4 v[52:55], v10, s[28:31], s42 offen sc1
    s_endpgm
K1_mm:
    s_sub_u32 s36, s2, 446
    s_lshr_b32 s34, s36, 2
    s_and_b32 s35, s36, 3
    s_load_dwordx8 s[40:47], s[0:1], 32
    s_load_dwordx2 s[48:49], s[0:1], 64
    v_lshlrev_b32 v9, 4, v25
    v_lshlrev_b32 v10, 1, v0
    v_lshrrev_b32 v5, 4, v25
    v_and_b32 v6, 15, v25
    v_xor_b32 v6, v6, v5
    v_lshlrev_b32 v6, 4, v6
    v_lshl_add_u32 v6, v5, 8, v6
    v_lshlrev_b32 v8, 4, v25
    v_and_b32 v3, 31, v25
    v_lshrrev_b32 v4, 5, v25
    s_waitcnt lgkmcnt(0)
    s_cmp_eq_u32 s34, 0
    s_cselect_b32 s52, s40, s44
    s_cselect_b32 s53, s41, s45
    s_cselect_b32 s54, s42, s46
    s_cselect_b32 s55, s43, s47
    s_cselect_b64 s[56:57], -1, 0
    s_mov_b32 s20, s52
    s_and_b32 s21, s53, 0xffff
    s_mov_b32 s22, 32768
    s_mov_b32 s23, 0x20000
    s_mov_b32 s24, s54
    s_and_b32 s25, s55, 0xffff
    s_mov_b32 s26, 32768
    s_mov_b32 s27, 0x20000
    s_mov_b32 s28, s14
    s_and_b32 s29, s15, 0xffff
    s_mov_b32 s30, 268435456
    s_mov_b32 s31, 0x20000
    s_mov_b32 s16, s48
    s_and_b32 s17, s49, 0xffff
    s_mov_b32 s18, 256
    s_mov_b32 s19, 0x20000
    buffer_load_ushort v10, v10, s[16:19], 0 offen
    s_and_b32 s39, s37, 3
    s_lshl_b32 s39, s39, 6
    v_xor_b32 v7, s39, v6
    s_lshl_b32 s39, s37, 10
    s_mov_b32 m0, s39
    s_lshl_b32 s38, s35, 13
    s_add_u32 s38, s38, s39
    buffer_load_dwordx4 v7, s[20:23], s38 offen lds
    s_lshl_b32 s38, s37, 12
    s_add_u32 m0, s38, 8192
    v_xor_b32 v7, 0, v6
    v_cndmask_b32 v7, v8, v7, s[56:57]
    buffer_load_dwordx4 v7, s[24:27], s38 offen offset:0 lds
    v_xor_b32 v7, 64, v6
    v_cndmask_b32 v7, v8, v7, s[56:57]
    buffer_load_dwordx4 v7, s[24:27], s38 offen offset:1024 lds
    v_xor_b32 v7, 128, v6
    v_cndmask_b32 v7, v8, v7, s[56:57]
    buffer_load_dwordx4 v7, s[24:27], s38 offen offset:2048 lds
    v_xor_b32 v7, 192, v6
    v_cndmask_b32 v7, v8, v7, s[56:57]
    buffer_load_dwordx4 v7, s[24:27], s38 offen offset:3072 lds
    s_and_b32 s39, s37, 3
    s_lshr_b32 s40, s37, 2
    s_lshl_b32 s41, s40, 7
    v_and_b32 v5, 15, v3
    v_xor_b32 v5, v5, v4
    v_lshlrev_b32 v5, 4, v5
    v_lshl_add_u32 v5, v3, 8, v5
    v_xor_b32 v5, s41, v5
    s_lshl_b32 s42, s39, 13
    s_add_u32 s42, s42, 8192
    v_add_u32 v7, s42, v5
    s_waitcnt vmcnt(0)
    s_barrier
    v_xor_b32 v8, 0, v5
    ds_read_b128 v[16:19], v8
    v_xor_b32 v8, 32, v5
    ds_read_b128 v[20:23], v8
    v_xor_b32 v8, 64, v5
    ds_read_b128 v[24:27], v8
    v_xor_b32 v8, 96, v5
    ds_read_b128 v[28:31], v8
    s_cmp_eq_u32 s34, 0
    s_cbranch_scc0 K1_mb
    v_xor_b32 v8, 0, v7
    ds_read_b128 v[32:35], v8
    v_xor_b32 v8, 32, v7
    ds_read_b128 v[36:39], v8
    v_xor_b32 v8, 64, v7
    ds_read_b128 v[40:43], v8
    v_xor_b32 v8, 96, v7
    ds_read_b128 v[44:47], v8
    s_branch K1_mc
K1_mb:
    v_lshlrev_b32 v6, 11, v4
    v_lshl_add_u32 v6, v3, 1, v6
    s_lshl_b32 s42, s39, 6
    s_lshl_b32 s43, s40, 14
    s_add_u32 s42, s42, s43
    s_add_u32 s42, s42, 8192
    v_add_u32 v6, s42, v6
    ds_read_u16 v32, v6 offset:0
    ds_read_u16 v48, v6 offset:256
    ds_read_u16 v33, v6 offset:512
    ds_read_u16 v49, v6 offset:768
    ds_read_u16 v34, v6 offset:1024
    ds_read_u16 v50, v6 offset:1280
    ds_read_u16 v35, v6 offset:1536
    ds_read_u16 v51, v6 offset:1792
    ds_read_u16 v36, v6 offset:4096
    ds_read_u16 v52, v6 offset:4352
    ds_read_u16 v37, v6 offset:4608
    ds_read_u16 v53, v6 offset:4864
    ds_read_u16 v38, v6 offset:5120
    ds_read_u16 v54, v6 offset:5376
    ds_read_u16 v39, v6 offset:5632
    ds_read_u16 v55, v6 offset:5888
    ds_read_u16 v40, v6 offset:8192
    ds_read_u16 v56, v6 offset:8448
    ds_read_u16 v41, v6 offset:8704
    ds_read_u16 v57, v6 offset:8960
    ds_read_u16 v42, v6 offset:9216
    ds_read_u16 v58, v6 offset:9472
    ds_read_u16 v43, v6 offset:9728
    ds_read_u16 v59, v6 offset:9984
    ds_read_u16 v44, v6 offset:12288
    ds_read_u16 v60, v6 offset:12544
    ds_read_u16 v45, v6 offset:12800
    ds_read_u16 v61, v6 offset:13056
    ds_read_u16 v46, v6 offset:13312
    ds_read_u16 v62, v6 offset:13568
    ds_read_u16 v47, v6 offset:13824
    ds_read_u16 v63, v6 offset:14080
    s_waitcnt lgkmcnt(0)
    v_lshl_or_b32 v32, v48, 16, v32
    v_lshl_or_b32 v33, v49, 16, v33
    v_lshl_or_b32 v34, v50, 16, v34
    v_lshl_or_b32 v35, v51, 16, v35
    v_lshl_or_b32 v36, v52, 16, v36
    v_lshl_or_b32 v37, v53, 16, v37
    v_lshl_or_b32 v38, v54, 16, v38
    v_lshl_or_b32 v39, v55, 16, v39
    v_lshl_or_b32 v40, v56, 16, v40
    v_lshl_or_b32 v41, v57, 16, v41
    v_lshl_or_b32 v42, v58, 16, v42
    v_lshl_or_b32 v43, v59, 16, v43
    v_lshl_or_b32 v44, v60, 16, v44
    v_lshl_or_b32 v45, v61, 16, v45
    v_lshl_or_b32 v46, v62, 16, v46
    v_lshl_or_b32 v47, v63, 16, v47
K1_mc:
    s_waitcnt lgkmcnt(0)
    v_mfma_f32_32x32x16_bf16 v[48:63], v[16:19], v[32:35], 0
    v_mfma_f32_32x32x16_bf16 v[48:63], v[20:23], v[36:39], v[48:63]
    v_mfma_f32_32x32x16_bf16 v[48:63], v[24:27], v[40:43], v[48:63]
    v_mfma_f32_32x32x16_bf16 v[48:63], v[28:31], v[44:47], v[48:63]
    s_lshl_b32 s42, s36, 15
    s_lshl_b32 s43, s39, 13
    s_add_u32 s42, s42, s43
    s_lshl_b32 s43, s40, 12
    s_add_u32 s42, s42, s43
    s_add_u32 s42, s42, 63963136
    s_mov_b32 s3, 598272
    v_lshlrev_b32 v10, 16, v10
    s_cmp_lg_u32 s36, 0
    s_cbranch_scc1 K1_nw
    buffer_store_dword v10, v1, s[28:31], s3 offen
K1_nw:
    s_nop 1
    buffer_store_dwordx4 v[48:51], v9, s[28:31], s42 offen offset:0
    buffer_store_dwordx4 v[52:55], v9, s[28:31], s42 offen offset:1024
    buffer_store_dwordx4 v[56:59], v9, s[28:31], s42 offen offset:2048
    buffer_store_dwordx4 v[60:63], v9, s[28:31], s42 offen offset:3072
K1_end:
    s_endpgm
.globl hop_kernel
.p2align 8
.type hop_kernel,@function
hop_kernel:
    s_cmp_ge_u32 s2, 256
    s_cbranch_scc1 K3_end
    s_load_dwordx2 s[4:5], s[0:1], 88
    v_lshrrev_b32 v1, 6, v0
    v_and_b32 v2, 63, v0
    v_readfirstlane_b32 s19, v1
    s_lshr_b32 s16, s2, 3
    s_and_b32 s16, s16, 3
    s_and_b32 s17, s2, 7
    s_lshl_b32 s17, s17, 3
    s_lshr_b32 s18, s2, 5
    s_or_b32 s18, s18, s17
    s_mul_i32 s20, s19, 6
    s_cmp_eq_u32 s19, 15
    s_cselect_b32 s20, 91, s20
    s_cmp_ge_u32 s19, 14
    s_cselect_b32 s21, 7, 6
    s_mov_b32 s33, s19
    s_waitcnt lgkmcnt(0)
    s_mov_b32 s8, s4
    s_and_b32 s9, s5, 0xffff
    s_mov_b32 s10, 268435456
    s_mov_b32 s11, 0x20000
    s_mov_b32 s28, s4
    s_and_b32 s29, s5, 0xffff
    s_mov_b32 s30, 268435456
    s_mov_b32 s31, 0x20000
    s_cmp_lg_u32 s19, 15
    s_cbranch_scc1 K3_nox
    s_getreg_b32 s50, hwreg(HW_REG_XCC_ID)
    s_and_b32 s50, s50, 0xff
    s_add_u32 s50, s50, 1
    s_mul_i32 s51, s18, 2176
    s_add_u32 s51, s51, 786432
    s_lshl_b32 s52, s16, 2
    s_add_u32 s52, s52, s51
    v_mov_b32 v4, s50
    v_mov_b32 v6, 0
    v_mov_b32 v7, 150592
    s_mov_b64 exec, 1
    buffer_store_dword v4, v6, s[8:11], s52 offen offset:2048 sc1
    ds_write_b32 v7, v6
    s_mov_b64 exec, -1
K3_nox:
    s_cmp_ge_u32 s2, 198
    s_cbranch_scc1 K2_idle
    s_cmp_ge_u32 s2, 196
    s_cbranch_scc1 K2_wts
    v_lshlrev_b32 v3, 4, v0
    s_mul_i32 s34, s2, 16512
    s_add_u32 s65, s34, 1048576
    buffer_load_dwordx4 v[20:23], v3, s[28:31], s65 offen
    v_lshlrev_b32 v4, 3, v0
    s_mov_b32 s35, 491520
    buffer_load_dwordx2 v[6:7], v4, s[28:31], s35 offen
    v_lshlrev_b32 v5, 4, v2
    s_lshl_b32 s34, s33, 10
    s_add_u32 s35, s34, 65536
    s_add_u32 s34, s34, 50240
    s_mov_b32 m0, s34
    s_nop 0
    buffer_load_dwordx4 v5, s[28:31], s35 offen lds
    s_add_u32 s34, s34, 16384
    s_add_u32 s35, s35, 16384
    s_mov_b32 m0, s34
    s_nop 0
    buffer_load_dwordx4 v5, s[28:31], s35 offen lds
    s_add_u32 s34, s34, 16384
    s_add_u32 s35, s35, 16384
    s_mov_b32 m0, s34
    s_nop 0
    buffer_load_dwordx4 v5, s[28:31], s35 offen lds
    s_add_u32 s34, s34, 16384
    s_add_u32 s35, s35, 16384
    s_cmp_lg_u32 s33, 0
    s_cbranch_scc1 K2_nd
    s_mov_b32 m0, s34
    s_nop 0
    buffer_load_dwordx4 v5, s[28:31], s35 offen lds
    s_lshl_b32 s35, s2, 8
    s_add_u32 s35, s35, 409600
    s_mov_b32 m0, 2048
    v_lshlrev_b32 v8, 2, v2
    buffer_load_dword v8, s[28:31], s35 offen lds
K2_nd:
    v_lshlrev_b32 v8, 2, v0
    v_mov_b32 v10, 0
    s_cmp_ge_u32 s33, 8
    s_cbranch_scc1 K2_nz
    s_and_b32 s35, s33, 6
    s_cmp_eq_u32 s35, 2
    s_cbranch_scc1 K2_nz
    s_cmp_ge_u32 s33, 2
    s_cselect_b32 s35, -1, 0
    v_mov_b32 v9, s35
    ds_write_b32 v8, v9
    ds_write_b32 v10, v10 offset:2304
K2_nz:
    v_bfe_u32 v9, v0, 2, 5
    v_lshrrev_b32 v11, 7, v0
    v_lshl_add_u32 v9, v9, 3, v11
    v_cmp_gt_u32 vcc, 250, v9
    s_mov_b64 s[38:39], vcc
    v_mov_b32 v12, 1
    v_mov_b32 v13, 0xfc
    s_mov_b32 s64, 0
    s_mov_b32 s66, 18944
    s_mov_b32 s67, 0
    s_mul_i32 s62, s2, 1338
    s_lshr_b32 s62, s62, 16
    s_mul_i32 s62, s62, 98
    s_lshl_b32 s60, s2, 1
    s_sub_u32 s63, s60, s62
    s_mov_b32 s60, s63
    s_add_u32 s61, s63, 1
    s_cmp_eq_u32 s63, 0
    s_cselect_b32 s60, 85, s60
    s_cmp_eq_u32 s63, 84
    s_cselect_b32 s61, 0, s61
    s_cmp_eq_u32 s63, 6
    s_cselect_b32 s60, 91, s60
    s_cmp_eq_u32 s63, 90
    s_cselect_b32 s61, 6, s61
    s_cmp_eq_u32 s63, 12
    s_cselect_b32 s60, 95, s60
    s_cmp_eq_u32 s63, 94
    s_cselect_b32 s61, 12, s61
    s_add_u32 s60, s60, s62
    s_add_u32 s61, s61, s62
    s_cmp_lt_u32 s33, 8
    s_cselect_b32 s60, s60, s61
    s_sub_u32 s61, s60, s62
    s_mul_i32 s63, s61, 43
    s_lshr_b32 s63, s63, 8
    s_cmp_ge_u32 s61, 84
    s_cselect_b32 s63, 14, s63
    s_cmp_ge_u32 s61, 91
    s_cselect_b32 s63, 15, s63
    s_mul_i32 s68, s63, 6
    s_cselect_b32 s68, 91, s68
    s_sub_u32 s69, s61, s68
    s_add_u32 s68, s68, s62
    s_lshl_b32 s68, s68, 2
    s_add_u32 s68, s68, 393216
    s_buffer_load_dwordx8 s[48:55], s[28:31], s68
    s_mul_i32 s62, s62, 10700
    s_lshr_b32 s62, s62, 16
    s_add_u32 s62, s62, s63
    s_mul_i32 s68, s62, 57344
    s_add_u32 s68, s68, 7864320
    s_waitcnt lgkmcnt(0)
    s_mov_b32 s56, 0
    s_and_b32 s57, s48, 0xffff
    s_cmp_gt_u32 s69, 0
    s_cselect_b32 s58, s57, 0
    s_cselect_b32 s57, s49, s57
    s_add_u32 s56, s56, s58
    s_and_b32 s57, s57, 0xffff
    s_cmp_gt_u32 s69, 1
    s_cselect_b32 s58, s57, 0
    s_cselect_b32 s57, s50, s57
    s_add_u32 s56, s56, s58
    s_and_b32 s57, s57, 0xffff
    s_cmp_gt_u32 s69, 2
    s_cselect_b32 s58, s57, 0
    s_cselect_b32 s57, s51, s57
    s_add_u32 s56, s56, s58
    s_and_b32 s57, s57, 0xffff
    s_cmp_gt_u32 s69, 3
    s_cselect_b32 s58, s57, 0
    s_cselect_b32 s57, s52, s57
    s_add_u32 s56, s56, s58
    s_and_b32 s57, s57, 0xffff
    s_cmp_gt_u32 s69, 4
    s_cselect_b32 s58, s57, 0
    s_cselect_b32 s57, s53, s57
    s_add_u32 s56, s56, s58
    s_and_b32 s57, s57, 0xffff
    s_cmp_gt_u32 s69, 5
    s_cselect_b32 s58, s57, 0
    s_cselect_b32 s57, s54, s57
    s_add_u32 s56, s56, s58
    s_and_b32 s57, s57, 0xffff
    s_and_b32 s58, s33, 7
    s_cbranch_scc1 K2_nlu
    s_lshl_b32 s58, s57, 2
    s_min_u32 s58, s58, 32
    s_lshl_b64 s[58:59], -1, s58
    s_not_b32 s58, s58
    v_mov_b32 v9, s58
    s_lshl_b32 s58, s33, 5
    v_lshl_add_u32 v8, v2, 2, s58
    ds_write_b32 v8, v9 offset:512
K2_nlu:
    s_waitcnt vmcnt(0) lgkmcnt(0)
    s_barrier
    v_or_b32 v6, v6, v7
    v_cmp_ne_u32 vcc, 0, v6
    s_and_b64 vcc, vcc, s[38:39]
    s_cbranch_vccz K2_reg
    ds_write_b32 v10, v12 offset:2304
K2_reg:
K2_loop:
    s_mov_b64 exec, s[38:39]
    v_cmp_ne_u32 s[40:41], -1, v20
    v_cmp_ne_u32 s[42:43], -1, v21
    v_cmp_ne_u32 s[44:45], -1, v22
    v_cmp_ne_u32 s[46:47], -1, v23
    s_mov_b64 exec, s[40:41]
    v_lshlrev_b32_sdwa v15, 1, v20 dst_sel:DWORD dst_unused:UNUSED_PAD src0_sel:DWORD src1_sel:WORD_0
    v_lshrrev_b32 v16, 15, v20
    ds_read_u16 v28, v16 offset:2048
    ds_read_u16 v24, v15 offset:50240
    s_mov_b64 exec, s[42:43]
    v_lshlrev_b32_sdwa v15, 1, v21 dst_sel:DWORD dst_unused:UNUSED_PAD src0_sel:DWORD src1_sel:WORD_0
    v_lshrrev_b32 v16, 15, v21
    ds_read_u16 v29, v16 offset:2048
    ds_read_u16 v25, v15 offset:50240
    s_mov_b64 exec, s[44:45]
    v_lshlrev_b32_sdwa v15, 1, v22 dst_sel:DWORD dst_unused:UNUSED_PAD src0_sel:DWORD src1_sel:WORD_0
    v_lshrrev_b32 v16, 15, v22
    ds_read_u16 v30, v16 offset:2048
    ds_read_u16 v26, v15 offset:50240
    s_mov_b64 exec, s[46:47]
    v_lshlrev_b32_sdwa v15, 1, v23 dst_sel:DWORD dst_unused:UNUSED_PAD src0_sel:DWORD src1_sel:WORD_0
    v_lshrrev_b32 v16, 15, v23
    ds_read_u16 v31, v16 offset:2048
    ds_read_u16 v27, v15 offset:50240
    s_waitcnt lgkmcnt(0)
    s_mov_b64 exec, s[40:41]
    v_lshlrev_b32 v28, 2, v28
    ds_add_rtn_u32 v32, v28, v12 offset:0
    v_and_or_b32 v36, v28, v13, s66
    v_lshrrev_b32 v16, 8, v28
    v_lshl_add_u32 v36, v16, 13, v36
    s_mov_b64 exec, s[42:43]
    v_lshlrev_b32 v29, 2, v29
    ds_add_rtn_u32 v33, v29, v12 offset:0
    v_and_or_b32 v37, v29, v13, s66
    v_lshrrev_b32 v16, 8, v29
    v_lshl_add_u32 v37, v16, 13, v37
    s_mov_b64 exec, s[44:45]
    v_lshlrev_b32 v30, 2, v30
    ds_add_rtn_u32 v34, v30, v12 offset:0
    v_and_or_b32 v38, v30, v13, s66
    v_lshrrev_b32 v16, 8, v30
    v_lshl_add_u32 v38, v16, 13, v38
    s_mov_b64 exec, s[46:47]
    v_lshlrev_b32 v31, 2, v31
    ds_add_rtn_u32 v35, v31, v12 offset:0
    v_and_or_b32 v39, v31, v13, s66
    v_lshrrev_b32 v16, 8, v31
    v_lshl_add_u32 v39, v16, 13, v39
    s_waitcnt lgkmcnt(0)
    s_mov_b64 exec, s[40:41]
    v_lshrrev_b32 v16, 1, v32
    v_lshl_add_u32 v15, v16, 8, v36
    v_and_b32 v16, 1, v32
    v_lshl_add_u32 v15, v16, 1, v15
    v_cmp_gt_u32 vcc, 64, v32
    s_and_b64 exec, exec, vcc
    ds_write_b16 v15, v24
    s_mov_b64 exec, s[42:43]
    v_lshrrev_b32 v16, 1, v33
    v_lshl_add_u32 v15, v16, 8, v37
    v_and_b32 v16, 1, v33
    v_lshl_add_u32 v15, v16, 1, v15
    v_cmp_gt_u32 vcc, 64, v33
    s_and_b64 exec, exec, vcc
    ds_write_b16 v15, v25
    s_mov_b64 exec, s[44:45]
    v_lshrrev_b32 v16, 1, v34
    v_lshl_add_u32 v15, v16, 8, v38
    v_and_b32 v16, 1, v34
    v_lshl_add_u32 v15, v16, 1, v15
    v_cmp_gt_u32 vcc, 64, v34
    s_and_b64 exec, exec, vcc
    ds_write_b16 v15, v26
    s_mov_b64 exec, s[46:47]
    v_lshrrev_b32 v16, 1, v35
    v_lshl_add_u32 v15, v16, 8, v39
    v_and_b32 v16, 1, v35
    v_lshl_add_u32 v15, v16, 1, v15
    v_cmp_gt_u32 vcc, 64, v35
    s_and_b64 exec, exec, vcc
    ds_write_b16 v15, v27
    s_mov_b64 exec, -1
    s_cmp_lg_u32 s64, 0
    s_cbranch_scc1 K2_pa
    v_cndmask_b32 v15, 0, v12, s[46:47]
    s_mov_b32 s64, 1
    s_nop 0
    v_mov_b32_dpp v15, v15 quad_perm:[3,3,3,3] row_mask:0xf bank_mask:0xf
    v_cmp_ne_u32 s[38:39], 0, v15
    s_cmp_eq_u64 s[38:39], 0
    s_cbranch_scc1 K2_pa
    s_mov_b64 exec, s[38:39]
    s_add_u32 s65, s65, 3407872
    buffer_load_dwordx4 v[20:23], v3, s[28:31], s65 offen
    s_waitcnt vmcnt(0)
    s_branch K2_loop
K2_pa:
    s_waitcnt lgkmcnt(0)
    s_barrier
    s_mov_b32 s41, s57
    s_mov_b32 s61, s56
    s_lshr_b32 s34, s33, 3
    s_and_b32 s36, s33, 7
    s_lshl_b32 s35, s34, 8
    v_lshl_add_u32 v4, v2, 2, s35
    ds_read_b32 v5, v4
    s_lshl_b32 s37, s34, 13
    s_add_u32 s37, s37, 18944
    s_lshr_b32 s46, s36, 1
    s_lshl_b32 s46, s46, 8
    s_and_b32 s47, s36, 1
    s_lshl_b32 s47, s47, 1
    s_add_u32 s46, s46, s47
    s_add_u32 s46, s46, s37
    v_lshl_add_u32 v16, v2, 2, s46
    ds_read_u16 v20, v16 offset:0
    ds_read_u16 v21, v16 offset:1024
    ds_read_u16 v22, v16 offset:2048
    ds_read_u16 v23, v16 offset:3072
    s_lshl_b32 s42, s41, 2
    s_waitcnt lgkmcnt(4)
    v_cmp_lt_u32 vcc, s42, v5
    s_min_u32 s42, s42, 32
    s_lshl_b64 s[44:45], -1, s42
    s_not_b32 s44, s44
    s_cbranch_vccz K2_ntq
    ds_write_b32 v10, v12 offset:2304
K2_ntq:
    v_min_u32 v15, s42, v5
    v_subrev_u32 v15, s36, v15
    v_add_u32 v15, 7, v15
    v_lshrrev_b32 v15, 3, v15
    s_sub_u32 s43, s42, 3
    s_max_i32 s43, s43, 2
    s_bfm_b32 s45, s43, 0
    s_cmp_eq_u32 s43, 32
    s_cselect_b32 s45, -1, s45
    s_lshl_b32 s46, s36, 2
    v_add_u32 v17, s46, v2
    v_and_b32 v17, 31, v17
    v_mul_u32_u24 v17, s43, v17
    v_lshrrev_b32 v17, 5, v17
    s_lshl_b32 s46, s34, 9
    s_add_u32 s46, s46, 1024
    v_lshrrev_b32 v8, 5, v2
    v_lshlrev_b32 v8, 8, v8
    v_add_u32 v8, s46, v8
    s_lshl_b32 s47, s34, 13
    s_add_u32 s47, s47, 2560
    v_lshl_add_u32 v19, v2, 2, s47
    v_mov_b32 v24, s44
    v_mov_b32 v26, -1
    v_mov_b32 v27, -1
    v_mov_b32 v41, 0x7c
    s_waitcnt lgkmcnt(0)
    v_lshl_or_b32 v20, v21, 16, v20
    v_lshl_or_b32 v21, v23, 16, v22
    v_cmp_lt_u32 vcc, 0, v15
K2_rd:
    s_mov_b64 exec, vcc
    s_cbranch_execz K2_sd
    v_and_b32 v28, v24, v26
    v_lshlrev_b32 v25, 2, v20
    v_and_b32 v31, s45, v28
    v_cmp_ne_u32 s[48:49], 0, v31
    v_cmp_ne_u32 s[52:53], 0, v28
    v_and_or_b32 v25, v25, v41, v8
    v_cndmask_b32 v31, v28, v31, s[48:49]
    v_alignbit_b32 v31, v31, v31, v17
    v_ffbl_b32 v31, v31
    v_add_u32 v37, v31, v17
    s_cmp_ge_u32 s67, 99
    s_cselect_b64 s[56:57], -1, 0
    s_mov_b64 s[50:51], s[56:57]
    s_andn2_b64 s[54:55], exec, s[52:53]
    s_cbranch_scc0 K2_l1
    s_mov_b64 exec, s[54:55]
    v_and_b32 v29, v24, v27
    v_cmp_eq_u32 s[50:51], 0, v29
    v_add_u32 v25, 128, v25
    s_nop 0
    v_cndmask_b32 v29, v29, v24, s[50:51]
    v_ffbh_u32 v29, v29
    v_sub_u32 v37, 31, v29
    s_or_b64 s[50:51], s[50:51], s[56:57]
    s_mov_b64 exec, vcc
K2_l1:
    v_lshlrev_b32 v34, v37, v12
    v_not_b32 v33, v34
    ds_and_rtn_b32 v24, v4, v33 offset:512
    ds_and_rtn_b32 v36, v25, v33
    v_and_b32 v37, 31, v37
    v_lshl_add_u32 v37, v37, 8, v19
    s_waitcnt lgkmcnt(0)
    v_and_b32 v35, v24, v34
    v_and_b32 v38, v36, v34
    v_cndmask_b32 v39, v38, v34, s[50:51]
    v_and_b32 v39, v39, v35
    v_cmp_ne_u32 s[48:49], 0, v39
    s_andn2_b64 exec, exec, s[48:49]
    ds_or_b32 v4, v35 offset:512
    ds_or_b32 v25, v38
    v_cndmask_b32 v26, v26, v36, s[52:53]
    v_cndmask_b32 v27, v36, v27, s[52:53]
    s_mov_b64 exec, s[48:49]
    ds_write_b16 v37, v20
    v_and_b32 v24, v24, v33
    v_alignbit_b32 v20, v21, v20, 16
    v_lshrrev_b32 v21, 16, v21
    v_mov_b64 v[26:27], -1
    v_subrev_u32 v15, 1, v15
    s_mov_b64 exec, vcc
    v_cmp_lt_u32 vcc, 0, v15
    s_add_u32 s67, s67, 1
    s_cmp_lt_u32 s67, 4096
    s_cbranch_scc1 K2_rd
    s_mov_b64 exec, -1
    ds_write_b32 v10, v12 offset:2304
K2_sd:
    s_mov_b64 exec, -1
    v_lshlrev_b32 v44, 4, v2
    s_mul_i32 s53, s18, 100352
    s_lshl_b32 s52, s19, 10
    s_add_u32 s53, s53, s52
    s_add_u32 s53, s53, 11585536
    s_add_u32 s52, s52, 101440
    s_mov_b32 m0, s52
    s_nop 0
    buffer_load_dwordx4 v44, s[8:11], s53 offen lds
    s_add_u32 s52, s52, 16384
    s_add_u32 s53, s53, 16384
    s_mov_b32 m0, s52
    s_nop 0
    buffer_load_dwordx4 v44, s[8:11], s53 offen lds
    s_add_u32 s52, s52, 16384
    s_add_u32 s53, s53, 16384
    s_mov_b32 m0, s52
    s_nop 0
    buffer_load_dwordx4 v44, s[8:11], s53 offen lds
    s_waitcnt lgkmcnt(0)
    s_barrier
    s_cmp_ge_u32 s36, s41
    s_cbranch_scc1 K2_end
    s_lshl_b32 s46, s36, 10
    v_add_u32 v11, s46, v19
    v_and_b32 v18, 31, v2
    v_lshl_add_u32 v18, v18, 2, v8
    ds_read_b32 v16, v4 offset:512
    ds_read_b32 v18, v18
    ds_read2st64_b32 v[20:21], v11 offset0:0 offset1:1
    ds_read2st64_b32 v[22:23], v11 offset0:2 offset1:3
    s_lshl_b32 s47, s36, 9
    s_add_u32 s37, s37, s47
    v_lshl_add_u32 v12, v2, 2, s37
    ds_read2st64_b32 v[24:25], v12 offset0:16 offset1:17
    v_mov_b32 v13, 0xffff
    v_lshlrev_b32 v15, 4, v2
    s_add_u32 s61, s61, s36
    s_lshr_b32 s39, s61, 1
    s_lshl_b32 s39, s39, 10
    s_and_b32 s61, s61, 1
    s_lshl_b32 s61, s61, 3
    s_add_u32 s39, s39, s61
    s_add_u32 s39, s39, s68
    s_lshl_b32 s38, s36, 2
    s_mov_b32 s50, -1
    s_mov_b32 s51, 0
    s_waitcnt lgkmcnt(3)
    v_lshrrev_b32 v16, s38, v16
    v_lshrrev_b32 v18, s38, v18
    v_and_b32 v26, 1, v18
    v_cmp_ne_u32 s[52:53], 0, v26
    v_and_b32 v26, 2, v18
    v_cmp_ne_u32 s[54:55], 0, v26
    v_and_b32 v26, 4, v18
    v_cmp_ne_u32 s[56:57], 0, v26
    v_and_b32 v26, 8, v18
    v_cmp_ne_u32 s[58:59], 0, v26
    s_ff1_i32_b32 s52, s52
    s_and_b32 s52, s52, 31
    s_add_u32 s52, s52, 24960
    s_ff1_i32_b32 s53, s53
    s_and_b32 s53, s53, 31
    s_add_u32 s53, s53, 24960
    s_ff1_i32_b32 s54, s54
    s_and_b32 s54, s54, 31
    s_add_u32 s54, s54, 24960
    s_ff1_i32_b32 s55, s55
    s_and_b32 s55, s55, 31
    s_add_u32 s55, s55, 24960
    s_ff1_i32_b32 s56, s56
    s_and_b32 s56, s56, 31
    s_add_u32 s56, s56, 24960
    s_ff1_i32_b32 s57, s57
    s_and_b32 s57, s57, 31
    s_add_u32 s57, s57, 24960
    s_ff1_i32_b32 s58, s58
    s_and_b32 s58, s58, 31
    s_add_u32 s58, s58, 24960
    s_ff1_i32_b32 s59, s59
    s_and_b32 s59, s59, 31
    s_add_u32 s59, s59, 24960
    s_waitcnt lgkmcnt(0)
    v_mov_b32 v26, s52
    v_mov_b32 v27, s53
    v_cndmask_b32 v26, v27, v26, s[50:51]
    v_and_b32 v27, 1, v16
    v_cmp_ne_u32 vcc, 0, v27
    s_nop 1
    v_cndmask_b32 v20, v20, v26, vcc
    v_mov_b32 v26, s54
    v_mov_b32 v27, s55
    v_cndmask_b32 v26, v27, v26, s[50:51]
    v_and_b32 v27, 2, v16
    v_cmp_ne_u32 vcc, 0, v27
    s_nop 1
    v_cndmask_b32 v21, v21, v26, vcc
    v_mov_b32 v26, s56
    v_mov_b32 v27, s57
    v_cndmask_b32 v26, v27, v26, s[50:51]
    v_and_b32 v27, 4, v16
    v_cmp_ne_u32 vcc, 0, v27
    s_nop 1
    v_cndmask_b32 v22, v22, v26, vcc
    v_mov_b32 v26, s58
    v_mov_b32 v27, s59
    v_cndmask_b32 v26, v27, v26, s[50:51]
    v_and_b32 v27, 8, v16
    v_cmp_ne_u32 vcc, 0, v27
    s_nop 1
    v_cndmask_b32 v23, v23, v26, vcc
    v_and_b32 v20, v13, v20
    v_and_b32 v22, v13, v22
    v_lshl_or_b32 v20, v21, 17, v20
    v_lshl_or_b32 v21, v23, 17, v22
    buffer_store_dwordx2 v[20:21], v15, s[28:31], s39 offen sc1
    s_add_u32 s36, s36, 8
    s_cmp_ge_u32 s36, s41
    s_cbranch_scc1 K2_end
    v_mov_b32 v43, -1
    s_add_u32 s38, s38, 32
    v_subrev_u32 v5, s38, v5
    v_mov_b32 v14, 1635803520
    v_cmp_lt_i32 vcc, 0, v5
    s_nop 1
    v_cndmask_b32 v26, 0, v13, vcc
    v_cmp_lt_i32 vcc, 1, v5
    s_nop 1
    v_cndmask_b32 v26, v26, v43, vcc
    v_bfi_b32 v24, v26, v24, v14
    v_and_b32 v26, 0xffff0000, v24
    v_add_u32 v24, v24, v26
    v_cmp_lt_i32 vcc, 2, v5
    s_nop 1
    v_cndmask_b32 v26, 0, v13, vcc
    v_cmp_lt_i32 vcc, 3, v5
    s_nop 1
    v_cndmask_b32 v26, v26, v43, vcc
    v_bfi_b32 v25, v26, v25, v14
    v_and_b32 v26, 0xffff0000, v25
    v_add_u32 v25, v25, v26
    s_add_u32 s39, s39, 4096
    buffer_store_dwordx2 v[24:25], v15, s[28:31], s39 offen sc1
    s_branch K2_end
K2_end:
    s_mov_b64 exec, -1
    s_waitcnt vmcnt(0) lgkmcnt(0)
    s_barrier
    s_cmp_lg_u32 s19, 0
    s_cbranch_scc1 K2_lo
    v_mov_b32 v10, 0
    ds_read_b32 v4, v10 offset:2304
    s_lshl_b32 s52, s2, 5
    s_add_u32 s52, s52, 933888
    s_mov_b64 exec, 1
    s_waitcnt lgkmcnt(0)
    v_add_u32 v4, 1, v4
    buffer_store_dword v4, v10, s[8:11], s52 offen sc1
    s_mov_b64 exec, -1
K2_lo:
    v_lshlrev_b32 v44, 4, v2
    s_mul_i32 s53, s18, 100352
    s_lshl_b32 s52, s19, 10
    s_add_u32 s53, s53, s52
    s_add_u32 s53, s53, 11534336
    s_add_u32 s52, s52, 50240
    s_mov_b32 m0, s52
    s_nop 0
    buffer_load_dwordx4 v44, s[8:11], s53 offen lds
    s_add_u32 s52, s52, 16384
    s_add_u32 s53, s53, 16384
    s_mov_b32 m0, s52
    s_nop 0
    buffer_load_dwordx4 v44, s[8:11], s53 offen lds
    s_add_u32 s52, s52, 16384
    s_add_u32 s53, s53, 16384
    s_mov_b32 m0, s52
    s_nop 0
    buffer_load_dwordx4 v44, s[8:11], s53 offen lds
    s_add_u32 s52, s52, 16384
    s_add_u32 s53, s53, 16384
    s_cmp_ge_u32 s19, 2
    s_cbranch_scc1 K3_nta
    s_mov_b32 m0, s52
    s_nop 0
    buffer_load_dwordx4 v44, s[8:11], s53 offen lds
K3_nta:
    s_mul_i32 s52, s16, 98
    s_add_u32 s52, s52, s20
    s_lshl_b32 s52, s52, 8
    s_add_u32 s52, s52, 262144
    v_lshlrev_b32 v44, 2, v2
    buffer_load_dword v33, v44, s[8:11], s52 offen offset:0
    buffer_load_dword v34, v44, s[8:11], s52 offen offset:256
    buffer_load_dword v35, v44, s[8:11], s52 offen offset:512
    buffer_load_dword v36, v44, s[8:11], s52 offen offset:768
    buffer_load_dword v37, v44, s[8:11], s52 offen offset:1024
    buffer_load_dword v38, v44, s[8:11], s52 offen offset:1280
    buffer_load_dword v39, v44, s[8:11], s52 offen offset:1536
    v_mul_u32_u24 v44, 24, v2
    v_mov_b32 v45, 364
    v_cmp_eq_u32 vcc, 15, v2
    s_nop 1
    v_cndmask_b32 v44, v44, v45, vcc
    s_mul_i32 s52, s16, 392
    s_add_u32 s52, s52, 393216
    s_mov_b64 exec, 0xffff
    buffer_load_dwordx4 v[120:123], v44, s[8:11], s52 offen
    buffer_load_dwordx3 v[124:126], v44, s[8:11], s52 offen offset:16
    s_mov_b64 exec, -1
    s_branch K3_join
K2_wts:
    s_sub_u32 s34, s2, 196
    s_lshl_b32 s39, s34, 17
    s_lshl_b32 s60, s33, 13
    s_add_u32 s39, s39, s60
    s_add_u32 s39, s39, 63963136
    s_add_u32 s60, s39, 4096
    v_lshlrev_b32 v8, 4, v2
    buffer_load_dwordx4 v[80:83], v8, s[28:31], s39 offen offset:0
    buffer_load_dwordx4 v[96:99], v8, s[28:31], s60 offen offset:0
    buffer_load_dwordx4 v[84:87], v8, s[28:31], s39 offen offset:1024
    buffer_load_dwordx4 v[100:103], v8, s[28:31], s60 offen offset:1024
    buffer_load_dwordx4 v[88:91], v8, s[28:31], s39 offen offset:2048
    buffer_load_dwordx4 v[104:107], v8, s[28:31], s60 offen offset:2048
    buffer_load_dwordx4 v[92:95], v8, s[28:31], s39 offen offset:3072
    buffer_load_dwordx4 v[108:111], v8, s[28:31], s60 offen offset:3072
    s_lshr_b32 s35, s33, 2
    s_and_b32 s36, s33, 3
    v_and_b32 v3, 31, v2
    v_lshrrev_b32 v4, 5, v2
    v_lshlrev_b32 v7, 2, v0
    s_cmp_ge_u32 s33, 8
    s_cbranch_scc1 K2w_nw
    s_mov_b32 s3, 598272
    buffer_load_dword v8, v7, s[28:31], s3 offen
    v_add_u32 v7, 66048, v7
    s_waitcnt vmcnt(0)
    ds_write_b32 v7, v8
K2w_nw:
    s_waitcnt vmcnt(0) lgkmcnt(0)
    s_barrier
    v_add_f32 v80, v80, v96
    v_add_f32 v81, v81, v97
    v_add_f32 v82, v82, v98
    v_add_f32 v83, v83, v99
    v_add_f32 v84, v84, v100
    v_add_f32 v85, v85, v101
    v_add_f32 v86, v86, v102
    v_add_f32 v87, v87, v103
    v_add_f32 v88, v88, v104
    v_add_f32 v89, v89, v105
    v_add_f32 v90, v90, v106
    v_add_f32 v91, v91, v107
    v_add_f32 v92, v92, v108
    v_add_f32 v93, v93, v109
    v_add_f32 v94, v94, v110
    v_add_f32 v95, v95, v111
    s_mul_i32 s39, s35, 16512
    s_lshl_b32 s60, s36, 7
    s_add_u32 s39, s39, s60
    v_mul_u32_u24 v6, 2064, v4
    v_lshl_add_u32 v6, v3, 2, v6
    v_add_u32 v6, s39, v6
    s_add_u32 s60, s60, 66048
    v_lshl_add_u32 v7, v3, 2, s60
    ds_read_b32 v8, v7
    ds_write_b32 v6, v80 offset:0
    ds_write_b32 v6, v81 offset:516
    ds_write_b32 v6, v82 offset:1032
    ds_write_b32 v6, v83 offset:1548
    ds_write_b32 v6, v84 offset:4128
    ds_write_b32 v6, v85 offset:4644
    ds_write_b32 v6, v86 offset:5160
    ds_write_b32 v6, v87 offset:5676
    ds_write_b32 v6, v88 offset:8256
    ds_write_b32 v6, v89 offset:8772
    ds_write_b32 v6, v90 offset:9288
    ds_write_b32 v6, v91 offset:9804
    ds_write_b32 v6, v92 offset:12384
    ds_write_b32 v6, v93 offset:12900
    ds_write_b32 v6, v94 offset:13416
    ds_write_b32 v6, v95 offset:13932
    v_add_f32 v9, v80, v81
    v_add_f32 v9, v9, v82
    v_add_f32 v9, v9, v83
    v_add_f32 v9, v9, v84
    v_add_f32 v9, v9, v85
    v_add_f32 v9, v9, v86
    v_add_f32 v9, v9, v87
    v_add_f32 v9, v9, v88
    v_add_f32 v9, v9, v89
    v_add_f32 v9, v9, v90
    v_add_f32 v9, v9, v91
    v_add_f32 v9, v9, v92
    v_add_f32 v9, v9, v93
    v_add_f32 v9, v9, v94
    v_add_f32 v9, v9, v95
    ds_add_f32 v7, v9 offset:1536
    s_waitcnt lgkmcnt(1)
    v_mul_f32 v48, v8, v80
    v_mul_f32 v49, v8, v81
    v_mul_f32 v50, v8, v82
    v_mul_f32 v51, v8, v83
    v_mul_f32 v52, v8, v84
    v_mul_f32 v53, v8, v85
    v_mul_f32 v54, v8, v86
    v_mul_f32 v55, v8, v87
    v_mul_f32 v56, v8, v88
    v_mul_f32 v57, v8, v89
    v_mul_f32 v58, v8, v90
    v_mul_f32 v59, v8, v91
    v_mul_f32 v60, v8, v92
    v_mul_f32 v61, v8, v93
    v_mul_f32 v62, v8, v94
    v_mul_f32 v63, v8, v95
    v_add_f32_dpp v80, v80, v80 row_ror:8 row_mask:0xf bank_mask:0x3
    v_add_f32_dpp v81, v81, v81 row_ror:8 row_mask:0xf bank_mask:0x3
    v_add_f32_dpp v82, v82, v82 row_ror:8 row_mask:0xf bank_mask:0x3
    v_add_f32_dpp v83, v83, v83 row_ror:8 row_mask:0xf bank_mask:0x3
    v_add_f32_dpp v84, v84, v84 row_ror:8 row_mask:0xf bank_mask:0x3
    v_add_f32_dpp v85, v85, v85 row_ror:8 row_mask:0xf bank_mask:0x3
    v_add_f32_dpp v86, v86, v86 row_ror:8 row_mask:0xf bank_mask:0x3
    v_add_f32_dpp v87, v87, v87 row_ror:8 row_mask:0xf bank_mask:0x3
    v_add_f32_dpp v80, v88, v88 row_ror:8 row_mask:0xf bank_mask:0xc
    v_add_f32_dpp v81, v89, v89 row_ror:8 row_mask:0xf bank_mask:0xc
    v_add_f32_dpp v82, v90, v90 row_ror:8 row_mask:0xf bank_mask:0xc
    v_add_f32_dpp v83, v91, v91 row_ror:8 row_mask:0xf bank_mask:0xc
    v_add_f32_dpp v84, v92, v92 row_ror:8 row_mask:0xf bank_mask:0xc
    v_add_f32_dpp v85, v93, v93 row_ror:8 row_mask:0xf bank_mask:0xc
    v_add_f32_dpp v86, v94, v94 row_ror:8 row_mask:0xf bank_mask:0xc
    v_add_f32_dpp v87, v95, v95 row_ror:8 row_mask:0xf bank_mask:0xc
    v_add_f32_dpp v80, v80, v80 row_half_mirror row_mask:0xf bank_mask:0x5
    v_add_f32_dpp v81, v81, v81 row_half_mirror row_mask:0xf bank_mask:0x5
    v_add_f32_dpp v82, v82, v82 row_half_mirror row_mask:0xf bank_mask:0x5
    v_add_f32_dpp v83, v83, v83 row_half_mirror row_mask:0xf bank_mask:0x5
    v_add_f32_dpp v80, v84, v84 row_half_mirror row_mask:0xf bank_mask:0xa
    v_add_f32_dpp v81, v85, v85 row_half_mirror row_mask:0xf bank_mask:0xa
    v_add_f32_dpp v82, v86, v86 row_half_mirror row_mask:0xf bank_mask:0xa
    v_add_f32_dpp v83, v87, v87 row_half_mirror row_mask:0xf bank_mask:0xa
    v_add_f32_dpp v80, v80, v80 quad_perm:[1,0,3,2] row_mask:0xf bank_mask:0xf
    v_add_f32_dpp v81, v81, v81 quad_perm:[1,0,3,2] row_mask:0xf bank_mask:0xf
    v_add_f32_dpp v82, v82, v82 quad_perm:[1,0,3,2] row_mask:0xf bank_mask:0xf
    v_add_f32_dpp v83, v83, v83 quad_perm:[1,0,3,2] row_mask:0xf bank_mask:0xf
    v_add_f32_dpp v80, v80, v80 quad_perm:[2,3,0,1] row_mask:0xf bank_mask:0xf
    v_add_f32_dpp v81, v81, v81 quad_perm:[2,3,0,1] row_mask:0xf bank_mask:0xf
    v_add_f32_dpp v82, v82, v82 quad_perm:[2,3,0,1] row_mask:0xf bank_mask:0xf
    v_add_f32_dpp v83, v83, v83 quad_perm:[2,3,0,1] row_mask:0xf bank_mask:0xf
    v_permlane16_swap_b32 v80, v81
    s_nop 0
    v_permlane16_swap_b32 v82, v83
    v_add_f32 v80, v80, v81
    v_add_f32 v82, v82, v83
    v_add_f32_dpp v48, v48, v48 row_ror:8 row_mask:0xf bank_mask:0x3
    v_add_f32_dpp v49, v49, v49 row_ror:8 row_mask:0xf bank_mask:0x3
    v_add_f32_dpp v50, v50, v50 row_ror:8 row_mask:0xf bank_mask:0x3
    v_add_f32_dpp v51, v51, v51 row_ror:8 row_mask:0xf bank_mask:0x3
    v_add_f32_dpp v52, v52, v52 row_ror:8 row_mask:0xf bank_mask:0x3
    v_add_f32_dpp v53, v53, v53 row_ror:8 row_mask:0xf bank_mask:0x3
    v_add_f32_dpp v54, v54, v54 row_ror:8 row_mask:0xf bank_mask:0x3
    v_add_f32_dpp v55, v55, v55 row_ror:8 row_mask:0xf bank_mask:0x3
    v_add_f32_dpp v48, v56, v56 row_ror:8 row_mask:0xf bank_mask:0xc
    v_add_f32_dpp v49, v57, v57 row_ror:8 row_mask:0xf bank_mask:0xc
    v_add_f32_dpp v50, v58, v58 row_ror:8 row_mask:0xf bank_mask:0xc
    v_add_f32_dpp v51, v59, v59 row_ror:8 row_mask:0xf bank_mask:0xc
    v_add_f32_dpp v52, v60, v60 row_ror:8 row_mask:0xf bank_mask:0xc
    v_add_f32_dpp v53, v61, v61 row_ror:8 row_mask:0xf bank_mask:0xc
    v_add_f32_dpp v54, v62, v62 row_ror:8 row_mask:0xf bank_mask:0xc
    v_add_f32_dpp v55, v63, v63 row_ror:8 row_mask:0xf bank_mask:0xc
    v_add_f32_dpp v48, v48, v48 row_half_mirror row_mask:0xf bank_mask:0x5
    v_add_f32_dpp v49, v49, v49 row_half_mirror row_mask:0xf bank_mask:0x5
    v_add_f32_dpp v50, v50, v50 row_half_mirror row_mask:0xf bank_mask:0x5
    v_add_f32_dpp v51, v51, v51 row_half_mirror row_mask:0xf bank_mask:0x5
    v_add_f32_dpp v48, v52, v52 row_half_mirror row_mask:0xf bank_mask:0xa
    v_add_f32_dpp v49, v53, v53 row_half_mirror row_mask:0xf bank_mask:0xa
    v_add_f32_dpp v50, v54, v54 row_half_mirror row_mask:0xf bank_mask:0xa
    v_add_f32_dpp v51, v55, v55 row_half_mirror row_mask:0xf bank_mask:0xa
    v_add_f32_dpp v48, v48, v48 quad_perm:[1,0,3,2] row_mask:0xf bank_mask:0xf
    v_add_f32_dpp v49, v49, v49 quad_perm:[1,0,3,2] row_mask:0xf bank_mask:0xf
    v_add_f32_dpp v50, v50, v50 quad_perm:[1,0,3,2] row_mask:0xf bank_mask:0xf
    v_add_f32_dpp v51, v51, v51 quad_perm:[1,0,3,2] row_mask:0xf bank_mask:0xf
    v_add_f32_dpp v48, v48, v48 quad_perm:[2,3,0,1] row_mask:0xf bank_mask:0xf
    v_add_f32_dpp v49, v49, v49 quad_perm:[2,3,0,1] row_mask:0xf bank_mask:0xf
    v_add_f32_dpp v50, v50, v50 quad_perm:[2,3,0,1] row_mask:0xf bank_mask:0xf
    v_add_f32_dpp v51, v51, v51 quad_perm:[2,3,0,1] row_mask:0xf bank_mask:0xf
    v_permlane16_swap_b32 v48, v49
    s_nop 0
    v_permlane16_swap_b32 v50, v51
    v_add_f32 v48, v48, v49
    v_add_f32 v50, v50, v51
    v_bfe_u32 v10, v2, 2, 2
    v_lshlrev_b32 v10, 5, v10
    v_bfe_u32 v11, v2, 4, 1
    v_lshl_add_u32 v10, v11, 2, v10
    v_lshl_add_u32 v10, v4, 4, v10
    s_lshl_b32 s60, s35, 7
    s_add_u32 s60, s60, 66048
    v_add_u32 v10, s60, v10
    s_mov_b32 exec_lo, 0x11111111
    s_mov_b32 exec_hi, 0x11111111
    ds_add_f32 v10, v80 offset:512
    ds_add_f32 v10, v82 offset:520
    ds_add_f32 v10, v48 offset:1024
    ds_add_f32 v10, v50 offset:1032
    s_mov_b64 exec, -1
    s_waitcnt lgkmcnt(0)
    s_barrier
    v_lshlrev_b32 v5, 3, v2
    v_add_u32 v5, 66048, v5
    ds_read_b64 v[8:9], v5
    ds_read_b64 v[10:11], v5 offset:512
    ds_read_b64 v[12:13], v5 offset:1024
    s_waitcnt lgkmcnt(0)
    v_add_f32 v8, v8, v9
    v_add_f32 v10, v10, v11
    v_add_f32 v12, v12, v13
    v_add_f32_dpp v8, v8, v8 row_shr:1 row_mask:0xf bank_mask:0xf bound_ctrl:0
    s_nop 1
    v_add_f32_dpp v8, v8, v8 row_shr:2 row_mask:0xf bank_mask:0xf bound_ctrl:0
    s_nop 1
    v_add_f32_dpp v8, v8, v8 row_shr:4 row_mask:0xf bank_mask:0xf bound_ctrl:0
    s_nop 1
    v_add_f32_dpp v8, v8, v8 row_shr:8 row_mask:0xf bank_mask:0xf bound_ctrl:0
    s_nop 1
    v_add_f32_dpp v8, v8, v8 row_bcast:15 row_mask:0xa bank_mask:0xf
    s_nop 1
    v_add_f32_dpp v8, v8, v8 row_bcast:31 row_mask:0xc bank_mask:0xf
    v_add_f32_dpp v10, v10, v10 row_shr:1 row_mask:0xf bank_mask:0xf bound_ctrl:0
    s_nop 1
    v_add_f32_dpp v10, v10, v10 row_shr:2 row_mask:0xf bank_mask:0xf bound_ctrl:0
    s_nop 1
    v_add_f32_dpp v10, v10, v10 row_shr:4 row_mask:0xf bank_mask:0xf bound_ctrl:0
    s_nop 1
    v_add_f32_dpp v10, v10, v10 row_shr:8 row_mask:0xf bank_mask:0xf bound_ctrl:0
    s_nop 1
    v_add_f32_dpp v10, v10, v10 row_bcast:15 row_mask:0xa bank_mask:0xf
    s_nop 1
    v_add_f32_dpp v10, v10, v10 row_bcast:31 row_mask:0xc bank_mask:0xf
    v_add_f32_dpp v12, v12, v12 row_shr:1 row_mask:0xf bank_mask:0xf bound_ctrl:0
    s_nop 1
    v_add_f32_dpp v12, v12, v12 row_shr:2 row_mask:0xf bank_mask:0xf bound_ctrl:0
    s_nop 1
    v_add_f32_dpp v12, v12, v12 row_shr:4 row_mask:0xf bank_mask:0xf bound_ctrl:0
    s_nop 1
    v_add_f32_dpp v12, v12, v12 row_shr:8 row_mask:0xf bank_mask:0xf bound_ctrl:0
    s_nop 1
    v_add_f32_dpp v12, v12, v12 row_bcast:15 row_mask:0xa bank_mask:0xf
    s_nop 1
    v_add_f32_dpp v12, v12, v12 row_bcast:31 row_mask:0xc bank_mask:0xf
    v_readlane_b32 s60, v8, 63
    v_readlane_b32 s61, v10, 63
    v_readlane_b32 s62, v12, 63
    s_mov_b32 s63, 1006632960
    s_mov_b32 s64, 3154116608
    s_mov_b32 s65, 1040356334
    v_lshlrev_b32 v15, 4, v2
    s_lshl_b32 s66, s33, 11
    s_lshl_b32 s67, s34, 15
    s_add_u32 s66, s66, s67
    s_add_u32 s66, s66, 524288
    s_lshr_b32 s35, s33, 1
    s_and_b32 s36, s33, 1
    v_and_b32 v3, 15, v2
    v_lshrrev_b32 v4, 4, v2
    s_cmp_eq_u32 s34, 0
    s_cbranch_scc0 K2w_fb
    v_and_b32 v5, 1, v3
    v_lshrrev_b32 v6, 2, v3
    v_lshl_or_b32 v5, v6, 1, v5
    v_bfe_u32 v6, v3, 1, 1
    v_lshl_or_b32 v5, v6, 4, v5
    s_lshr_b32 s37, s35, 1
    s_lshl_b32 s37, s37, 5
    s_and_b32 s38, s35, 1
    s_lshl_b32 s38, s38, 3
    s_add_u32 s37, s37, s38
    v_add_u32 v5, s37, v5
    v_lshlrev_b32 v7, 2, v5
    v_add_u32 v7, 66048, v7
    ds_read_b32 v14, v7 offset:512
    s_lshl_b32 s37, s36, 8
    v_lshl_add_u32 v6, v4, 3, s37
    v_mul_u32_u24 v5, 516, v5
    v_add_u32 v5, v5, v6
    v_add_u32 v6, 67584, v6
    ds_read2_b32 v[16:17], v5 offset0:0 offset1:1
    ds_read2_b32 v[24:25], v6 offset0:0 offset1:1
    ds_read2_b32 v[18:19], v5 offset0:16 offset1:17
    ds_read2_b32 v[26:27], v6 offset0:16 offset1:17
    ds_read2_b32 v[20:21], v5 offset0:8 offset1:9
    ds_read2_b32 v[28:29], v6 offset0:8 offset1:9
    ds_read2_b32 v[22:23], v5 offset0:24 offset1:25
    ds_read2_b32 v[30:31], v6 offset0:24 offset1:25
    ds_read2_b32 v[32:33], v5 offset0:32 offset1:33
    ds_read2_b32 v[40:41], v6 offset0:32 offset1:33
    ds_read2_b32 v[34:35], v5 offset0:48 offset1:49
    ds_read2_b32 v[42:43], v6 offset0:48 offset1:49
    ds_read2_b32 v[36:37], v5 offset0:40 offset1:41
    ds_read2_b32 v[44:45], v6 offset0:40 offset1:41
    ds_read2_b32 v[38:39], v5 offset0:56 offset1:57
    ds_read2_b32 v[46:47], v6 offset0:56 offset1:57
    v_mov_b32 v8, s61
    v_mul_f32 v8, s63, v8
    s_waitcnt lgkmcnt(0)
    v_sub_f32 v14, v8, v14
    v_mul_f32 v14, s63, v14
    v_add_f32 v16, v16, v14
    v_fmac_f32 v16, s64, v24
    v_mul_f32 v16, s65, v16
    v_add_f32 v17, v17, v14
    v_fmac_f32 v17, s64, v25
    v_mul_f32 v17, s65, v17
    v_add_f32 v18, v18, v14
    v_fmac_f32 v18, s64, v26
    v_mul_f32 v18, s65, v18
    v_add_f32 v19, v19, v14
    v_fmac_f32 v19, s64, v27
    v_mul_f32 v19, s65, v19
    v_add_f32 v20, v20, v14
    v_fmac_f32 v20, s64, v28
    v_mul_f32 v20, s65, v20
    v_add_f32 v21, v21, v14
    v_fmac_f32 v21, s64, v29
    v_mul_f32 v21, s65, v21
    v_add_f32 v22, v22, v14
    v_fmac_f32 v22, s64, v30
    v_mul_f32 v22, s65, v22
    v_add_f32 v23, v23, v14
    v_fmac_f32 v23, s64, v31
    v_mul_f32 v23, s65, v23
    v_cvt_pk_bf16_f32 v48, v16, v17
    v_cvt_pk_bf16_f32 v49, v18, v19
    v_cvt_pk_bf16_f32 v50, v20, v21
    v_cvt_pk_bf16_f32 v51, v22, v23
    buffer_store_dwordx4 v[48:51], v15, s[28:31], s66 offen offset:0
    v_add_f32 v32, v32, v14
    v_fmac_f32 v32, s64, v40
    v_mul_f32 v32, s65, v32
    v_add_f32 v33, v33, v14
    v_fmac_f32 v33, s64, v41
    v_mul_f32 v33, s65, v33
    v_add_f32 v34, v34, v14
    v_fmac_f32 v34, s64, v42
    v_mul_f32 v34, s65, v34
    v_add_f32 v35, v35, v14
    v_fmac_f32 v35, s64, v43
    v_mul_f32 v35, s65, v35
    v_add_f32 v36, v36, v14
    v_fmac_f32 v36, s64, v44
    v_mul_f32 v36, s65, v36
    v_add_f32 v37, v37, v14
    v_fmac_f32 v37, s64, v45
    v_mul_f32 v37, s65, v37
    v_add_f32 v38, v38, v14
    v_fmac_f32 v38, s64, v46
    v_mul_f32 v38, s65, v38
    v_add_f32 v39, v39, v14
    v_fmac_f32 v39, s64, v47
    v_mul_f32 v39, s65, v39
    v_cvt_pk_bf16_f32 v52, v32, v33
    v_cvt_pk_bf16_f32 v53, v34, v35
    v_cvt_pk_bf16_f32 v54, v36, v37
    v_cvt_pk_bf16_f32 v55, v38, v39
    buffer_store_dwordx4 v[52:55], v15, s[28:31], s66 offen offset:1024
    s_branch K2w_end
K2w_fb:
    s_lshr_b32 s37, s35, 1
    s_lshl_b32 s37, s37, 7
    s_and_b32 s38, s35, 1
    s_lshl_b32 s38, s38, 2
    s_add_u32 s37, s37, s38
    v_lshl_add_u32 v5, v3, 3, s37
    v_add_u32 v7, 67584, v5
    ds_read_b32 v14, v7
    s_mul_i32 s37, s36, 33024
    v_mul_u32_u24 v6, 1032, v4
    v_add3_u32 v5, v5, v6, s37
    ds_read_b32 v16, v5 offset:0
    ds_read_b32 v17, v5 offset:516
    ds_read_b32 v18, v5 offset:8256
    ds_read_b32 v19, v5 offset:8772
    ds_read_b32 v20, v5 offset:4128
    ds_read_b32 v21, v5 offset:4644
    ds_read_b32 v22, v5 offset:12384
    ds_read_b32 v23, v5 offset:12900
    ds_read_b32 v24, v5 offset:16512
    ds_read_b32 v25, v5 offset:17028
    ds_read_b32 v26, v5 offset:24768
    ds_read_b32 v27, v5 offset:25284
    ds_read_b32 v28, v5 offset:20640
    ds_read_b32 v29, v5 offset:21156
    ds_read_b32 v30, v5 offset:28896
    ds_read_b32 v31, v5 offset:29412
    s_waitcnt lgkmcnt(0)
    v_fmac_f32 v16, s64, v14
    v_fmac_f32 v17, s64, v14
    v_fmac_f32 v18, s64, v14
    v_fmac_f32 v19, s64, v14
    v_fmac_f32 v20, s64, v14
    v_fmac_f32 v21, s64, v14
    v_fmac_f32 v22, s64, v14
    v_fmac_f32 v23, s64, v14
    v_cvt_pk_bf16_f32 v48, v16, v17
    v_cvt_pk_bf16_f32 v49, v18, v19
    v_cvt_pk_bf16_f32 v50, v20, v21
    v_cvt_pk_bf16_f32 v51, v22, v23
    buffer_store_dwordx4 v[48:51], v15, s[28:31], s66 offen offset:0
    v_fmac_f32 v24, s64, v14
    v_fmac_f32 v25, s64, v14
    v_fmac_f32 v26, s64, v14
    v_fmac_f32 v27, s64, v14
    v_fmac_f32 v28, s64, v14
    v_fmac_f32 v29, s64, v14
    v_fmac_f32 v30, s64, v14
    v_fmac_f32 v31, s64, v14
    v_cvt_pk_bf16_f32 v52, v24, v25
    v_cvt_pk_bf16_f32 v53, v26, v27
    v_cvt_pk_bf16_f32 v54, v28, v29
    v_cvt_pk_bf16_f32 v55, v30, v31
    buffer_store_dwordx4 v[52:55], v15, s[28:31], s66 offen offset:1024
    s_cmp_ge_u32 s33, 4
    s_cbranch_scc1 K2w_end
    v_and_b32 v5, 3, v2
    v_max_u32 v7, 1, v5
    v_lshlrev_b32 v7, 9, v7
    v_lshl_add_u32 v7, v4, 3, v7
    s_lshl_b32 s37, s33, 7
    s_add_u32 s37, s37, 65536
    v_add_u32 v7, s37, v7
    ds_read2_b32 v[16:17], v7 offset0:0 offset1:1
    ds_read2_b32 v[18:19], v7 offset0:16 offset1:17
    ds_read2_b32 v[20:21], v7 offset0:8 offset1:9
    ds_read2_b32 v[22:23], v7 offset0:24 offset1:25
    v_mov_b32 v8, s61
    v_mov_b32 v9, s62
    v_cmp_eq_u32 s[40:41], 2, v5
    v_cmp_eq_u32 s[42:43], 3, v5
    v_cmp_eq_u32 s[44:45], 0, v5
    v_cndmask_b32 v8, 0, v8, s[40:41]
    v_cndmask_b32 v8, v8, v9, s[42:43]
    s_waitcnt lgkmcnt(0)
    v_fmac_f32 v16, s64, v8
    v_cndmask_b32 v16, v16, 1.0, s[44:45]
    v_fmac_f32 v17, s64, v8
    v_cndmask_b32 v17, v17, 1.0, s[44:45]
    v_fmac_f32 v18, s64, v8
    v_cndmask_b32 v18, v18, 1.0, s[44:45]
    v_fmac_f32 v19, s64, v8
    v_cndmask_b32 v19, v19, 1.0, s[44:45]
    v_fmac_f32 v20, s64, v8
    v_cndmask_b32 v20, v20, 1.0, s[44:45]
    v_fmac_f32 v21, s64, v8
    v_cndmask_b32 v21, v21, 1.0, s[44:45]
    v_fmac_f32 v22, s64, v8
    v_cndmask_b32 v22, v22, 1.0, s[44:45]
    v_fmac_f32 v23, s64, v8
    v_cndmask_b32 v23, v23, 1.0, s[44:45]
    v_cvt_pk_bf16_f32 v48, v16, v17
    v_cvt_pk_bf16_f32 v49, v18, v19
    v_cvt_pk_bf16_f32 v50, v20, v21
    v_cvt_pk_bf16_f32 v51, v22, v23
    s_lshl_b32 s37, s33, 10
    s_add_u32 s37, s37, 589824
    buffer_store_dwordx4 v[48:51], v15, s[28:31], s37 offen
    v_mov_b32 v8, s60
    s_mov_b32 s37, 598016
    s_mov_b64 exec, 1
    buffer_store_dword v8, v15, s[28:31], s37 offen
K2w_end:
    s_mov_b64 exec, -1
    s_waitcnt lgkmcnt(0)
    s_barrier
    s_branch K2_tab
K2_idle:
K2_tab:
    v_lshlrev_b32 v44, 4, v2
    s_mul_i32 s53, s18, 100352
    s_lshl_b32 s52, s19, 10
    s_add_u32 s53, s53, s52
    s_add_u32 s53, s53, 11585536
    s_add_u32 s52, s52, 101440
    s_mov_b32 m0, s52
    s_nop 0
    buffer_load_dwordx4 v44, s[8:11], s53 offen lds
    s_add_u32 s52, s52, 16384
    s_add_u32 s53, s53, 16384
    s_mov_b32 m0, s52
    s_nop 0
    buffer_load_dwordx4 v44, s[8:11], s53 offen lds
    s_add_u32 s52, s52, 16384
    s_add_u32 s53, s53, 16384
    s_mov_b32 m0, s52
    s_nop 0
    buffer_load_dwordx4 v44, s[8:11], s53 offen lds
    s_mul_i32 s53, s18, 100352
    s_lshl_b32 s52, s19, 10
    s_add_u32 s53, s53, s52
    s_add_u32 s53, s53, 11534336
    s_add_u32 s52, s52, 50240
    s_mov_b32 m0, s52
    s_nop 0
    buffer_load_dwordx4 v44, s[8:11], s53 offen lds
    s_add_u32 s52, s52, 16384
    s_add_u32 s53, s53, 16384
    s_mov_b32 m0, s52
    s_nop 0
    buffer_load_dwordx4 v44, s[8:11], s53 offen lds
    s_add_u32 s52, s52, 16384
    s_add_u32 s53, s53, 16384
    s_mov_b32 m0, s52
    s_nop 0
    buffer_load_dwordx4 v44, s[8:11], s53 offen lds
    s_add_u32 s52, s52, 16384
    s_add_u32 s53, s53, 16384
    s_cmp_ge_u32 s19, 2
    s_cbranch_scc1 K3_ntb
    s_mov_b32 m0, s52
    s_nop 0
    buffer_load_dwordx4 v44, s[8:11], s53 offen lds
K3_ntb:
    s_mul_i32 s52, s16, 98
    s_add_u32 s52, s52, s20
    s_lshl_b32 s52, s52, 8
    s_add_u32 s52, s52, 262144
    v_lshlrev_b32 v44, 2, v2
    buffer_load_dword v33, v44, s[8:11], s52 offen offset:0
    buffer_load_dword v34, v44, s[8:11], s52 offen offset:256
    buffer_load_dword v35, v44, s[8:11], s52 offen offset:512
    buffer_load_dword v36, v44, s[8:11], s52 offen offset:768
    buffer_load_dword v37, v44, s[8:11], s52 offen offset:1024
    buffer_load_dword v38, v44, s[8:11], s52 offen offset:1280
    buffer_load_dword v39, v44, s[8:11], s52 offen offset:1536
    v_mul_u32_u24 v44, 24, v2
    v_mov_b32 v45, 364
    v_cmp_eq_u32 vcc, 15, v2
    s_nop 1
    v_cndmask_b32 v44, v44, v45, vcc
    s_mul_i32 s52, s16, 392
    s_add_u32 s52, s52, 393216
    s_mov_b64 exec, 0xffff
    buffer_load_dwordx4 v[120:123], v44, s[8:11], s52 offen
    buffer_load_dwordx3 v[124:126], v44, s[8:11], s52 offen offset:16
    s_mov_b64 exec, -1
    s_cmp_lt_u32 s2, 200
    s_cbranch_scc1 K3_join
    s_cmp_ge_u32 s19, 14
    s_cbranch_scc1 K3_join
    s_lshr_b32 s52, s2, 3
    s_sub_u32 s52, s52, 25
    s_mul_i32 s52, s52, 114688
    s_and_b32 s53, s2, 7
    s_mul_i32 s53, s53, 802816
    s_add_u32 s52, s52, s53
    s_add_u32 s52, s52, 17956864
    v_lshlrev_b32 v118, 7, v0
    buffer_load_dword v119, v118, s[8:11], s52 offen
K3_join:
    s_getreg_b32 s50, hwreg(HW_REG_XCC_ID)
    s_and_b32 s50, s50, 0xff
    s_add_u32 s50, s50, 1
    s_mul_i32 s51, s18, 2176
    s_add_u32 s51, s51, 786432
    s_mul_i32 s48, s16, 98
    s_add_u32 s48, s48, s20
    s_lshl_b32 s49, s48, 2
    s_add_u32 s49, s49, 393216
    s_buffer_load_dwordx8 s[40:47], s[8:11], s49
    v_mov_b32 v5, v2
    v_lshlrev_b32 v0, 2, v5
    v_lshlrev_b32 v8, 4, v5
    s_mul_i32 s39, s18, 100352
    s_add_u32 s39, s39, 11534336
    s_lshl_b32 s69, s16, 4
    s_add_u32 s69, s69, s19
    s_mul_i32 s69, s69, 57344
    s_add_u32 s69, s69, 7864320
    s_waitcnt lgkmcnt(0)
    s_cmp_eq_u32 s21, 7
    s_cselect_b32 s46, s46, 0
    s_add_u32 s41, s41, s40
    s_add_u32 s42, s42, s41
    s_add_u32 s43, s43, s42
    s_add_u32 s44, s44, s43
    s_add_u32 s45, s45, s44
    s_add_u32 s46, s46, s45
    s_min_u32 s47, s46, 44
    s_sub_u32 s28, s47, 3
    s_mov_b64 s[32:33], 0
    s_sub_u32 s40, s40, 1
    s_bitset1_b64 s[32:33], s40
    s_sub_u32 s41, s41, 1
    s_bitset1_b64 s[32:33], s41
    s_sub_u32 s42, s42, 1
    s_bitset1_b64 s[32:33], s42
    s_sub_u32 s43, s43, 1
    s_bitset1_b64 s[32:33], s43
    s_sub_u32 s44, s44, 1
    s_bitset1_b64 s[32:33], s44
    s_sub_u32 s45, s45, 1
    s_bitset1_b64 s[32:33], s45
    s_sub_u32 s46, s46, 1
    s_bitset1_b64 s[32:33], s46
    s_add_u32 s52, s28, 1
    s_lshr_b64 s[34:35], s[32:33], s52
    s_mov_b64 s[24:25], s[32:33]
    s_bitset1_b64 s[24:25], s28
    s_mov_b32 s64, 0
    s_mul_i32 s52, s16, 1568
    s_add_u32 s52, s52, 933888
    s_waitcnt vmcnt(0)
    v_add3_u32 v12, v120, v121, v122
    v_add3_u32 v12, v12, v123, v124
    v_add_u32 v12, v12, v125
    s_mov_b64 exec, 0xc000
    v_add_u32 v12, v12, v126
    s_mov_b64 exec, -1
    s_cmp_lg_u32 s19, 0
    s_cbranch_scc1 K3_nw
    v_lshlrev_b32 v6, 3, v0
    s_mov_b32 exec_hi, 0x1ffff
K3_wpb:
    buffer_load_dword v4, v6, s[8:11], s52 offen sc1
    s_waitcnt vmcnt(0)
    v_cmp_eq_u32 vcc, 0, v4
    s_cbranch_vccz K3_wdb
    s_add_u32 s64, s64, 1
    s_cmp_gt_u32 s64, 16777216
    s_cbranch_scc1 K3_wdb
    s_sleep 2
    s_branch K3_wpb
K3_wdb:
    v_cmp_ne_u32 vcc, 1, v4
    s_cmp_lg_u64 vcc, 0
    s_cselect_b32 s52, 1, 0
    v_mov_b32 v4, s52
    v_mov_b32 v6, 150592
    ds_write_b32 v6, v4 offset:4
    s_mov_b64 exec, -1
K3_nw:
    s_waitcnt lgkmcnt(0)
    s_barrier
    buffer_load_dwordx4 v[40:43], v8, s[8:11], s69 offen offset:0
    buffer_load_dwordx4 v[44:47], v8, s[8:11], s69 offen offset:1024
    buffer_load_dwordx4 v[48:51], v8, s[8:11], s69 offen offset:2048
    buffer_load_dwordx4 v[52:55], v8, s[8:11], s69 offen offset:3072
    s_lshl_b32 m0, s48, 8
    v_mov_b32 v6, 150592
    ds_read_b32 v19, v6 offset:4
    ds_read_addtid_b32 v26 offset:50240
    ds_read_addtid_b32 v27 offset:50496
    ds_read_addtid_b32 v28 offset:50752
    ds_read_addtid_b32 v29 offset:51008
    ds_read_addtid_b32 v30 offset:51264
    ds_read_addtid_b32 v31 offset:51520
    ds_read_addtid_b32 v32 offset:51776
    buffer_load_dword v24, v0, s[8:11], s51 offen offset:2048 sc1
    v_lshlrev_b32 v25, 2, v0
    s_cmp_gt_u32 s47, 8
    s_cselect_b64 exec, -1, 1
    s_add_u32 s69, s69, 4096
    buffer_load_dwordx4 v[56:59], v25, s[8:11], s69 offen offset:0
    s_cmp_gt_u32 s47, 10
    s_cselect_b64 exec, -1, 1
    buffer_load_dwordx4 v[60:63], v25, s[8:11], s69 offen offset:1024
    s_cmp_gt_u32 s47, 12
    s_cselect_b64 exec, -1, 1
    buffer_load_dwordx4 v[64:67], v25, s[8:11], s69 offen offset:2048
    s_cmp_gt_u32 s47, 14
    s_cselect_b64 exec, -1, 1
    buffer_load_dwordx4 v[68:71], v25, s[8:11], s69 offen offset:3072
    s_mov_b64 exec, -1
    s_mov_b64 s[88:89], s[24:25]
    s_or_b32 s24, s24, 286331153
    s_or_b32 s25, s25, 273
    v_lshrrev_b32 v1, 3, v5
    v_mul_u32_u24 v1, 65664, v1
    v_and_b32 v4, 7, v5
    v_lshl_add_u32 v1, v4, 4, v1
    v_and_b32 v4, 3, v5
    v_cmp_eq_u32 s[54:55], 0, v4
    v_cmp_eq_u32 s[56:57], 1, v4
    v_mov_b32 v2, 0x3f80
    v_mov_b32 v3, 0x3f800000
    v_cndmask_b32 v6, 0, v2, s[54:55]
    v_cndmask_b32 v6, v6, v3, s[56:57]
    v_mov_b32 v7, v6
    v_mov_b32 v2, 0
    v_mov_b32 v3, 0
    v_mov_b32 v4, 0
    v_mov_b32 v5, 0
    s_lshl_b32 s52, s19, 7
    s_add_u32 s65, s52, s51
    s_lshl_b32 s58, s16, 2
    s_add_u32 s58, s58, s65
    s_lshl_b32 s59, s20, 8
    s_mul_i32 s60, s16, 25088
    s_add_u32 s60, s60, s59
    s_mul_i32 s61, s48, 131328
    s_lshl_b32 s52, s18, 7
    s_add_u32 s61, s61, s52
    s_add_u32 s61, s61, 65011712
    s_add_u32 s52, s16, 1
    s_and_b32 s52, s52, 3
    s_mul_i32 s52, s52, 25088
    s_add_u32 s66, s52, s59
    s_add_u32 s52, s16, 2
    s_and_b32 s52, s52, 3
    s_mul_i32 s52, s52, 25088
    s_add_u32 s67, s52, s59
    s_add_u32 s52, s16, 3
    s_and_b32 s52, s52, 3
    s_mul_i32 s52, s52, 25088
    s_add_u32 s68, s52, s59
    s_mov_b32 s22, 1
    s_mov_b64 exec, 15
    s_waitcnt vmcnt(4)
K3_xp:
    v_cmp_eq_u32 vcc, 0, v24
    s_cbranch_vccz K3_xb
    s_add_u32 s64, s64, 1
    s_cmp_gt_u32 s64, 16777216
    s_cbranch_scc1 K3_xb
    buffer_load_dword v24, v0, s[8:11], s51 offen offset:2048 sc1
    s_waitcnt vmcnt(0)
    s_branch K3_xp
K3_xb:
    v_cmp_ne_u32 vcc, s50, v24
    s_cmp_lg_u64 vcc, 0
    s_cselect_b32 s23, 1, 0
    s_mov_b64 exec, -1
    s_mov_b64 exec, 0xffff
    s_waitcnt lgkmcnt(0)
    v_lshl_add_u32 v12, v19, 8, v12
    v_cmp_lt_u32 vcc, 44, v12
    s_cmp_lg_u64 vcc, 0
    s_cselect_b32 s29, 1, 0
    s_mov_b64 exec, -1
    s_getpc_b64 s[40:41]
K3_pc:
    s_add_u32 s40, s40, K3_fl0_0-K3_pc
    s_addc_u32 s41, s41, 0
    s_mul_i32 s42, s23, K3_fl1_0-K3_fl0_0
    s_mov_b32 s43, K3_fl2_0-K3_fl0_0
    s_add_u32 s45, s23, 1
    s_mul_i32 s45, s45, 6422528
    s_add_u32 s45, s45, s39
    s_waitcnt lgkmcnt(0)
K3_hop:
    s_mov_b32 s52, s39
    s_mov_b32 s39, s45
    s_add_u32 s53, s39, 6422528
    s_cmp_eq_u32 s23, 0
    s_cselect_b32 s45, s52, s53
    s_add_u32 s61, s61, 8192
    s_add_u32 s37, s39, s60
    s_cmp_eq_u32 s22, 7
    s_cselect_b32 s42, s43, s42
    s_add_u32 s26, s40, s42
    s_addc_u32 s27, s41, 0
    s_setprio 3
    s_mov_b32 s94, 2
    s_cmp_lg_u32 s29, 0
    s_cbranch_scc1 K3_slow
    v_lshlrev_b32_sdwa v8, 2, v40 dst_sel:DWORD dst_unused:UNUSED_PAD src0_sel:DWORD src1_sel:WORD_0
    v_lshrrev_b32 v9, 15, v40
    v_lshlrev_b32_sdwa v10, 2, v41 dst_sel:DWORD dst_unused:UNUSED_PAD src0_sel:DWORD src1_sel:WORD_0
    v_lshrrev_b32 v11, 15, v41
    ds_read_b32 v12, v8 offset:50240
    ds_read_b32 v13, v9 offset:50240
    ds_read_b32 v14, v10 offset:50240
    ds_read_b32 v15, v11 offset:50240
    v_lshlrev_b32_sdwa v8, 2, v42 dst_sel:DWORD dst_unused:UNUSED_PAD src0_sel:DWORD src1_sel:WORD_0
    v_lshrrev_b32 v9, 15, v42
    v_lshlrev_b32_sdwa v10, 2, v43 dst_sel:DWORD dst_unused:UNUSED_PAD src0_sel:DWORD src1_sel:WORD_0
    v_lshrrev_b32 v11, 15, v43
    ds_read_b32 v16, v8 offset:50240
    ds_read_b32 v17, v9 offset:50240
    ds_read_b32 v18, v10 offset:50240
    ds_read_b32 v19, v11 offset:50240
    v_lshlrev_b32_sdwa v8, 2, v44 dst_sel:DWORD dst_unused:UNUSED_PAD src0_sel:DWORD src1_sel:WORD_0
    v_lshrrev_b32 v9, 15, v44
    v_lshlrev_b32_sdwa v10, 2, v45 dst_sel:DWORD dst_unused:UNUSED_PAD src0_sel:DWORD src1_sel:WORD_0
    v_lshrrev_b32 v11, 15, v45
    s_sub_u32 s38, s61, 8192
    buffer_store_dwordx4 v[26:29], v1, s[8:11], s38 offen sc1
    s_cmp_eq_u32 s22, 7
    s_cbranch_scc0 K3_npf
    s_cmp_eq_u32 s19, 0
    s_cbranch_scc0 K3_npf
    s_getpc_b64 s[52:53]
PF_1:
    s_add_u32 s52, s52, att_kernel-PF_1
    s_addc_u32 s53, s53, 0
    v_lshlrev_b32 v24, 5, v0
    s_mov_b32 s54, 0
PF_1_l:
    v_cmp_gt_u32 vcc, K4_end-att_kernel, v24
    s_and_b64 exec, exec, vcc
    s_cbranch_execz PF_1_e
    global_load_dword v5, v24, s[52:53]
    v_add_u32 v24, 8192, v24
    s_branch PF_1_l
PF_1_e:
    s_mov_b64 exec, -1
K3_npf:
    ds_read_b32 v20, v8 offset:50240
    ds_read_b32 v21, v9 offset:50240
    ds_read_b32 v22, v10 offset:50240
    ds_read_b32 v23, v11 offset:50240
    s_waitcnt lgkmcnt(8)
    v_mfma_f32_4x4x4_16b_bf16 v[2:5], v[6:7], v[12:13], v[2:5]
    v_lshlrev_b32_sdwa v8, 2, v46 dst_sel:DWORD dst_unused:UNUSED_PAD src0_sel:DWORD src1_sel:WORD_0
    v_lshrrev_b32 v9, 15, v46
    v_mfma_f32_4x4x4_16b_bf16 v[2:5], v[6:7], v[14:15], v[2:5]
    v_lshlrev_b32_sdwa v10, 2, v47 dst_sel:DWORD dst_unused:UNUSED_PAD src0_sel:DWORD src1_sel:WORD_0
    v_lshrrev_b32 v11, 15, v47
    s_bitcmp1_b64 s[24:25], 0
    s_cbranch_scc1 K3_st0
K3_bk0:
    ds_read_b32 v12, v8 offset:50240
    ds_read_b32 v13, v9 offset:50240
    ds_read_b32 v14, v10 offset:50240
    ds_read_b32 v15, v11 offset:50240
    s_waitcnt lgkmcnt(8)
    v_mfma_f32_4x4x4_16b_bf16 v[2:5], v[6:7], v[16:17], v[2:5]
    v_lshlrev_b32_sdwa v8, 2, v48 dst_sel:DWORD dst_unused:UNUSED_PAD src0_sel:DWORD src1_sel:WORD_0
    v_lshrrev_b32 v9, 15, v48
    v_mfma_f32_4x4x4_16b_bf16 v[2:5], v[6:7], v[18:19], v[2:5]
    v_lshlrev_b32_sdwa v10, 2, v49 dst_sel:DWORD dst_unused:UNUSED_PAD src0_sel:DWORD src1_sel:WORD_0
    v_lshrrev_b32 v11, 15, v49
    s_bitcmp1_b64 s[24:25], 1
    s_cbranch_scc1 K3_st1
K3_bk1:
    ds_read_b32 v16, v8 offset:50240
    ds_read_b32 v17, v9 offset:50240
    ds_read_b32 v18, v10 offset:50240
    ds_read_b32 v19, v11 offset:50240
    s_waitcnt lgkmcnt(8)
    v_mfma_f32_4x4x4_16b_bf16 v[2:5], v[6:7], v[20:21], v[2:5]
    v_lshlrev_b32_sdwa v8, 2, v50 dst_sel:DWORD dst_unused:UNUSED_PAD src0_sel:DWORD src1_sel:WORD_0
    v_lshrrev_b32 v9, 15, v50
    v_mfma_f32_4x4x4_16b_bf16 v[2:5], v[6:7], v[22:23], v[2:5]
    v_lshlrev_b32_sdwa v10, 2, v51 dst_sel:DWORD dst_unused:UNUSED_PAD src0_sel:DWORD src1_sel:WORD_0
    v_lshrrev_b32 v11, 15, v51
    s_bitcmp1_b64 s[24:25], 2
    s_cbranch_scc1 K3_st2
K3_bk2:
    ds_read_b32 v20, v8 offset:50240
    ds_read_b32 v21, v9 offset:50240
    ds_read_b32 v22, v10 offset:50240
    ds_read_b32 v23, v11 offset:50240
    s_waitcnt lgkmcnt(8)
    v_mfma_f32_4x4x4_16b_bf16 v[2:5], v[6:7], v[12:13], v[2:5]
    v_lshlrev_b32_sdwa v8, 2, v52 dst_sel:DWORD dst_unused:UNUSED_PAD src0_sel:DWORD src1_sel:WORD_0
    v_lshrrev_b32 v9, 15, v52
    v_mfma_f32_4x4x4_16b_bf16 v[2:5], v[6:7], v[14:15], v[2:5]
    v_lshlrev_b32_sdwa v10, 2, v53 dst_sel:DWORD dst_unused:UNUSED_PAD src0_sel:DWORD src1_sel:WORD_0
    v_lshrrev_b32 v11, 15, v53
    s_bitcmp1_b64 s[24:25], 3
    s_cbranch_scc1 K3_st3
K3_bk3:
    ds_read_b32 v12, v8 offset:50240
    ds_read_b32 v13, v9 offset:50240
    ds_read_b32 v14, v10 offset:50240
    ds_read_b32 v15, v11 offset:50240
    s_waitcnt lgkmcnt(8)
    v_mfma_f32_4x4x4_16b_bf16 v[2:5], v[6:7], v[16:17], v[2:5]
    v_lshlrev_b32_sdwa v8, 2, v54 dst_sel:DWORD dst_unused:UNUSED_PAD src0_sel:DWORD src1_sel:WORD_0
    v_lshrrev_b32 v9, 15, v54
    v_mfma_f32_4x4x4_16b_bf16 v[2:5], v[6:7], v[18:19], v[2:5]
    v_lshlrev_b32_sdwa v10, 2, v55 dst_sel:DWORD dst_unused:UNUSED_PAD src0_sel:DWORD src1_sel:WORD_0
    v_lshrrev_b32 v11, 15, v55
    s_bitcmp1_b64 s[24:25], 4
    s_cbranch_scc1 K3_st4
K3_bk4:
    ds_read_b32 v16, v8 offset:50240
    ds_read_b32 v17, v9 offset:50240
    ds_read_b32 v18, v10 offset:50240
    ds_read_b32 v19, v11 offset:50240
    s_waitcnt lgkmcnt(8)
    v_mfma_f32_4x4x4_16b_bf16 v[2:5], v[6:7], v[20:21], v[2:5]
    v_lshlrev_b32_sdwa v8, 2, v56 dst_sel:DWORD dst_unused:UNUSED_PAD src0_sel:DWORD src1_sel:WORD_0
    v_lshrrev_b32 v9, 15, v56
    v_mfma_f32_4x4x4_16b_bf16 v[2:5], v[6:7], v[22:23], v[2:5]
    v_lshlrev_b32_sdwa v10, 2, v57 dst_sel:DWORD dst_unused:UNUSED_PAD src0_sel:DWORD src1_sel:WORD_0
    v_lshrrev_b32 v11, 15, v57
    s_bitcmp1_b64 s[24:25], 5
    s_cbranch_scc1 K3_st5
K3_bk5:
    ds_read_b32 v20, v8 offset:50240
    ds_read_b32 v21, v9 offset:50240
    ds_read_b32 v22, v10 offset:50240
    ds_read_b32 v23, v11 offset:50240
    s_waitcnt lgkmcnt(8)
    v_mfma_f32_4x4x4_16b_bf16 v[2:5], v[6:7], v[12:13], v[2:5]
    v_lshlrev_b32_sdwa v8, 2, v58 dst_sel:DWORD dst_unused:UNUSED_PAD src0_sel:DWORD src1_sel:WORD_0
    v_lshrrev_b32 v9, 15, v58
    v_mfma_f32_4x4x4_16b_bf16 v[2:5], v[6:7], v[14:15], v[2:5]
    v_lshlrev_b32_sdwa v10, 2, v59 dst_sel:DWORD dst_unused:UNUSED_PAD src0_sel:DWORD src1_sel:WORD_0
    v_lshrrev_b32 v11, 15, v59
    s_bitcmp1_b64 s[24:25], 6
    s_cbranch_scc1 K3_st6
K3_bk6:
    ds_read_b32 v12, v8 offset:50240
    ds_read_b32 v13, v9 offset:50240
    ds_read_b32 v14, v10 offset:50240
    ds_read_b32 v15, v11 offset:50240
    s_waitcnt lgkmcnt(8)
    v_mfma_f32_4x4x4_16b_bf16 v[2:5], v[6:7], v[16:17], v[2:5]
    v_lshlrev_b32_sdwa v8, 2, v60 dst_sel:DWORD dst_unused:UNUSED_PAD src0_sel:DWORD src1_sel:WORD_0
    v_lshrrev_b32 v9, 15, v60
    v_mfma_f32_4x4x4_16b_bf16 v[2:5], v[6:7], v[18:19], v[2:5]
    v_lshlrev_b32_sdwa v10, 2, v61 dst_sel:DWORD dst_unused:UNUSED_PAD src0_sel:DWORD src1_sel:WORD_0
    v_lshrrev_b32 v11, 15, v61
    s_bitcmp1_b64 s[24:25], 7
    s_cbranch_scc1 K3_st7
K3_bk7:
    ds_read_b32 v16, v8 offset:50240
    ds_read_b32 v17, v9 offset:50240
    ds_read_b32 v18, v10 offset:50240
    ds_read_b32 v19, v11 offset:50240
    s_waitcnt lgkmcnt(8)
    v_mfma_f32_4x4x4_16b_bf16 v[2:5], v[6:7], v[20:21], v[2:5]
    v_lshlrev_b32_sdwa v8, 2, v62 dst_sel:DWORD dst_unused:UNUSED_PAD src0_sel:DWORD src1_sel:WORD_0
    v_lshrrev_b32 v9, 15, v62
    v_mfma_f32_4x4x4_16b_bf16 v[2:5], v[6:7], v[22:23], v[2:5]
    v_lshlrev_b32_sdwa v10, 2, v63 dst_sel:DWORD dst_unused:UNUSED_PAD src0_sel:DWORD src1_sel:WORD_0
    v_lshrrev_b32 v11, 15, v63
    s_bitcmp1_b64 s[24:25], 8
    s_cbranch_scc1 K3_st8
K3_bk8:
    ds_read_b32 v20, v8 offset:50240
    ds_read_b32 v21, v9 offset:50240
    ds_read_b32 v22, v10 offset:50240
    ds_read_b32 v23, v11 offset:50240
    s_waitcnt lgkmcnt(8)
    v_mfma_f32_4x4x4_16b_bf16 v[2:5], v[6:7], v[12:13], v[2:5]
    v_lshlrev_b32_sdwa v8, 2, v64 dst_sel:DWORD dst_unused:UNUSED_PAD src0_sel:DWORD src1_sel:WORD_0
    v_lshrrev_b32 v9, 15, v64
    v_mfma_f32_4x4x4_16b_bf16 v[2:5], v[6:7], v[14:15], v[2:5]
    v_lshlrev_b32_sdwa v10, 2, v65 dst_sel:DWORD dst_unused:UNUSED_PAD src0_sel:DWORD src1_sel:WORD_0
    v_lshrrev_b32 v11, 15, v65
    s_setprio 2
    s_bitcmp1_b64 s[24:25], 9
    s_cbranch_scc1 K3_st9
K3_bk9:
    ds_read_b32 v12, v8 offset:50240
    ds_read_b32 v13, v9 offset:50240
    ds_read_b32 v14, v10 offset:50240
    ds_read_b32 v15, v11 offset:50240
    s_waitcnt lgkmcnt(8)
    v_mfma_f32_4x4x4_16b_bf16 v[2:5], v[6:7], v[16:17], v[2:5]
    v_lshlrev_b32_sdwa v8, 2, v66 dst_sel:DWORD dst_unused:UNUSED_PAD src0_sel:DWORD src1_sel:WORD_0
    v_lshrrev_b32 v9, 15, v66
    v_mfma_f32_4x4x4_16b_bf16 v[2:5], v[6:7], v[18:19], v[2:5]
    v_lshlrev_b32_sdwa v10, 2, v67 dst_sel:DWORD dst_unused:UNUSED_PAD src0_sel:DWORD src1_sel:WORD_0
    v_lshrrev_b32 v11, 15, v67
    s_bitcmp1_b64 s[24:25], 10
    s_cbranch_scc1 K3_st10
K3_bk10:
    ds_read_b32 v16, v8 offset:50240
    ds_read_b32 v17, v9 offset:50240
    ds_read_b32 v18, v10 offset:50240
    ds_read_b32 v19, v11 offset:50240
    s_waitcnt lgkmcnt(8)
    v_mfma_f32_4x4x4_16b_bf16 v[2:5], v[6:7], v[20:21], v[2:5]
    v_lshlrev_b32_sdwa v8, 2, v68 dst_sel:DWORD dst_unused:UNUSED_PAD src0_sel:DWORD src1_sel:WORD_0
    v_lshrrev_b32 v9, 15, v68
    v_mfma_f32_4x4x4_16b_bf16 v[2:5], v[6:7], v[22:23], v[2:5]
    v_lshlrev_b32_sdwa v10, 2, v69 dst_sel:DWORD dst_unused:UNUSED_PAD src0_sel:DWORD src1_sel:WORD_0
    v_lshrrev_b32 v11, 15, v69
    s_bitcmp1_b64 s[24:25], 11
    s_cbranch_scc1 K3_st11
K3_bk11:
    ds_read_b32 v20, v8 offset:50240
    ds_read_b32 v21, v9 offset:50240
    ds_read_b32 v22, v10 offset:50240
    ds_read_b32 v23, v11 offset:50240
    s_waitcnt lgkmcnt(8)
    v_mfma_f32_4x4x4_16b_bf16 v[2:5], v[6:7], v[12:13], v[2:5]
    v_lshlrev_b32_sdwa v8, 2, v70 dst_sel:DWORD dst_unused:UNUSED_PAD src0_sel:DWORD src1_sel:WORD_0
    v_lshrrev_b32 v9, 15, v70
    v_mfma_f32_4x4x4_16b_bf16 v[2:5], v[6:7], v[14:15], v[2:5]
    v_lshlrev_b32_sdwa v10, 2, v71 dst_sel:DWORD dst_unused:UNUSED_PAD src0_sel:DWORD src1_sel:WORD_0
    v_lshrrev_b32 v11, 15, v71
    s_bitcmp1_b64 s[24:25], 12
    s_cbranch_scc1 K3_st12
K3_bk12:
    ds_read_b32 v12, v8 offset:50240
    ds_read_b32 v13, v9 offset:50240
    ds_read_b32 v14, v10 offset:50240
    ds_read_b32 v15, v11 offset:50240
    s_waitcnt lgkmcnt(8)
    v_mfma_f32_4x4x4_16b_bf16 v[2:5], v[6:7], v[16:17], v[2:5]
    v_lshlrev_b32_sdwa v8, 2, v72 dst_sel:DWORD dst_unused:UNUSED_PAD src0_sel:DWORD src1_sel:WORD_0
    v_lshrrev_b32 v9, 15, v72
    v_mfma_f32_4x4x4_16b_bf16 v[2:5], v[6:7], v[18:19], v[2:5]
    v_lshlrev_b32_sdwa v10, 2, v73 dst_sel:DWORD dst_unused:UNUSED_PAD src0_sel:DWORD src1_sel:WORD_0
    v_lshrrev_b32 v11, 15, v73
    s_bitcmp1_b64 s[24:25], 13
    s_cbranch_scc1 K3_st13
K3_bk13:
    ds_read_b32 v16, v8 offset:50240
    ds_read_b32 v17, v9 offset:50240
    ds_read_b32 v18, v10 offset:50240
    ds_read_b32 v19, v11 offset:50240
    s_waitcnt lgkmcnt(8)
    v_mfma_f32_4x4x4_16b_bf16 v[2:5], v[6:7], v[20:21], v[2:5]
    v_lshlrev_b32_sdwa v8, 2, v74 dst_sel:DWORD dst_unused:UNUSED_PAD src0_sel:DWORD src1_sel:WORD_0
    v_lshrrev_b32 v9, 15, v74
    v_mfma_f32_4x4x4_16b_bf16 v[2:5], v[6:7], v[22:23], v[2:5]
    v_lshlrev_b32_sdwa v10, 2, v75 dst_sel:DWORD dst_unused:UNUSED_PAD src0_sel:DWORD src1_sel:WORD_0
    v_lshrrev_b32 v11, 15, v75
    s_bitcmp1_b64 s[24:25], 14
    s_cbranch_scc1 K3_st14
K3_bk14:
    ds_read_b32 v20, v8 offset:50240
    ds_read_b32 v21, v9 offset:50240
    ds_read_b32 v22, v10 offset:50240
    ds_read_b32 v23, v11 offset:50240
    s_waitcnt lgkmcnt(8)
    v_mfma_f32_4x4x4_16b_bf16 v[2:5], v[6:7], v[12:13], v[2:5]
    v_lshlrev_b32_sdwa v8, 2, v76 dst_sel:DWORD dst_unused:UNUSED_PAD src0_sel:DWORD src1_sel:WORD_0
    v_lshrrev_b32 v9, 15, v76
    v_mfma_f32_4x4x4_16b_bf16 v[2:5], v[6:7], v[14:15], v[2:5]
    v_lshlrev_b32_sdwa v10, 2, v77 dst_sel:DWORD dst_unused:UNUSED_PAD src0_sel:DWORD src1_sel:WORD_0
    v_lshrrev_b32 v11, 15, v77
    s_bitcmp1_b64 s[24:25], 15
    s_cbranch_scc1 K3_st15
K3_bk15:
    ds_read_b32 v12, v8 offset:50240
    ds_read_b32 v13, v9 offset:50240
    ds_read_b32 v14, v10 offset:50240
    ds_read_b32 v15, v11 offset:50240
    s_waitcnt lgkmcnt(8)
    v_mfma_f32_4x4x4_16b_bf16 v[2:5], v[6:7], v[16:17], v[2:5]
    v_lshlrev_b32_sdwa v8, 2, v78 dst_sel:DWORD dst_unused:UNUSED_PAD src0_sel:DWORD src1_sel:WORD_0
    v_lshrrev_b32 v9, 15, v78
    v_mfma_f32_4x4x4_16b_bf16 v[2:5], v[6:7], v[18:19], v[2:5]
    v_lshlrev_b32_sdwa v10, 2, v79 dst_sel:DWORD dst_unused:UNUSED_PAD src0_sel:DWORD src1_sel:WORD_0
    v_lshrrev_b32 v11, 15, v79
    s_bitcmp1_b64 s[24:25], 16
    s_cbranch_scc1 K3_st16
K3_bk16:
    ds_read_b32 v16, v8 offset:50240
    ds_read_b32 v17, v9 offset:50240
    ds_read_b32 v18, v10 offset:50240
    ds_read_b32 v19, v11 offset:50240
    s_waitcnt lgkmcnt(8)
    v_mfma_f32_4x4x4_16b_bf16 v[2:5], v[6:7], v[20:21], v[2:5]
    v_lshlrev_b32_sdwa v8, 2, v80 dst_sel:DWORD dst_unused:UNUSED_PAD src0_sel:DWORD src1_sel:WORD_0
    v_lshrrev_b32 v9, 15, v80
    v_mfma_f32_4x4x4_16b_bf16 v[2:5], v[6:7], v[22:23], v[2:5]
    v_lshlrev_b32_sdwa v10, 2, v81 dst_sel:DWORD dst_unused:UNUSED_PAD src0_sel:DWORD src1_sel:WORD_0
    v_lshrrev_b32 v11, 15, v81
    s_bitcmp1_b64 s[24:25], 17
    s_cbranch_scc1 K3_st17
K3_bk17:
    ds_read_b32 v20, v8 offset:50240
    ds_read_b32 v21, v9 offset:50240
    ds_read_b32 v22, v10 offset:50240
    ds_read_b32 v23, v11 offset:50240
    s_waitcnt lgkmcnt(8)
    v_mfma_f32_4x4x4_16b_bf16 v[2:5], v[6:7], v[12:13], v[2:5]
    v_lshlrev_b32_sdwa v8, 2, v82 dst_sel:DWORD dst_unused:UNUSED_PAD src0_sel:DWORD src1_sel:WORD_0
    v_lshrrev_b32 v9, 15, v82
    v_mfma_f32_4x4x4_16b_bf16 v[2:5], v[6:7], v[14:15], v[2:5]
    v_lshlrev_b32_sdwa v10, 2, v83 dst_sel:DWORD dst_unused:UNUSED_PAD src0_sel:DWORD src1_sel:WORD_0
    v_lshrrev_b32 v11, 15, v83
    s_setprio 1
    s_bitcmp1_b64 s[24:25], 18
    s_cbranch_scc1 K3_st18
K3_bk18:
    ds_read_b32 v12, v8 offset:50240
    ds_read_b32 v13, v9 offset:50240
    ds_read_b32 v14, v10 offset:50240
    ds_read_b32 v15, v11 offset:50240
    s_waitcnt lgkmcnt(8)
    v_mfma_f32_4x4x4_16b_bf16 v[2:5], v[6:7], v[16:17], v[2:5]
    v_lshlrev_b32_sdwa v8, 2, v84 dst_sel:DWORD dst_unused:UNUSED_PAD src0_sel:DWORD src1_sel:WORD_0
    v_lshrrev_b32 v9, 15, v84
    v_mfma_f32_4x4x4_16b_bf16 v[2:5], v[6:7], v[18:19], v[2:5]
    v_lshlrev_b32_sdwa v10, 2, v85 dst_sel:DWORD dst_unused:UNUSED_PAD src0_sel:DWORD src1_sel:WORD_0
    v_lshrrev_b32 v11, 15, v85
    s_bitcmp1_b64 s[24:25], 19
    s_cbranch_scc1 K3_st19
K3_bk19:
    ds_read_b32 v16, v8 offset:50240
    ds_read_b32 v17, v9 offset:50240
    ds_read_b32 v18, v10 offset:50240
    ds_read_b32 v19, v11 offset:50240
    s_waitcnt lgkmcnt(8)
    v_mfma_f32_4x4x4_16b_bf16 v[2:5], v[6:7], v[20:21], v[2:5]
    v_lshlrev_b32_sdwa v8, 2, v86 dst_sel:DWORD dst_unused:UNUSED_PAD src0_sel:DWORD src1_sel:WORD_0
    v_lshrrev_b32 v9, 15, v86
    v_mfma_f32_4x4x4_16b_bf16 v[2:5], v[6:7], v[22:23], v[2:5]
    v_lshlrev_b32_sdwa v10, 2, v87 dst_sel:DWORD dst_unused:UNUSED_PAD src0_sel:DWORD src1_sel:WORD_0
    v_lshrrev_b32 v11, 15, v87
    s_bitcmp1_b64 s[24:25], 20
    s_cbranch_scc1 K3_st20
K3_bk20:
    ds_read_b32 v20, v8 offset:50240
    ds_read_b32 v21, v9 offset:50240
    ds_read_b32 v22, v10 offset:50240
    ds_read_b32 v23, v11 offset:50240
    s_waitcnt lgkmcnt(8)
    v_mfma_f32_4x4x4_16b_bf16 v[2:5], v[6:7], v[12:13], v[2:5]
    v_lshlrev_b32_sdwa v8, 2, v88 dst_sel:DWORD dst_unused:UNUSED_PAD src0_sel:DWORD src1_sel:WORD_0
    v_lshrrev_b32 v9, 15, v88
    v_mfma_f32_4x4x4_16b_bf16 v[2:5], v[6:7], v[14:15], v[2:5]
    v_lshlrev_b32_sdwa v10, 2, v89 dst_sel:DWORD dst_unused:UNUSED_PAD src0_sel:DWORD src1_sel:WORD_0
    v_lshrrev_b32 v11, 15, v89
    s_bitcmp1_b64 s[24:25], 21
    s_cbranch_scc1 K3_st21
K3_bk21:
    ds_read_b32 v12, v8 offset:50240
    ds_read_b32 v13, v9 offset:50240
    ds_read_b32 v14, v10 offset:50240
    ds_read_b32 v15, v11 offset:50240
    s_waitcnt lgkmcnt(8)
    v_mfma_f32_4x4x4_16b_bf16 v[2:5], v[6:7], v[16:17], v[2:5]
    v_lshlrev_b32_sdwa v8, 2, v90 dst_sel:DWORD dst_unused:UNUSED_PAD src0_sel:DWORD src1_sel:WORD_0
    v_lshrrev_b32 v9, 15, v90
    v_mfma_f32_4x4x4_16b_bf16 v[2:5], v[6:7], v[18:19], v[2:5]
    v_lshlrev_b32_sdwa v10, 2, v91 dst_sel:DWORD dst_unused:UNUSED_PAD src0_sel:DWORD src1_sel:WORD_0
    v_lshrrev_b32 v11, 15, v91
    s_bitcmp1_b64 s[24:25], 22
    s_cbranch_scc1 K3_st22
K3_bk22:
    ds_read_b32 v16, v8 offset:50240
    ds_read_b32 v17, v9 offset:50240
    ds_read_b32 v18, v10 offset:50240
    ds_read_b32 v19, v11 offset:50240
    s_waitcnt lgkmcnt(8)
    v_mfma_f32_4x4x4_16b_bf16 v[2:5], v[6:7], v[20:21], v[2:5]
    v_lshlrev_b32_sdwa v8, 2, v92 dst_sel:DWORD dst_unused:UNUSED_PAD src0_sel:DWORD src1_sel:WORD_0
    v_lshrrev_b32 v9, 15, v92
    v_mfma_f32_4x4x4_16b_bf16 v[2:5], v[6:7], v[22:23], v[2:5]
    v_lshlrev_b32_sdwa v10, 2, v93 dst_sel:DWORD dst_unused:UNUSED_PAD src0_sel:DWORD src1_sel:WORD_0
    v_lshrrev_b32 v11, 15, v93
    s_bitcmp1_b64 s[24:25], 23
    s_cbranch_scc1 K3_st23
K3_bk23:
    ds_read_b32 v20, v8 offset:50240
    ds_read_b32 v21, v9 offset:50240
    ds_read_b32 v22, v10 offset:50240
    ds_read_b32 v23, v11 offset:50240
    s_waitcnt lgkmcnt(8)
    v_mfma_f32_4x4x4_16b_bf16 v[2:5], v[6:7], v[12:13], v[2:5]
    v_lshlrev_b32_sdwa v8, 2, v94 dst_sel:DWORD dst_unused:UNUSED_PAD src0_sel:DWORD src1_sel:WORD_0
    v_lshrrev_b32 v9, 15, v94
    v_mfma_f32_4x4x4_16b_bf16 v[2:5], v[6:7], v[14:15], v[2:5]
    v_lshlrev_b32_sdwa v10, 2, v95 dst_sel:DWORD dst_unused:UNUSED_PAD src0_sel:DWORD src1_sel:WORD_0
    v_lshrrev_b32 v11, 15, v95
    s_bitcmp1_b64 s[24:25], 24
    s_cbranch_scc1 K3_st24
K3_bk24:
    ds_read_b32 v12, v8 offset:50240
    ds_read_b32 v13, v9 offset:50240
    ds_read_b32 v14, v10 offset:50240
    ds_read_b32 v15, v11 offset:50240
    s_waitcnt lgkmcnt(8)
    v_mfma_f32_4x4x4_16b_bf16 v[2:5], v[6:7], v[16:17], v[2:5]
    v_lshlrev_b32_sdwa v8, 2, v96 dst_sel:DWORD dst_unused:UNUSED_PAD src0_sel:DWORD src1_sel:WORD_0
    v_lshrrev_b32 v9, 15, v96
    v_mfma_f32_4x4x4_16b_bf16 v[2:5], v[6:7], v[18:19], v[2:5]
    v_lshlrev_b32_sdwa v10, 2, v97 dst_sel:DWORD dst_unused:UNUSED_PAD src0_sel:DWORD src1_sel:WORD_0
    v_lshrrev_b32 v11, 15, v97
    s_bitcmp1_b64 s[24:25], 25
    s_cbranch_scc1 K3_st25
K3_bk25:
    ds_read_b32 v16, v8 offset:50240
    ds_read_b32 v17, v9 offset:50240
    ds_read_b32 v18, v10 offset:50240
    ds_read_b32 v19, v11 offset:50240
    s_waitcnt lgkmcnt(8)
    v_mfma_f32_4x4x4_16b_bf16 v[2:5], v[6:7], v[20:21], v[2:5]
    v_lshlrev_b32_sdwa v8, 2, v98 dst_sel:DWORD dst_unused:UNUSED_PAD src0_sel:DWORD src1_sel:WORD_0
    v_lshrrev_b32 v9, 15, v98
    v_mfma_f32_4x4x4_16b_bf16 v[2:5], v[6:7], v[22:23], v[2:5]
    v_lshlrev_b32_sdwa v10, 2, v99 dst_sel:DWORD dst_unused:UNUSED_PAD src0_sel:DWORD src1_sel:WORD_0
    v_lshrrev_b32 v11, 15, v99
    s_bitcmp1_b64 s[24:25], 26
    s_cbranch_scc1 K3_st26
K3_bk26:
    ds_read_b32 v20, v8 offset:50240
    ds_read_b32 v21, v9 offset:50240
    ds_read_b32 v22, v10 offset:50240
    ds_read_b32 v23, v11 offset:50240
    s_waitcnt lgkmcnt(8)
    v_mfma_f32_4x4x4_16b_bf16 v[2:5], v[6:7], v[12:13], v[2:5]
    v_lshlrev_b32_sdwa v8, 2, v100 dst_sel:DWORD dst_unused:UNUSED_PAD src0_sel:DWORD src1_sel:WORD_0
    v_lshrrev_b32 v9, 15, v100
    v_mfma_f32_4x4x4_16b_bf16 v[2:5], v[6:7], v[14:15], v[2:5]
    v_lshlrev_b32_sdwa v10, 2, v101 dst_sel:DWORD dst_unused:UNUSED_PAD src0_sel:DWORD src1_sel:WORD_0
    v_lshrrev_b32 v11, 15, v101
    s_setprio 0
    s_bitcmp1_b64 s[24:25], 27
    s_cbranch_scc1 K3_st27
K3_bk27:
    ds_read_b32 v12, v8 offset:50240
    ds_read_b32 v13, v9 offset:50240
    ds_read_b32 v14, v10 offset:50240
    ds_read_b32 v15, v11 offset:50240
    s_waitcnt lgkmcnt(8)
    v_mfma_f32_4x4x4_16b_bf16 v[2:5], v[6:7], v[16:17], v[2:5]
    v_lshlrev_b32_sdwa v8, 2, v102 dst_sel:DWORD dst_unused:UNUSED_PAD src0_sel:DWORD src1_sel:WORD_0
    v_lshrrev_b32 v9, 15, v102
    v_mfma_f32_4x4x4_16b_bf16 v[2:5], v[6:7], v[18:19], v[2:5]
    v_lshlrev_b32_sdwa v10, 2, v103 dst_sel:DWORD dst_unused:UNUSED_PAD src0_sel:DWORD src1_sel:WORD_0
    v_lshrrev_b32 v11, 15, v103
    s_bitcmp1_b64 s[24:25], 28
    s_cbranch_scc1 K3_st28
K3_bk28:
    ds_read_b32 v16, v8 offset:50240
    ds_read_b32 v17, v9 offset:50240
    ds_read_b32 v18, v10 offset:50240
    ds_read_b32 v19, v11 offset:50240
    s_waitcnt lgkmcnt(8)
    v_mfma_f32_4x4x4_16b_bf16 v[2:5], v[6:7], v[20:21], v[2:5]
    v_lshlrev_b32_sdwa v8, 2, v104 dst_sel:DWORD dst_unused:UNUSED_PAD src0_sel:DWORD src1_sel:WORD_0
    v_lshrrev_b32 v9, 15, v104
    v_mfma_f32_4x4x4_16b_bf16 v[2:5], v[6:7], v[22:23], v[2:5]
    v_lshlrev_b32_sdwa v10, 2, v105 dst_sel:DWORD dst_unused:UNUSED_PAD src0_sel:DWORD src1_sel:WORD_0
    v_lshrrev_b32 v11, 15, v105
    s_bitcmp1_b64 s[24:25], 29
    s_cbranch_scc1 K3_st29
K3_bk29:
    ds_read_b32 v20, v8 offset:50240
    ds_read_b32 v21, v9 offset:50240
    ds_read_b32 v22, v10 offset:50240
    ds_read_b32 v23, v11 offset:50240
    s_waitcnt lgkmcnt(8)
    v_mfma_f32_4x4x4_16b_bf16 v[2:5], v[6:7], v[12:13], v[2:5]
    v_lshlrev_b32_sdwa v8, 2, v106 dst_sel:DWORD dst_unused:UNUSED_PAD src0_sel:DWORD src1_sel:WORD_0
    v_lshrrev_b32 v9, 15, v106
    v_mfma_f32_4x4x4_16b_bf16 v[2:5], v[6:7], v[14:15], v[2:5]
    v_lshlrev_b32_sdwa v10, 2, v107 dst_sel:DWORD dst_unused:UNUSED_PAD src0_sel:DWORD src1_sel:WORD_0
    v_lshrrev_b32 v11, 15, v107
    s_bitcmp1_b64 s[24:25], 30
    s_cbranch_scc1 K3_st30
K3_bk30:
    ds_read_b32 v12, v8 offset:50240
    ds_read_b32 v13, v9 offset:50240
    ds_read_b32 v14, v10 offset:50240
    ds_read_b32 v15, v11 offset:50240
    s_waitcnt lgkmcnt(8)
    v_mfma_f32_4x4x4_16b_bf16 v[2:5], v[6:7], v[16:17], v[2:5]
    v_lshlrev_b32_sdwa v8, 2, v108 dst_sel:DWORD dst_unused:UNUSED_PAD src0_sel:DWORD src1_sel:WORD_0
    v_lshrrev_b32 v9, 15, v108
    v_mfma_f32_4x4x4_16b_bf16 v[2:5], v[6:7], v[18:19], v[2:5]
    v_lshlrev_b32_sdwa v10, 2, v109 dst_sel:DWORD dst_unused:UNUSED_PAD src0_sel:DWORD src1_sel:WORD_0
    v_lshrrev_b32 v11, 15, v109
    s_bitcmp1_b64 s[24:25], 31
    s_cbranch_scc1 K3_st31
K3_bk31:
    ds_read_b32 v16, v8 offset:50240
    ds_read_b32 v17, v9 offset:50240
    ds_read_b32 v18, v10 offset:50240
    ds_read_b32 v19, v11 offset:50240
    s_waitcnt lgkmcnt(8)
    v_mfma_f32_4x4x4_16b_bf16 v[2:5], v[6:7], v[20:21], v[2:5]
    v_lshlrev_b32_sdwa v8, 2, v110 dst_sel:DWORD dst_unused:UNUSED_PAD src0_sel:DWORD src1_sel:WORD_0
    v_lshrrev_b32 v9, 15, v110
    v_mfma_f32_4x4x4_16b_bf16 v[2:5], v[6:7], v[22:23], v[2:5]
    v_lshlrev_b32_sdwa v10, 2, v111 dst_sel:DWORD dst_unused:UNUSED_PAD src0_sel:DWORD src1_sel:WORD_0
    v_lshrrev_b32 v11, 15, v111
    s_bitcmp1_b64 s[24:25], 32
    s_cbranch_scc1 K3_st32
K3_bk32:
    ds_read_b32 v20, v8 offset:50240
    ds_read_b32 v21, v9 offset:50240
    ds_read_b32 v22, v10 offset:50240
    ds_read_b32 v23, v11 offset:50240
    s_waitcnt lgkmcnt(8)
    v_mfma_f32_4x4x4_16b_bf16 v[2:5], v[6:7], v[12:13], v[2:5]
    v_lshlrev_b32_sdwa v8, 2, v112 dst_sel:DWORD dst_unused:UNUSED_PAD src0_sel:DWORD src1_sel:WORD_0
    v_lshrrev_b32 v9, 15, v112
    v_mfma_f32_4x4x4_16b_bf16 v[2:5], v[6:7], v[14:15], v[2:5]
    v_lshlrev_b32_sdwa v10, 2, v113 dst_sel:DWORD dst_unused:UNUSED_PAD src0_sel:DWORD src1_sel:WORD_0
    v_lshrrev_b32 v11, 15, v113
    s_bitcmp1_b64 s[24:25], 33
    s_cbranch_scc1 K3_st33
K3_bk33:
    ds_read_b32 v12, v8 offset:50240
    ds_read_b32 v13, v9 offset:50240
    ds_read_b32 v14, v10 offset:50240
    ds_read_b32 v15, v11 offset:50240
    s_waitcnt lgkmcnt(8)
    v_mfma_f32_4x4x4_16b_bf16 v[2:5], v[6:7], v[16:17], v[2:5]
    v_lshlrev_b32_sdwa v8, 2, v114 dst_sel:DWORD dst_unused:UNUSED_PAD src0_sel:DWORD src1_sel:WORD_0
    v_lshrrev_b32 v9, 15, v114
    v_mfma_f32_4x4x4_16b_bf16 v[2:5], v[6:7], v[18:19], v[2:5]
    v_lshlrev_b32_sdwa v10, 2, v115 dst_sel:DWORD dst_unused:UNUSED_PAD src0_sel:DWORD src1_sel:WORD_0
    v_lshrrev_b32 v11, 15, v115
    s_bitcmp1_b64 s[24:25], 34
    s_cbranch_scc1 K3_st34
K3_bk34:
    ds_read_b32 v16, v8 offset:50240
    ds_read_b32 v17, v9 offset:50240
    ds_read_b32 v18, v10 offset:50240
    ds_read_b32 v19, v11 offset:50240
    s_waitcnt lgkmcnt(8)
    v_mfma_f32_4x4x4_16b_bf16 v[2:5], v[6:7], v[20:21], v[2:5]
    v_lshlrev_b32_sdwa v8, 2, v116 dst_sel:DWORD dst_unused:UNUSED_PAD src0_sel:DWORD src1_sel:WORD_0
    v_lshrrev_b32 v9, 15, v116
    v_mfma_f32_4x4x4_16b_bf16 v[2:5], v[6:7], v[22:23], v[2:5]
    v_lshlrev_b32_sdwa v10, 2, v117 dst_sel:DWORD dst_unused:UNUSED_PAD src0_sel:DWORD src1_sel:WORD_0
    v_lshrrev_b32 v11, 15, v117
    s_bitcmp1_b64 s[24:25], 35
    s_cbranch_scc1 K3_st35
K3_bk35:
    ds_read_b32 v20, v8 offset:50240
    ds_read_b32 v21, v9 offset:50240
    ds_read_b32 v22, v10 offset:50240
    ds_read_b32 v23, v11 offset:50240
    s_waitcnt lgkmcnt(8)
    v_mfma_f32_4x4x4_16b_bf16 v[2:5], v[6:7], v[12:13], v[2:5]
    v_lshlrev_b32_sdwa v8, 2, v118 dst_sel:DWORD dst_unused:UNUSED_PAD src0_sel:DWORD src1_sel:WORD_0
    v_lshrrev_b32 v9, 15, v118
    v_mfma_f32_4x4x4_16b_bf16 v[2:5], v[6:7], v[14:15], v[2:5]
    v_lshlrev_b32_sdwa v10, 2, v119 dst_sel:DWORD dst_unused:UNUSED_PAD src0_sel:DWORD src1_sel:WORD_0
    v_lshrrev_b32 v11, 15, v119
    s_bitcmp1_b64 s[24:25], 36
    s_cbranch_scc1 K3_st36
K3_bk36:
    ds_read_b32 v12, v8 offset:50240
    ds_read_b32 v13, v9 offset:50240
    ds_read_b32 v14, v10 offset:50240
    ds_read_b32 v15, v11 offset:50240
    s_waitcnt lgkmcnt(8)
    v_mfma_f32_4x4x4_16b_bf16 v[2:5], v[6:7], v[16:17], v[2:5]
    v_lshlrev_b32_sdwa v8, 2, v120 dst_sel:DWORD dst_unused:UNUSED_PAD src0_sel:DWORD src1_sel:WORD_0
    v_lshrrev_b32 v9, 15, v120
    v_mfma_f32_4x4x4_16b_bf16 v[2:5], v[6:7], v[18:19], v[2:5]
    v_lshlrev_b32_sdwa v10, 2, v121 dst_sel:DWORD dst_unused:UNUSED_PAD src0_sel:DWORD src1_sel:WORD_0
    v_lshrrev_b32 v11, 15, v121
    s_bitcmp1_b64 s[24:25], 37
    s_cbranch_scc1 K3_st37
K3_bk37:
    ds_read_b32 v16, v8 offset:50240
    ds_read_b32 v17, v9 offset:50240
    ds_read_b32 v18, v10 offset:50240
    ds_read_b32 v19, v11 offset:50240
    s_waitcnt lgkmcnt(8)
    v_mfma_f32_4x4x4_16b_bf16 v[2:5], v[6:7], v[20:21], v[2:5]
    v_lshlrev_b32_sdwa v8, 2, v122 dst_sel:DWORD dst_unused:UNUSED_PAD src0_sel:DWORD src1_sel:WORD_0
    v_lshrrev_b32 v9, 15, v122
    v_mfma_f32_4x4x4_16b_bf16 v[2:5], v[6:7], v[22:23], v[2:5]
    v_lshlrev_b32_sdwa v10, 2, v123 dst_sel:DWORD dst_unused:UNUSED_PAD src0_sel:DWORD src1_sel:WORD_0
    v_lshrrev_b32 v11, 15, v123
    s_bitcmp1_b64 s[24:25], 38
    s_cbranch_scc1 K3_st38
K3_bk38:
    ds_read_b32 v20, v8 offset:50240
    ds_read_b32 v21, v9 offset:50240
    ds_read_b32 v22, v10 offset:50240
    ds_read_b32 v23, v11 offset:50240
    s_waitcnt lgkmcnt(8)
    v_mfma_f32_4x4x4_16b_bf16 v[2:5], v[6:7], v[12:13], v[2:5]
    v_lshlrev_b32_sdwa v8, 2, v124 dst_sel:DWORD dst_unused:UNUSED_PAD src0_sel:DWORD src1_sel:WORD_0
    v_lshrrev_b32 v9, 15, v124
    v_mfma_f32_4x4x4_16b_bf16 v[2:5], v[6:7], v[14:15], v[2:5]
    v_lshlrev_b32_sdwa v10, 2, v125 dst_sel:DWORD dst_unused:UNUSED_PAD src0_sel:DWORD src1_sel:WORD_0
    v_lshrrev_b32 v11, 15, v125
    s_bitcmp1_b64 s[24:25], 39
    s_cbranch_scc1 K3_st39
K3_bk39:
    ds_read_b32 v12, v8 offset:50240
    ds_read_b32 v13, v9 offset:50240
    ds_read_b32 v14, v10 offset:50240
    ds_read_b32 v15, v11 offset:50240
    s_waitcnt lgkmcnt(8)
    v_mfma_f32_4x4x4_16b_bf16 v[2:5], v[6:7], v[16:17], v[2:5]
    v_lshlrev_b32_sdwa v8, 2, v126 dst_sel:DWORD dst_unused:UNUSED_PAD src0_sel:DWORD src1_sel:WORD_0
    v_lshrrev_b32 v9, 15, v126
    v_mfma_f32_4x4x4_16b_bf16 v[2:5], v[6:7], v[18:19], v[2:5]
    v_lshlrev_b32_sdwa v10, 2, v127 dst_sel:DWORD dst_unused:UNUSED_PAD src0_sel:DWORD src1_sel:WORD_0
    v_lshrrev_b32 v11, 15, v127
    s_bitcmp1_b64 s[24:25], 40
    s_cbranch_scc1 K3_st40
K3_bk40:
    ds_read_b32 v16, v8 offset:50240
    ds_read_b32 v17, v9 offset:50240
    ds_read_b32 v18, v10 offset:50240
    ds_read_b32 v19, v11 offset:50240
    s_waitcnt lgkmcnt(8)
    v_mfma_f32_4x4x4_16b_bf16 v[2:5], v[6:7], v[20:21], v[2:5]
    s_nop 1
    v_mfma_f32_4x4x4_16b_bf16 v[2:5], v[6:7], v[22:23], v[2:5]
    s_bitcmp1_b64 s[24:25], 41
    s_cbranch_scc1 K3_st41
K3_bk41:
    s_endpgm
K3_st0:
    s_cmp_eq_u32 s22, 1
    s_cbranch_scc0 K3_nl0
    v_lshlrev_b32 v25, 2, v0
    s_cmp_gt_u32 s47, 16
    s_cselect_b64 exec, -1, 1
    s_add_u32 s69, s69, 4096
    buffer_load_dwordx4 v[72:75], v25, s[8:11], s69 offen offset:0
    s_cmp_gt_u32 s47, 18
    s_cselect_b64 exec, -1, 1
    buffer_load_dwordx4 v[76:79], v25, s[8:11], s69 offen offset:1024
    s_mov_b64 exec, -1
    s_waitcnt vmcnt(6)
K3_nl0:
    s_bitcmp1_b64 s[32:33], 0
    s_cbranch_scc0 K3_nf0
    s_swappc_b64 s[30:31], s[26:27]
K3_nf0:
    s_cmp_eq_u32 s28, 0
    s_cbranch_scc1 K3_dr1
    s_branch K3_bk0
K3_st1:
    s_bitcmp1_b64 s[32:33], 1
    s_cbranch_scc0 K3_nf1
    s_swappc_b64 s[30:31], s[26:27]
K3_nf1:
    s_cmp_eq_u32 s28, 1
    s_cbranch_scc1 K3_dr2
    s_branch K3_bk1
K3_st2:
    s_bitcmp1_b64 s[32:33], 2
    s_cbranch_scc0 K3_nf2
    s_swappc_b64 s[30:31], s[26:27]
K3_nf2:
    s_cmp_eq_u32 s28, 2
    s_cbranch_scc1 K3_dr0
    s_branch K3_bk2
K3_st3:
    s_bitcmp1_b64 s[32:33], 3
    s_cbranch_scc0 K3_nf3
    s_swappc_b64 s[30:31], s[26:27]
K3_nf3:
    s_cmp_eq_u32 s28, 3
    s_cbranch_scc1 K3_dr1
    s_branch K3_bk3
K3_st4:
    s_cmp_eq_u32 s22, 1
    s_cbranch_scc0 K3_nl4
    v_lshlrev_b32 v25, 2, v0
    s_cmp_gt_u32 s47, 20
    s_cselect_b64 exec, -1, 1
    buffer_load_dwordx4 v[80:83], v25, s[8:11], s69 offen offset:2048
    s_cmp_gt_u32 s47, 22
    s_cselect_b64 exec, -1, 1
    buffer_load_dwordx4 v[84:87], v25, s[8:11], s69 offen offset:3072
    s_mov_b64 exec, -1
    s_waitcnt vmcnt(6)
K3_nl4:
    s_bitcmp1_b64 s[32:33], 4
    s_cbranch_scc0 K3_nf4
    s_swappc_b64 s[30:31], s[26:27]
K3_nf4:
    s_cmp_eq_u32 s28, 4
    s_cbranch_scc1 K3_dr2
    s_branch K3_bk4
K3_st5:
    s_bitcmp1_b64 s[32:33], 5
    s_cbranch_scc0 K3_nf5
    s_swappc_b64 s[30:31], s[26:27]
K3_nf5:
    s_cmp_eq_u32 s28, 5
    s_cbranch_scc1 K3_dr0
    s_branch K3_bk5
K3_st6:
    s_bitcmp1_b64 s[32:33], 6
    s_cbranch_scc0 K3_nf6
    s_swappc_b64 s[30:31], s[26:27]
K3_nf6:
    s_cmp_eq_u32 s28, 6
    s_cbranch_scc1 K3_dr1
    s_branch K3_bk6
K3_st7:
    s_bitcmp1_b64 s[32:33], 7
    s_cbranch_scc0 K3_nf7
    s_swappc_b64 s[30:31], s[26:27]
K3_nf7:
    s_cmp_eq_u32 s28, 7
    s_cbranch_scc1 K3_dr2
    s_branch K3_bk7
K3_st8:
    s_cmp_eq_u32 s22, 1
    s_cbranch_scc0 K3_nl8
    v_lshlrev_b32 v25, 2, v0
    s_cmp_gt_u32 s47, 24
    s_cselect_b64 exec, -1, 1
    s_add_u32 s69, s69, 4096
    buffer_load_dwordx4 v[88:91], v25, s[8:11], s69 offen offset:0
    s_cmp_gt_u32 s47, 26
    s_cselect_b64 exec, -1, 1
    buffer_load_dwordx4 v[92:95], v25, s[8:11], s69 offen offset:1024
    s_mov_b64 exec, -1
    s_waitcnt vmcnt(6)
K3_nl8:
    s_bitcmp1_b64 s[32:33], 8
    s_cbranch_scc0 K3_nf8
    s_swappc_b64 s[30:31], s[26:27]
K3_nf8:
    s_cmp_eq_u32 s28, 8
    s_cbranch_scc1 K3_dr0
    s_branch K3_bk8
K3_st9:
    s_bitcmp1_b64 s[32:33], 9
    s_cbranch_scc0 K3_nf9
    s_swappc_b64 s[30:31], s[26:27]
K3_nf9:
    s_cmp_eq_u32 s28, 9
    s_cbranch_scc1 K3_dr1
    s_branch K3_bk9
K3_st10:
    s_bitcmp1_b64 s[32:33], 10
    s_cbranch_scc0 K3_nf10
    s_swappc_b64 s[30:31], s[26:27]
K3_nf10:
    s_cmp_eq_u32 s28, 10
    s_cbranch_scc1 K3_dr2
    s_branch K3_bk10
K3_st11:
    s_bitcmp1_b64 s[32:33], 11
    s_cbranch_scc0 K3_nf11
    s_swappc_b64 s[30:31], s[26:27]
K3_nf11:
    s_cmp_eq_u32 s28, 11
    s_cbranch_scc1 K3_dr0
    s_branch K3_bk11
K3_st12:
    s_cmp_eq_u32 s22, 1
    s_cbranch_scc0 K3_nl12
    v_lshlrev_b32 v25, 2, v0
    s_cmp_gt_u32 s47, 28
    s_cselect_b64 exec, -1, 1
    buffer_load_dwordx4 v[96:99], v25, s[8:11], s69 offen offset:2048
    s_cmp_gt_u32 s47, 30
    s_cselect_b64 exec, -1, 1
    buffer_load_dwordx4 v[100:103], v25, s[8:11], s69 offen offset:3072
    s_mov_b64 exec, -1
    s_waitcnt vmcnt(6)
K3_nl12:
    s_bitcmp1_b64 s[32:33], 12
    s_cbranch_scc0 K3_nf12
    s_swappc_b64 s[30:31], s[26:27]
K3_nf12:
    s_cmp_eq_u32 s28, 12
    s_cbranch_scc1 K3_dr1
    s_branch K3_bk12
K3_st13:
    s_bitcmp1_b64 s[32:33], 13
    s_cbranch_scc0 K3_nf13
    s_swappc_b64 s[30:31], s[26:27]
K3_nf13:
    s_cmp_eq_u32 s28, 13
    s_cbranch_scc1 K3_dr2
    s_branch K3_bk13
K3_st14:
    s_bitcmp1_b64 s[32:33], 14
    s_cbranch_scc0 K3_nf14
    s_swappc_b64 s[30:31], s[26:27]
K3_nf14:
    s_cmp_eq_u32 s28, 14
    s_cbranch_scc1 K3_dr0
    s_branch K3_bk14
K3_st15:
    s_bitcmp1_b64 s[32:33], 15
    s_cbranch_scc0 K3_nf15
    s_swappc_b64 s[30:31], s[26:27]
K3_nf15:
    s_cmp_eq_u32 s28, 15
    s_cbranch_scc1 K3_dr1
    s_branch K3_bk15
K3_st16:
    s_cmp_eq_u32 s22, 1
    s_cbranch_scc0 K3_nl16
    v_lshlrev_b32 v25, 2, v0
    s_cmp_gt_u32 s47, 32
    s_cselect_b64 exec, -1, 1
    s_add_u32 s69, s69, 4096
    buffer_load_dwordx4 v[104:107], v25, s[8:11], s69 offen offset:0
    s_cmp_gt_u32 s47, 34
    s_cselect_b64 exec, -1, 1
    buffer_load_dwordx4 v[108:111], v25, s[8:11], s69 offen offset:1024
    s_mov_b64 exec, -1
    s_waitcnt vmcnt(6)
K3_nl16:
    s_bitcmp1_b64 s[32:33], 16
    s_cbranch_scc0 K3_nf16
    s_swappc_b64 s[30:31], s[26:27]
K3_nf16:
    s_cmp_eq_u32 s28, 16
    s_cbranch_scc1 K3_dr2
    s_branch K3_bk16
K3_st17:
    s_bitcmp1_b64 s[32:33], 17
    s_cbranch_scc0 K3_nf17
    s_swappc_b64 s[30:31], s[26:27]
K3_nf17:
    s_cmp_eq_u32 s28, 17
    s_cbranch_scc1 K3_dr0
    s_branch K3_bk17
K3_st18:
    s_bitcmp1_b64 s[32:33], 18
    s_cbranch_scc0 K3_nf18
    s_swappc_b64 s[30:31], s[26:27]
K3_nf18:
    s_cmp_eq_u32 s28, 18
    s_cbranch_scc1 K3_dr1
    s_branch K3_bk18
K3_st19:
    s_bitcmp1_b64 s[32:33], 19
    s_cbranch_scc0 K3_nf19
    s_swappc_b64 s[30:31], s[26:27]
K3_nf19:
    s_cmp_eq_u32 s28, 19
    s_cbranch_scc1 K3_dr2
    s_branch K3_bk19
K3_st20:
    s_cmp_eq_u32 s22, 1
    s_cbranch_scc0 K3_nl20
    v_lshlrev_b32 v25, 2, v0
    s_cmp_gt_u32 s47, 36
    s_cselect_b64 exec, -1, 1
    buffer_load_dwordx4 v[112:115], v25, s[8:11], s69 offen offset:2048
    s_cmp_gt_u32 s47, 38
    s_cselect_b64 exec, -1, 1
    buffer_load_dwordx4 v[116:119], v25, s[8:11], s69 offen offset:3072
    s_mov_b64 exec, -1
    s_waitcnt vmcnt(6)
K3_nl20:
    s_bitcmp1_b64 s[32:33], 20
    s_cbranch_scc0 K3_nf20
    s_swappc_b64 s[30:31], s[26:27]
K3_nf20:
    s_cmp_eq_u32 s28, 20
    s_cbranch_scc1 K3_dr0
    s_branch K3_bk20
K3_st21:
    s_bitcmp1_b64 s[32:33], 21
    s_cbranch_scc0 K3_nf21
    s_swappc_b64 s[30:31], s[26:27]
K3_nf21:
    s_cmp_eq_u32 s28, 21
    s_cbranch_scc1 K3_dr1
    s_branch K3_bk21
K3_st22:
    s_bitcmp1_b64 s[32:33], 22
    s_cbranch_scc0 K3_nf22
    s_swappc_b64 s[30:31], s[26:27]
K3_nf22:
    s_cmp_eq_u32 s28, 22
    s_cbranch_scc1 K3_dr2
    s_branch K3_bk22
K3_st23:
    s_bitcmp1_b64 s[32:33], 23
    s_cbranch_scc0 K3_nf23
    s_swappc_b64 s[30:31], s[26:27]
K3_nf23:
    s_cmp_eq_u32 s28, 23
    s_cbranch_scc1 K3_dr0
    s_branch K3_bk23
K3_st24:
    s_cmp_eq_u32 s22, 1
    s_cbranch_scc0 K3_nl24
    v_lshlrev_b32 v25, 2, v0
    s_cmp_gt_u32 s47, 40
    s_cselect_b64 exec, -1, 1
    s_add_u32 s69, s69, 4096
    buffer_load_dwordx4 v[120:123], v25, s[8:11], s69 offen offset:0
    s_cmp_gt_u32 s47, 42
    s_cselect_b64 exec, -1, 1
    buffer_load_dwordx4 v[124:127], v25, s[8:11], s69 offen offset:1024
    s_mov_b64 exec, -1
    s_waitcnt vmcnt(6)
K3_nl24:
    s_bitcmp1_b64 s[32:33], 24
    s_cbranch_scc0 K3_nf24
    s_swappc_b64 s[30:31], s[26:27]
K3_nf24:
    s_cmp_eq_u32 s28, 24
    s_cbranch_scc1 K3_dr1
    s_branch K3_bk24
K3_st25:
    s_bitcmp1_b64 s[32:33], 25
    s_cbranch_scc0 K3_nf25
    s_swappc_b64 s[30:31], s[26:27]
K3_nf25:
    s_cmp_eq_u32 s28, 25
    s_cbranch_scc1 K3_dr2
    s_branch K3_bk25
K3_st26:
    s_bitcmp1_b64 s[32:33], 26
    s_cbranch_scc0 K3_nf26
    s_swappc_b64 s[30:31], s[26:27]
K3_nf26:
    s_cmp_eq_u32 s28, 26
    s_cbranch_scc1 K3_dr0
    s_branch K3_bk26
K3_st27:
    s_bitcmp1_b64 s[32:33], 27
    s_cbranch_scc0 K3_nf27
    s_swappc_b64 s[30:31], s[26:27]
K3_nf27:
    s_cmp_eq_u32 s28, 27
    s_cbranch_scc1 K3_dr1
    s_branch K3_bk27
K3_st28:
    s_cmp_eq_u32 s22, 1
    s_cbranch_scc0 K3_nl28
    s_mov_b64 exec, -1
    s_waitcnt vmcnt(4)
K3_nl28:
    s_bitcmp1_b64 s[32:33], 28
    s_cbranch_scc0 K3_nf28
    s_swappc_b64 s[30:31], s[26:27]
K3_nf28:
    s_cmp_eq_u32 s28, 28
    s_cbranch_scc1 K3_dr2
    s_branch K3_bk28
K3_st29:
    s_bitcmp1_b64 s[32:33], 29
    s_cbranch_scc0 K3_nf29
    s_swappc_b64 s[30:31], s[26:27]
K3_nf29:
    s_cmp_eq_u32 s28, 29
    s_cbranch_scc1 K3_dr0
    s_branch K3_bk29
K3_st30:
    s_bitcmp1_b64 s[32:33], 30
    s_cbranch_scc0 K3_nf30
    s_swappc_b64 s[30:31], s[26:27]
K3_nf30:
    s_cmp_eq_u32 s28, 30
    s_cbranch_scc1 K3_dr1
    s_branch K3_bk30
K3_st31:
    s_bitcmp1_b64 s[32:33], 31
    s_cbranch_scc0 K3_nf31
    s_swappc_b64 s[30:31], s[26:27]
K3_nf31:
    s_cmp_eq_u32 s28, 31
    s_cbranch_scc1 K3_dr2
    s_branch K3_bk31
K3_st32:
    s_cmp_eq_u32 s22, 1
    s_cbranch_scc0 K3_nl32
    s_mov_b64 exec, -1
    s_waitcnt vmcnt(2)
K3_nl32:
    s_bitcmp1_b64 s[32:33], 32
    s_cbranch_scc0 K3_nf32
    s_swappc_b64 s[30:31], s[26:27]
K3_nf32:
    s_cmp_eq_u32 s28, 32
    s_cbranch_scc1 K3_dr0
    s_branch K3_bk32
K3_st33:
    s_bitcmp1_b64 s[32:33], 33
    s_cbranch_scc0 K3_nf33
    s_swappc_b64 s[30:31], s[26:27]
K3_nf33:
    s_cmp_eq_u32 s28, 33
    s_cbranch_scc1 K3_dr1
    s_branch K3_bk33
K3_st34:
    s_bitcmp1_b64 s[32:33], 34
    s_cbranch_scc0 K3_nf34
    s_swappc_b64 s[30:31], s[26:27]
K3_nf34:
    s_cmp_eq_u32 s28, 34
    s_cbranch_scc1 K3_dr2
    s_branch K3_bk34
K3_st35:
    s_bitcmp1_b64 s[32:33], 35
    s_cbranch_scc0 K3_nf35
    s_swappc_b64 s[30:31], s[26:27]
K3_nf35:
    s_cmp_eq_u32 s28, 35
    s_cbranch_scc1 K3_dr0
    s_branch K3_bk35
K3_st36:
    s_cmp_eq_u32 s22, 1
    s_cbranch_scc0 K3_nl36
    s_mov_b64 exec, -1
    s_waitcnt vmcnt(0)
K3_nl36:
    s_bitcmp1_b64 s[32:33], 36
    s_cbranch_scc0 K3_nf36
    s_swappc_b64 s[30:31], s[26:27]
K3_nf36:
    s_cmp_eq_u32 s28, 36
    s_cbranch_scc1 K3_dr1
    s_branch K3_bk36
K3_st37:
    s_bitcmp1_b64 s[32:33], 37
    s_cbranch_scc0 K3_nf37
    s_swappc_b64 s[30:31], s[26:27]
K3_nf37:
    s_cmp_eq_u32 s28, 37
    s_cbranch_scc1 K3_dr2
    s_branch K3_bk37
K3_st38:
    s_bitcmp1_b64 s[32:33], 38
    s_cbranch_scc0 K3_nf38
    s_swappc_b64 s[30:31], s[26:27]
K3_nf38:
    s_cmp_eq_u32 s28, 38
    s_cbranch_scc1 K3_dr0
    s_branch K3_bk38
K3_st39:
    s_bitcmp1_b64 s[32:33], 39
    s_cbranch_scc0 K3_nf39
    s_swappc_b64 s[30:31], s[26:27]
K3_nf39:
    s_cmp_eq_u32 s28, 39
    s_cbranch_scc1 K3_dr1
    s_branch K3_bk39
K3_st40:
    s_cmp_eq_u32 s22, 1
    s_cbranch_scc0 K3_nl40
    s_mov_b64 exec, -1
    s_waitcnt vmcnt(0)
K3_nl40:
    s_bitcmp1_b64 s[32:33], 40
    s_cbranch_scc0 K3_nf40
    s_swappc_b64 s[30:31], s[26:27]
K3_nf40:
    s_cmp_eq_u32 s28, 40
    s_cbranch_scc1 K3_dr2
    s_branch K3_bk40
K3_st41:
    s_bitcmp1_b64 s[32:33], 41
    s_cbranch_scc0 K3_nf41
    s_swappc_b64 s[30:31], s[26:27]
K3_nf41:
    s_cmp_eq_u32 s28, 41
    s_cbranch_scc1 K3_dr0
    s_branch K3_bk41
K3_dr0:
    s_waitcnt lgkmcnt(4)
    v_mfma_f32_4x4x4_16b_bf16 v[2:5], v[6:7], v[12:13], v[2:5]
    s_nop 1
    v_mfma_f32_4x4x4_16b_bf16 v[2:5], v[6:7], v[14:15], v[2:5]
    s_bitcmp1_b32 s34, 0
    s_cbranch_scc0 K3_dn0_0
    s_swappc_b64 s[30:31], s[26:27]
K3_dn0_0:
    s_waitcnt lgkmcnt(0)
    v_mfma_f32_4x4x4_16b_bf16 v[2:5], v[6:7], v[16:17], v[2:5]
    s_nop 1
    v_mfma_f32_4x4x4_16b_bf16 v[2:5], v[6:7], v[18:19], v[2:5]
    s_swappc_b64 s[30:31], s[26:27]
    s_branch K3_hend
K3_dr1:
    s_waitcnt lgkmcnt(4)
    v_mfma_f32_4x4x4_16b_bf16 v[2:5], v[6:7], v[16:17], v[2:5]
    s_nop 1
    v_mfma_f32_4x4x4_16b_bf16 v[2:5], v[6:7], v[18:19], v[2:5]
    s_bitcmp1_b32 s34, 0
    s_cbranch_scc0 K3_dn1_0
    s_swappc_b64 s[30:31], s[26:27]
K3_dn1_0:
    s_waitcnt lgkmcnt(0)
    v_mfma_f32_4x4x4_16b_bf16 v[2:5], v[6:7], v[20:21], v[2:5]
    s_nop 1
    v_mfma_f32_4x4x4_16b_bf16 v[2:5], v[6:7], v[22:23], v[2:5]
    s_swappc_b64 s[30:31], s[26:27]
    s_branch K3_hend
K3_dr2:
    s_waitcnt lgkmcnt(4)
    v_mfma_f32_4x4x4_16b_bf16 v[2:5], v[6:7], v[20:21], v[2:5]
    s_nop 1
    v_mfma_f32_4x4x4_16b_bf16 v[2:5], v[6:7], v[22:23], v[2:5]
    s_bitcmp1_b32 s34, 0
    s_cbranch_scc0 K3_dn2_0
    s_swappc_b64 s[30:31], s[26:27]
K3_dn2_0:
    s_waitcnt lgkmcnt(0)
    v_mfma_f32_4x4x4_16b_bf16 v[2:5], v[6:7], v[12:13], v[2:5]
    s_nop 1
    v_mfma_f32_4x4x4_16b_bf16 v[2:5], v[6:7], v[14:15], v[2:5]
    s_swappc_b64 s[30:31], s[26:27]
    s_branch K3_hend
    .p2align 7
K3_fl0_0:
    s_add_u32 s26, s26, 128
    s_addc_u32 s27, s27, 0
    s_nop 1
    v_mul_f32 v24, v33, v2
    v_mul_f32 v25, v33, v3
    v_mov_b64 v[2:3], 0
    v_cvt_pk_bf16_f32 v26, v24, v25
    s_setpc_b64 s[30:31]
    .if (. - K3_fl0_0) > 128
    .error "flush too long"
    .endif
    .p2align 7
K3_fl0_1:
    s_add_u32 s26, s26, 128
    s_addc_u32 s27, s27, 0
    v_lshrrev_b32 v24, 6, v0
    v_mul_u32_u24 v24, 65664, v24
    v_and_b32 v25, 60, v0
    v_lshl_add_u32 v24, v25, 1, v24
    s_add_u32 s38, s38, 525312
    buffer_store_dwordx2 v[30:31], v24, s[8:11], s38 offen sc1
    v_mul_f32 v24, v34, v2
    v_mul_f32 v25, v34, v3
    v_mov_b64 v[2:3], 0
    v_cvt_pk_bf16_f32 v27, v24, v25
    s_setpc_b64 s[30:31]
    .if (. - K3_fl0_1) > 128
    .error "flush too long"
    .endif
    .p2align 7
K3_fl0_2:
    s_add_u32 s26, s26, 128
    s_addc_u32 s27, s27, 0
    s_cmp_eq_u32 s21, 7
    s_cbranch_scc0 K3_t_2
    v_lshrrev_b32 v24, 7, v0
    v_mul_u32_u24 v24, 65664, v24
    v_and_b32 v25, 124, v0
    v_add_u32 v24, v24, v25
    s_add_u32 s38, s38, 262656
    buffer_store_dword v32, v24, s[8:11], s38 offen sc1
K3_t_2:
    v_mul_f32 v24, v35, v2
    v_mul_f32 v25, v35, v3
    v_mov_b64 v[2:3], 0
    v_cvt_pk_bf16_f32 v28, v24, v25
    s_setpc_b64 s[30:31]
    .if (. - K3_fl0_2) > 128
    .error "flush too long"
    .endif
    .p2align 7
K3_fl0_3:
    s_add_u32 s26, s26, 128
    s_addc_u32 s27, s27, 0
    s_nop 1
    v_mul_f32 v24, v36, v2
    v_mul_f32 v25, v36, v3
    v_mov_b64 v[2:3], 0
    v_cvt_pk_bf16_f32 v29, v24, v25
    v_lshlrev_b32 v24, 2, v0
    buffer_store_dwordx4 v[26:29], v24, s[8:11], s37 offen
    s_setpc_b64 s[30:31]
    .if (. - K3_fl0_3) > 128
    .error "flush too long"
    .endif
    .p2align 7
K3_fl0_4:
    s_add_u32 s26, s26, 128
    s_addc_u32 s27, s27, 0
    s_nop 1
    v_mul_f32 v24, v37, v2
    v_mul_f32 v25, v37, v3
    v_mov_b64 v[2:3], 0
    v_cvt_pk_bf16_f32 v30, v24, v25
    s_setpc_b64 s[30:31]
    .if (. - K3_fl0_4) > 128
    .error "flush too long"
    .endif
    .p2align 7
K3_fl0_5:
    s_add_u32 s26, s26, 128
    s_addc_u32 s27, s27, 0
    s_nop 1
    v_mul_f32 v24, v38, v2
    v_mul_f32 v25, v38, v3
    v_mov_b64 v[2:3], 0
    v_cvt_pk_bf16_f32 v31, v24, v25
    v_lshlrev_b32 v24, 1, v0
    buffer_store_dwordx2 v[30:31], v24, s[8:11], s37 offen offset:1024
    s_setpc_b64 s[30:31]
    .if (. - K3_fl0_5) > 128
    .error "flush too long"
    .endif
    .p2align 7
K3_fl0_6:
    s_add_u32 s26, s26, 128
    s_addc_u32 s27, s27, 0
    s_nop 1
    v_mul_f32 v24, v39, v2
    v_mul_f32 v25, v39, v3
    v_mov_b64 v[2:3], 0
    v_cvt_pk_bf16_f32 v32, v24, v25
    buffer_store_dword v32, v0, s[8:11], s37 offen offset:1536
    s_setpc_b64 s[30:31]
    .if (. - K3_fl0_6) > 128
    .error "flush too long"
    .endif
    .p2align 7
K3_fl1_0:
    s_add_u32 s26, s26, 128
    s_addc_u32 s27, s27, 0
    s_nop 1
    v_mul_f32 v24, v33, v2
    v_mul_f32 v25, v33, v3
    v_mov_b64 v[2:3], 0
    v_cvt_pk_bf16_f32 v26, v24, v25
    s_setpc_b64 s[30:31]
    .if (. - K3_fl1_0) > 128
    .error "flush too long"
    .endif
    .p2align 7
K3_fl1_1:
    s_add_u32 s26, s26, 128
    s_addc_u32 s27, s27, 0
    v_lshrrev_b32 v24, 6, v0
    v_mul_u32_u24 v24, 65664, v24
    v_and_b32 v25, 60, v0
    v_lshl_add_u32 v24, v25, 1, v24
    s_add_u32 s38, s38, 525312
    buffer_store_dwordx2 v[30:31], v24, s[8:11], s38 offen sc1
    v_mul_f32 v24, v34, v2
    v_mul_f32 v25, v34, v3
    v_mov_b64 v[2:3], 0
    v_cvt_pk_bf16_f32 v27, v24, v25
    s_setpc_b64 s[30:31]
    .if (. - K3_fl1_1) > 128
    .error "flush too long"
    .endif
    .p2align 7
K3_fl1_2:
    s_add_u32 s26, s26, 128
    s_addc_u32 s27, s27, 0
    s_cmp_eq_u32 s21, 7
    s_cbranch_scc0 K3_t_3
    v_lshrrev_b32 v24, 7, v0
    v_mul_u32_u24 v24, 65664, v24
    v_and_b32 v25, 124, v0
    v_add_u32 v24, v24, v25
    s_add_u32 s38, s38, 262656
    buffer_store_dword v32, v24, s[8:11], s38 offen sc1
K3_t_3:
    v_mul_f32 v24, v35, v2
    v_mul_f32 v25, v35, v3
    v_mov_b64 v[2:3], 0
    v_cvt_pk_bf16_f32 v28, v24, v25
    s_setpc_b64 s[30:31]
    .if (. - K3_fl1_2) > 128
    .error "flush too long"
    .endif
    .p2align 7
K3_fl1_3:
    s_add_u32 s26, s26, 128
    s_addc_u32 s27, s27, 0
    s_nop 1
    v_mul_f32 v24, v36, v2
    v_mul_f32 v25, v36, v3
    v_mov_b64 v[2:3], 0
    v_cvt_pk_bf16_f32 v29, v24, v25
    v_lshlrev_b32 v24, 2, v0
    buffer_store_dwordx4 v[26:29], v24, s[8:11], s37 offen sc1
    s_setpc_b64 s[30:31]
    .if (. - K3_fl1_3) > 128
    .error "flush too long"
    .endif
    .p2align 7
K3_fl1_4:
    s_add_u32 s26, s26, 128
    s_addc_u32 s27, s27, 0
    s_nop 1
    v_mul_f32 v24, v37, v2
    v_mul_f32 v25, v37, v3
    v_mov_b64 v[2:3], 0
    v_cvt_pk_bf16_f32 v30, v24, v25
    s_setpc_b64 s[30:31]
    .if (. - K3_fl1_4) > 128
    .error "flush too long"
    .endif
    .p2align 7
K3_fl1_5:
    s_add_u32 s26, s26, 128
    s_addc_u32 s27, s27, 0
    s_nop 1
    v_mul_f32 v24, v38, v2
    v_mul_f32 v25, v38, v3
    v_mov_b64 v[2:3], 0
    v_cvt_pk_bf16_f32 v31, v24, v25
    v_lshlrev_b32 v24, 1, v0
    buffer_store_dwordx2 v[30:31], v24, s[8:11], s37 offen offset:1024 sc1
    s_setpc_b64 s[30:31]
    .if (. - K3_fl1_5) > 128
    .error "flush too long"
    .endif
    .p2align 7
K3_fl1_6:
    s_add_u32 s26, s26, 128
    s_addc_u32 s27, s27, 0
    s_nop 1
    v_mul_f32 v24, v39, v2
    v_mul_f32 v25, v39, v3
    v_mov_b64 v[2:3], 0
    v_cvt_pk_bf16_f32 v32, v24, v25
    buffer_store_dword v32, v0, s[8:11], s37 offen offset:1536 sc1
    s_setpc_b64 s[30:31]
    .if (. - K3_fl1_6) > 128
    .error "flush too long"
    .endif
    .p2align 7
K3_fl2_0:
    s_add_u32 s26, s26, 128
    s_addc_u32 s27, s27, 0
    s_nop 1
    v_mul_f32 v24, v33, v2
    v_mul_f32 v25, v33, v3
    v_mov_b64 v[2:3], 0
    v_cvt_pk_bf16_f32 v26, v24, v25
    s_setpc_b64 s[30:31]
    .if (. - K3_fl2_0) > 128
    .error "flush too long"
    .endif
    .p2align 7
K3_fl2_1:
    s_add_u32 s26, s26, 128
    s_addc_u32 s27, s27, 0
    v_lshrrev_b32 v24, 6, v0
    v_mul_u32_u24 v24, 65664, v24
    v_and_b32 v25, 60, v0
    v_lshl_add_u32 v24, v25, 1, v24
    s_add_u32 s38, s38, 525312
    buffer_store_dwordx2 v[30:31], v24, s[8:11], s38 offen sc1
    s_cmp_lg_u32 s19, 0
    s_cbranch_scc1 K3_nwb
    s_cmp_ge_u32 s2, 8
    s_cbranch_scc1 K3_nwb
    buffer_wbl2 sc1
K3_nwb:
    v_mul_f32 v24, v34, v2
    v_mul_f32 v25, v34, v3
    v_mov_b64 v[2:3], 0
    v_cvt_pk_bf16_f32 v27, v24, v25
    s_setpc_b64 s[30:31]
    .if (. - K3_fl2_1) > 128
    .error "flush too long"
    .endif
    .p2align 7
K3_fl2_2:
    s_add_u32 s26, s26, 128
    s_addc_u32 s27, s27, 0
    s_cmp_eq_u32 s21, 7
    s_cbranch_scc0 K3_t_4
    v_lshrrev_b32 v24, 7, v0
    v_mul_u32_u24 v24, 65664, v24
    v_and_b32 v25, 124, v0
    v_add_u32 v24, v24, v25
    s_add_u32 s38, s38, 262656
    buffer_store_dword v32, v24, s[8:11], s38 offen sc1
K3_t_4:
    v_mul_f32 v24, v35, v2
    v_mul_f32 v25, v35, v3
    v_mov_b64 v[2:3], 0
    v_cvt_pk_bf16_f32 v28, v24, v25
    s_setpc_b64 s[30:31]
    .if (. - K3_fl2_2) > 128
    .error "flush too long"
    .endif
    .p2align 7
K3_fl2_3:
    s_add_u32 s26, s26, 128
    s_addc_u32 s27, s27, 0
    s_nop 1
    v_mul_f32 v24, v36, v2
    v_mul_f32 v25, v36, v3
    v_mov_b64 v[2:3], 0
    v_cvt_pk_bf16_f32 v29, v24, v25
    s_setpc_b64 s[30:31]
    .if (. - K3_fl2_3) > 128
    .error "flush too long"
    .endif
    .p2align 7
K3_fl2_4:
    s_add_u32 s26, s26, 128
    s_addc_u32 s27, s27, 0
    s_nop 1
    v_mul_f32 v24, v37, v2
    v_mul_f32 v25, v37, v3
    v_mov_b64 v[2:3], 0
    v_cvt_pk_bf16_f32 v30, v24, v25
    s_setpc_b64 s[30:31]
    .if (. - K3_fl2_4) > 128
    .error "flush too long"
    .endif
    .p2align 7
K3_fl2_5:
    s_add_u32 s26, s26, 128
    s_addc_u32 s27, s27, 0
    s_nop 1
    v_mul_f32 v24, v38, v2
    v_mul_f32 v25, v38, v3
    v_mov_b64 v[2:3], 0
    v_cvt_pk_bf16_f32 v31, v24, v25
    s_setpc_b64 s[30:31]
    .if (. - K3_fl2_5) > 128
    .error "flush too long"
    .endif
    .p2align 7
K3_fl2_6:
    s_add_u32 s26, s26, 128
    s_addc_u32 s27, s27, 0
    s_nop 1
    v_mul_f32 v24, v39, v2
    v_mul_f32 v25, v39, v3
    v_mov_b64 v[2:3], 0
    v_cvt_pk_bf16_f32 v32, v24, v25
    s_setpc_b64 s[30:31]
    .if (. - K3_fl2_6) > 128
    .error "flush too long"
    .endif
K3_slow:
    s_load_dwordx4 s[72:75], s[0:1], 8
    s_sub_u32 s38, s61, 8192
    buffer_store_dwordx4 v[26:29], v1, s[8:11], s38 offen sc1
    s_lshl_b32 s52, s20, 9
    s_add_u32 s52, s52, 0
    v_lshl_add_u32 v8, v0, 1, s52
    v_mov_b32 v10, 0
    v_mov_b32 v11, 0
    ds_write_b64 v8, v[10:11] offset:0
    ds_write_b64 v8, v[10:11] offset:512
    ds_write_b64 v8, v[10:11] offset:1024
    ds_write_b64 v8, v[10:11] offset:1536
    ds_write_b64 v8, v[10:11] offset:2048
    ds_write_b64 v8, v[10:11] offset:2560
    s_cmp_eq_u32 s21, 7
    s_cbranch_scc0 K3_s6
    ds_write_b64 v8, v[10:11] offset:3072
K3_s6:
    s_waitcnt lgkmcnt(0)
    s_mov_b32 s76, s72
    s_and_b32 s77, s73, 0xffff
    s_mov_b32 s78, 1600000
    s_mov_b32 s79, 0x20000
    s_mov_b32 s80, s74
    s_and_b32 s81, s75, 0xffff
    s_mov_b32 s82, 1600000
    s_mov_b32 s83, 0x20000
    s_barrier
    s_lshl_b32 s52, s19, 8
    s_mul_i32 s53, s16, 6272
    s_mov_b32 s54, 65536
K3_sl:
    buffer_load_dword v12, v0, s[76:79], s52 offen
    buffer_load_dword v13, v0, s[80:83], s52 offen
    v_add_u32 v14, s52, v0
    s_waitcnt vmcnt(0)
    v_lshlrev_b32 v12, 1, v12
    v_lshlrev_b32 v13, 1, v13
    buffer_load_ushort v12, v12, s[8:11], s54 offen
    buffer_load_ushort v13, v13, s[8:11], s54 offen
    s_waitcnt vmcnt(0)
    v_lshlrev_b32 v12, 2, v12
    ds_read_b32 v12, v12 offset:50240
    v_subrev_u32 v13, s53, v13
    v_cmp_gt_u32 vcc, 1600000, v14
    s_mov_b64 exec, vcc
    v_cmp_gt_u32 vcc, 6272, v13
    s_mov_b64 exec, vcc
    v_lshlrev_b32 v13, 3, v13
    v_add_u32 v13, 0, v13
    s_waitcnt lgkmcnt(0)
    v_lshlrev_b32 v15, 16, v12
    v_and_b32 v12, 0xffff0000, v12
    ds_add_f32 v13, v15
    ds_add_f32 v13, v12 offset:4
    s_mov_b64 exec, -1
    s_add_u32 s52, s52, 4096
    s_cmp_lt_u32 s52, 1600000
    s_cbranch_scc1 K3_sl
    s_waitcnt lgkmcnt(0)
    s_barrier
    ds_read_b64 v[2:3], v8 offset:0
    s_waitcnt lgkmcnt(0)
    s_swappc_b64 s[30:31], s[26:27]
    ds_read_b64 v[2:3], v8 offset:512
    s_waitcnt lgkmcnt(0)
    s_swappc_b64 s[30:31], s[26:27]
    ds_read_b64 v[2:3], v8 offset:1024
    s_waitcnt lgkmcnt(0)
    s_swappc_b64 s[30:31], s[26:27]
    ds_read_b64 v[2:3], v8 offset:1536
    s_waitcnt lgkmcnt(0)
    s_swappc_b64 s[30:31], s[26:27]
    ds_read_b64 v[2:3], v8 offset:2048
    s_waitcnt lgkmcnt(0)
    s_swappc_b64 s[30:31], s[26:27]
    ds_read_b64 v[2:3], v8 offset:2560
    s_waitcnt lgkmcnt(0)
    s_swappc_b64 s[30:31], s[26:27]
    s_cmp_eq_u32 s21, 7
    s_cbranch_scc0 K3_hend
    ds_read_b64 v[2:3], v8 offset:3072
    s_waitcnt lgkmcnt(0)
    s_swappc_b64 s[30:31], s[26:27]
K3_hend:
    s_mov_b64 s[24:25], s[88:89]
    s_cmp_eq_u32 s22, 7
    s_cbranch_scc1 K3_fin
    s_setprio 0
    v_mov_b32 v24, s22
    v_mov_b32 v25, 1
    v_mov_b32 v2, 150592
    s_mov_b64 exec, 1
    ds_add_u32 v2, v25
    s_waitcnt vmcnt(0)
    s_cmp_eq_u32 s23, 0
    s_cbranch_scc0 K3_g1
    buffer_store_dword v24, v0, s[8:11], s58 offen
    s_branch K3_g2
K3_g1:
    buffer_store_dword v24, v0, s[8:11], s58 offen sc1
K3_g2:
    s_mov_b64 exec, 15
K3_poll:
    s_add_u32 s64, s64, 1
    s_cmp_gt_u32 s64, 16777216
    s_cbranch_scc1 K3_pb
    buffer_load_dword v12, v0, s[8:11], s65 offen sc1
    s_waitcnt vmcnt(0)
    v_cmp_gt_u32 vcc, s22, v12
    s_cbranch_vccz K3_pb
    s_sleep 2
    s_branch K3_poll
K3_pb:
K3_px:
    s_mov_b64 exec, -1
    v_lshlrev_b32 v24, 1, v0
    s_add_u32 s53, s66, s39
    s_add_u32 s54, s67, s39
    s_add_u32 s55, s68, s39
K3_pA:
    v_lshlrev_b32 v7, 2, v0
    buffer_load_dwordx4 v[14:17], v7, s[8:11], s53 offen sc1 nt
    buffer_load_dwordx4 v[18:21], v7, s[8:11], s54 offen sc1 nt
    buffer_load_dwordx4 v[2:5], v7, s[8:11], s55 offen sc1 nt
K3_pB:
    buffer_load_dwordx2 v[8:9], v24, s[8:11], s53 offen offset:1024 sc1 nt
    buffer_load_dwordx2 v[10:11], v24, s[8:11], s54 offen offset:1024 sc1 nt
    buffer_load_dwordx2 v[12:13], v24, s[8:11], s55 offen offset:1024 sc1 nt
    s_cmp_eq_u32 s21, 7
    s_cbranch_scc0 K3_p6
    buffer_load_dword v22, v0, s[8:11], s53 offen offset:1536 sc1 nt
    buffer_load_dword v23, v0, s[8:11], s54 offen offset:1536 sc1 nt
    buffer_load_dword v25, v0, s[8:11], s55 offen offset:1536 sc1 nt
K3_p6:
K3_pD:
    s_lshl_b32 s52, s22, 4
    v_mov_b32 v24, 150592
    s_mov_b64 exec, 1
K3_aw:
    ds_read_b32 v7, v24
    s_waitcnt lgkmcnt(0)
    v_readfirstlane_b32 s53, v7
    s_cmp_ge_u32 s53, s52
    s_cbranch_scc1 K3_ad
    s_add_u32 s64, s64, 1
    s_cmp_gt_u32 s64, 16777216
    s_cbranch_scc1 K3_ad
    s_sleep 2
    s_branch K3_aw
K3_ad:
    s_mov_b64 exec, -1
    s_mov_b32 m0, s60
    s_nop 0
    ds_write_addtid_b32 v26 offset:50240
    ds_write_addtid_b32 v27 offset:50496
    ds_write_addtid_b32 v28 offset:50752
    ds_write_addtid_b32 v29 offset:51008
    ds_write_addtid_b32 v30 offset:51264
    ds_write_addtid_b32 v31 offset:51520
    s_cmp_eq_u32 s21, 7
    s_cbranch_scc0 K3_w6
    ds_write_addtid_b32 v32 offset:51776
    s_waitcnt vmcnt(0)
    s_mov_b32 m0, s66
    s_nop 0
    ds_write_addtid_b32 v22 offset:51776
    s_mov_b32 m0, s67
    s_nop 0
    ds_write_addtid_b32 v23 offset:51776
    s_mov_b32 m0, s68
    s_nop 0
    ds_write_addtid_b32 v25 offset:51776
K3_w6:
    s_mov_b32 m0, s66
    s_waitcnt vmcnt(5)
    ds_write_addtid_b32 v14 offset:50240
    ds_write_addtid_b32 v15 offset:50496
    ds_write_addtid_b32 v16 offset:50752
    ds_write_addtid_b32 v17 offset:51008
    s_mov_b32 m0, s67
    s_waitcnt vmcnt(4)
    ds_write_addtid_b32 v18 offset:50240
    ds_write_addtid_b32 v19 offset:50496
    ds_write_addtid_b32 v20 offset:50752
    ds_write_addtid_b32 v21 offset:51008
    s_mov_b32 m0, s68
    s_waitcnt vmcnt(3)
    ds_write_addtid_b32 v2 offset:50240
    ds_write_addtid_b32 v3 offset:50496
    ds_write_addtid_b32 v4 offset:50752
    ds_write_addtid_b32 v5 offset:51008
    s_mov_b32 m0, s66
    s_waitcnt vmcnt(2)
    ds_write_addtid_b32 v8 offset:51264
    ds_write_addtid_b32 v9 offset:51520
    s_mov_b32 m0, s67
    s_waitcnt vmcnt(1)
    ds_write_addtid_b32 v10 offset:51264
    ds_write_addtid_b32 v11 offset:51520
    s_mov_b32 m0, s68
    s_waitcnt vmcnt(0)
    ds_write_addtid_b32 v12 offset:51264
    ds_write_addtid_b32 v13 offset:51520
    v_mov_b32 v7, v6
    v_mov_b32 v2, 0
    v_mov_b32 v3, 0
    v_mov_b32 v4, 0
    v_mov_b32 v5, 0
    s_add_u32 s22, s22, 1
    s_waitcnt vmcnt(0) lgkmcnt(0)
    s_barrier
    s_branch K3_hop
K3_fin:
    s_mov_b32 s38, s61
    buffer_store_dwordx4 v[26:29], v1, s[8:11], s38 offen sc1
    v_lshrrev_b32 v24, 6, v0
    v_mul_u32_u24 v24, 65664, v24
    v_and_b32 v25, 60, v0
    v_lshl_add_u32 v24, v25, 1, v24
    s_add_u32 s38, s38, 525312
    buffer_store_dwordx2 v[30:31], v24, s[8:11], s38 offen sc1
    s_cmp_eq_u32 s21, 7
    s_cbranch_scc0 K3_t_5
    v_lshrrev_b32 v24, 7, v0
    v_mul_u32_u24 v24, 65664, v24
    v_and_b32 v25, 124, v0
    v_add_u32 v24, v24, v25
    s_add_u32 s38, s38, 262656
    buffer_store_dword v32, v24, s[8:11], s38 offen sc1
K3_t_5:
K3_end:
    s_endpgm
.globl att_kernel
.p2align 8
.type att_kernel,@function
att_kernel:
    s_cmp_ge_u32 s2, 256
    s_cbranch_scc1 K4_end
    s_load_dwordx2 s[4:5], s[0:1], 88
    s_load_dwordx2 s[6:7], s[0:1], 72
    v_lshrrev_b32 v4, 6, v0
    v_and_b32 v0, 63, v0
    v_readfirstlane_b32 s19, v4
    v_lshlrev_b32 v2, 4, v0
    v_lshrrev_b32 v5, 3, v0
    v_and_b32 v6, 7, v0
    v_xor_b32 v6, v6, v5
    s_lshl_b32 s3, s19, 1
    v_xor_b32 v6, s3, v6
    v_lshlrev_b32 v6, 4, v6
    v_lshl_add_u32 v103, v5, 7, v6
    v_xor_b32 v12, 16, v103
    s_mul_i32 s20, s2, 3
    s_lshl_b32 s44, s19, 14
    v_lshrrev_b32 v5, 5, v0
    v_bfe_u32 v6, v0, 3, 1
    v_xor_b32 v6, v6, v5
    v_lshlrev_b32 v3, 3, v5
    v_lshl_add_u32 v102, v6, 2, v3
    v_add_u32 v102, 524288, v102
    s_waitcnt lgkmcnt(0)
    s_mov_b32 s8, s4
    s_and_b32 s9, s5, 0xffff
    s_mov_b32 s10, 268435456
    s_mov_b32 s11, 0x20000
    s_mov_b32 s12, s6
    s_and_b32 s13, s7, 0xffff
    s_mov_b32 s14, 6400000
    s_mov_b32 s15, 0x20000
    s_mov_b32 s3, 598016
    s_buffer_load_dword s24, s[8:11], s3
    s_add_u32 s60, s20, 0
    s_add_u32 s61, s20, 1
    s_add_u32 s62, s20, 2
    s_lshl_b32 s3, s60, 3
    s_add_u32 s3, s3, s19
    s_add_u32 s52, s3, 0
    s_lshl_b32 s3, s60, 3
    s_add_u32 s3, s3, s19
    s_add_u32 s53, s3, 4
    s_lshl_b32 s3, s61, 3
    s_add_u32 s3, s3, s19
    s_add_u32 s54, s3, 0
    s_lshl_b32 s3, s61, 3
    s_add_u32 s3, s3, s19
    s_add_u32 s55, s3, 4
    s_lshl_b32 s3, s62, 3
    s_add_u32 s3, s3, s19
    s_add_u32 s56, s3, 0
    s_lshl_b32 s3, s62, 3
    s_add_u32 s3, s3, s19
    s_add_u32 s57, s3, 4
    s_lshr_b32 s58, s2, 1
    s_add_u32 s58, s58, 6144
    s_lshr_b32 s63, s58, 3
    s_and_b32 s3, s2, 3
    s_cmp_eq_u32 s19, s3
    s_cselect_b32 s31, 1, 0
    s_xor_b32 s49, s58, s19
    s_and_b32 s49, s49, 7
    s_lshl_b32 s49, s49, 4
    s_and_b32 s59, s2, 1
    s_lshl_b32 s59, s59, 2
    s_or_b32 s49, s49, s59
    s_lshl_b32 s25, s19, 10
    s_add_u32 s26, s25, 524288
    s_add_u32 s25, s25, 0x10000
    s_add_u32 m0, s25, 0
    s_add_u32 s27, s26, 0
    buffer_load_dwordx4 v2, s[8:11], s27 offen lds
    s_add_u32 m0, s25, 4096
    s_add_u32 s27, s26, 4096
    buffer_load_dwordx4 v2, s[8:11], s27 offen lds
    s_mul_i32 s21, s60, 65664
    s_add_u32 s21, s21, s44
    s_add_u32 s21, s21, 65011712
    s_add_u32 m0, s44, 0
    s_nop 0
    buffer_load_dwordx4 v103, s[8:11], s21 offen offset:0 lds
    buffer_load_dwordx4 v103, s[8:11], s21 offen offset:1024 lds
    buffer_load_dwordx4 v103, s[8:11], s21 offen offset:2048 lds
    buffer_load_dwordx4 v103, s[8:11], s21 offen offset:3072 lds
    s_add_u32 s21, s21, 4096
    s_add_u32 m0, s44, 4096
    s_nop 0
    buffer_load_dwordx4 v103, s[8:11], s21 offen offset:0 lds
    buffer_load_dwordx4 v103, s[8:11], s21 offen offset:1024 lds
    buffer_load_dwordx4 v103, s[8:11], s21 offen offset:2048 lds
    buffer_load_dwordx4 v103, s[8:11], s21 offen offset:3072 lds
    s_add_u32 s21, s21, 4096
    s_add_u32 m0, s44, 8192
    s_nop 0
    buffer_load_dwordx4 v12, s[8:11], s21 offen offset:0 lds
    buffer_load_dwordx4 v12, s[8:11], s21 offen offset:1024 lds
    buffer_load_dwordx4 v12, s[8:11], s21 offen offset:2048 lds
    buffer_load_dwordx4 v12, s[8:11], s21 offen offset:3072 lds
    s_add_u32 s21, s21, 4096
    s_add_u32 m0, s44, 12288
    s_nop 0
    buffer_load_dwordx4 v12, s[8:11], s21 offen offset:0 lds
    buffer_load_dwordx4 v12, s[8:11], s21 offen offset:1024 lds
    buffer_load_dwordx4 v12, s[8:11], s21 offen offset:2048 lds
    buffer_load_dwordx4 v12, s[8:11], s21 offen offset:3072 lds
    s_lshl_b32 s23, s52, 4
    s_add_u32 s23, s23, 131072
    buffer_load_dword v100, v102, s[8:11], s23 offen
    buffer_load_dwordx2 v[252:253], v3, s[8:11], s23 offen
    s_add_u32 m0, s25, 65536
    s_add_u32 s27, s26, 65536
    buffer_load_dwordx4 v2, s[8:11], s27 offen lds
    s_add_u32 m0, s25, 8192
    s_add_u32 s27, s26, 8192
    buffer_load_dwordx4 v2, s[8:11], s27 offen lds
    s_add_u32 m0, s25, 12288
    s_add_u32 s27, s26, 12288
    buffer_load_dwordx4 v2, s[8:11], s27 offen lds
    s_add_u32 m0, s25, 16384
    s_add_u32 s27, s26, 16384
    buffer_load_dwordx4 v2, s[8:11], s27 offen lds
    s_add_u32 m0, s25, 20480
    s_add_u32 s27, s26, 20480
    buffer_load_dwordx4 v2, s[8:11], s27 offen lds
    s_add_u32 m0, s25, 24576
    s_add_u32 s27, s26, 24576
    buffer_load_dwordx4 v2, s[8:11], s27 offen lds
    s_add_u32 m0, s25, 28672
    s_add_u32 s27, s26, 28672
    buffer_load_dwordx4 v2, s[8:11], s27 offen lds
    v_and_b32 v4, 7, v0
    v_lshrrev_b32 v7, 4, v0
    v_xor_b32 v1, v4, v7
    v_xor_b32 v1, s19, v1
    v_lshlrev_b32 v1, 4, v1
    v_lshl_add_u32 v1, v4, 13, v1
    v_lshl_add_u32 v1, v7, 7, v1
    v_and_or_b32 v1, v0, 8, v1
    v_cmp_eq_u32 vcc, 0, v6
    v_subrev_u32 v238, 1, v6
    v_and_b32 v8, 1, v0
    v_lshlrev_b32 v8, 4, v8
    v_mov_b32 v9, 0x3f80
    v_lshlrev_b32 v9, v8, v9
    v_bfe_u32 v8, v0, 1, 1
    v_bfe_u32 v10, v0, 3, 1
    v_bfe_u32 v11, v0, 2, 1
    v_xor_b32 v13, 0, v10
    v_lshl_or_b32 v13, v13, 1, v8
    v_or_b32 v14, 0, v11
    v_cmp_eq_u32 s[40:41], v14, v7
    s_nop 1
    v_cndmask_b32 v14, 0, v9, s[40:41]
    v_cmp_eq_u32 s[40:41], 0, v13
    s_nop 1
    v_cndmask_b32 v88, 0, v14, s[40:41]
    v_cmp_eq_u32 s[40:41], 1, v13
    s_nop 1
    v_cndmask_b32 v89, 0, v14, s[40:41]
    v_cmp_eq_u32 s[40:41], 2, v13
    s_nop 1
    v_cndmask_b32 v90, 0, v14, s[40:41]
    v_cmp_eq_u32 s[40:41], 3, v13
    s_nop 1
    v_cndmask_b32 v91, 0, v14, s[40:41]
    v_xor_b32 v13, 1, v10
    v_lshl_or_b32 v13, v13, 1, v8
    v_or_b32 v14, 2, v11
    v_cmp_eq_u32 s[40:41], v14, v7
    s_nop 1
    v_cndmask_b32 v14, 0, v9, s[40:41]
    v_cmp_eq_u32 s[40:41], 0, v13
    s_nop 1
    v_cndmask_b32 v92, 0, v14, s[40:41]
    v_cmp_eq_u32 s[40:41], 1, v13
    s_nop 1
    v_cndmask_b32 v93, 0, v14, s[40:41]
    v_cmp_eq_u32 s[40:41], 2, v13
    s_nop 1
    v_cndmask_b32 v94, 0, v14, s[40:41]
    v_cmp_eq_u32 s[40:41], 3, v13
    s_nop 1
    v_cndmask_b32 v95, 0, v14, s[40:41]
    s_lshl_b32 s25, s19, 10
    s_add_u32 s25, s25, 139264
    v_lshl_add_u32 v9, v7, 4, s25
    v_lshl_add_u32 v8, v6, 6, v9
    v_lshl_add_u32 v4, v4, 2, s25
    v_lshl_add_u32 v4, v5, 5, v4
    v_lshl_add_u32 v4, v6, 6, v4
    v_and_b32 v11, 3, v0
    v_cmp_eq_u32 s[32:33], 1, v11
    v_cmp_eq_u32 s[34:35], 2, v11
    v_cmp_eq_u32 s[36:37], 3, v11
    v_bfe_u32 v11, v0, 2, 2
    v_cmp_eq_u32 s[38:39], v11, v7
    v_and_b32 v11, 3, v0
    v_cmp_eq_u32 s[40:41], v11, v7
    v_mov_b32 v13, 0x3f80
    s_nop 0
    v_cndmask_b32 v13, 0, v13, s[40:41]
    v_bfe_u32 v11, v0, 3, 1
    v_bfe_u32 v14, v0, 2, 1
    v_lshl_or_b32 v11, v14, 1, v11
    v_cmp_eq_u32 s[40:41], 0, v11
    s_nop 1
    v_cndmask_b32 v232, 0, v13, s[40:41]
    v_lshlrev_b32 v236, 16, v232
    v_cmp_eq_u32 s[40:41], 1, v11
    s_nop 1
    v_cndmask_b32 v233, 0, v13, s[40:41]
    v_lshlrev_b32 v237, 16, v233
    v_cmp_eq_u32 s[40:41], 2, v11
    s_nop 1
    v_cndmask_b32 v234, 0, v13, s[40:41]
    v_lshlrev_b32 v238, 16, v234
    v_cmp_eq_u32 s[40:41], 3, v11
    s_nop 1
    v_cndmask_b32 v235, 0, v13, s[40:41]
    v_lshlrev_b32 v239, 16, v235
    v_and_b32 v11, 1, v7
    v_and_b32 v13, 15, v0
    v_subrev_u32 v10, 1, v6
    v_lshlrev_b32 v7, 2, v13
    v_lshl_add_u32 v7, v11, 7, v7
    v_add_u32 v15, 131072, v2
    s_mov_b32 s48, 0xffff0000
    v_add_u32 v0, 0x10000, v2
    s_mov_b32 s28, 1006632960
    s_mov_b32 s29, 925353388
    s_mov_b32 s30, 1069066811
    s_waitcnt lgkmcnt(0)
    s_waitcnt vmcnt(9)
    s_barrier
    s_lshl_b32 s25, s19, 10
    s_add_u32 s25, s25, 0x10000
    s_add_u32 m0, s25, 32768
    s_add_u32 s27, s26, 32768
    buffer_load_dwordx4 v2, s[8:11], s27 offen lds
    s_add_u32 m0, s25, 36864
    s_add_u32 s27, s26, 36864
    v_xor_b32 v77, 576, v1
    v_xor_b32 v76, 0, v1
    ds_read2st64_b32 v[16:17], v76 offset0:0 offset1:4
    ds_read2st64_b32 v[18:19], v77 offset0:0 offset1:4
    ds_read_b128 a[0:3], v0 offset:0
    v_xor_b32 v79, 580, v1
    v_xor_b32 v78, 4, v1
    ds_read2st64_b32 v[32:33], v78 offset0:0 offset1:4
    ds_read2st64_b32 v[34:35], v79 offset0:0 offset1:4
    ds_read2st64_b32 v[20:21], v76 offset0:8 offset1:12
    ds_read2st64_b32 v[22:23], v77 offset0:8 offset1:12
    ds_read_b128 a[4:7], v0 offset:1024
    ds_read2st64_b32 v[36:37], v78 offset0:8 offset1:12
    ds_read2st64_b32 v[38:39], v79 offset0:8 offset1:12
    ds_read2st64_b32 v[24:25], v76 offset0:16 offset1:20
    ds_read2st64_b32 v[26:27], v77 offset0:16 offset1:20
    buffer_load_dwordx4 v2, s[8:11], s27 offen lds
    s_add_u32 m0, s25, 40960
    s_add_u32 s27, s26, 40960
    ds_read_b128 a[8:11], v0 offset:2048
    ds_read2st64_b32 v[40:41], v78 offset0:16 offset1:20
    ds_read2st64_b32 v[42:43], v79 offset0:16 offset1:20
    ds_read2st64_b32 v[28:29], v76 offset0:24 offset1:28
    ds_read2st64_b32 v[30:31], v77 offset0:24 offset1:28
    ds_read_b128 a[12:15], v0 offset:3072
    ds_read2st64_b32 v[44:45], v78 offset0:24 offset1:28
    s_waitcnt lgkmcnt(15)
    v_mfma_f32_16x16x32_bf16 v[104:107], a[0:3], v[16:19], 0
    ds_read2st64_b32 v[46:47], v79 offset0:24 offset1:28
    ds_read_b128 a[16:19], v0 offset:4096
    ds_read_b128 a[20:23], v0 offset:5120
    s_waitcnt lgkmcnt(15)
    v_mfma_f32_16x16x32_bf16 v[112:115], a[0:3], v[32:35], 0
    ds_read_b128 a[24:27], v0 offset:6144
    ds_read_b128 a[28:31], v0 offset:7168
    buffer_load_dwordx4 v2, s[8:11], s27 offen lds
    s_waitcnt lgkmcnt(15)
    v_mfma_f32_16x16x32_bf16 v[104:107], a[4:7], v[20:23], v[104:107]
    s_add_u32 m0, s25, 45056
    s_add_u32 s27, s26, 45056
    v_xor_b32 v77, 512, v1
    s_waitcnt lgkmcnt(14)
    v_mfma_f32_16x16x32_bf16 v[112:115], a[4:7], v[36:39], v[112:115]
    s_mul_i32 s21, s61, 65664
    v_xor_b32 v76, 64, v1
    v_xor_b32 v79, 516, v1
    s_waitcnt lgkmcnt(11)
    v_mfma_f32_16x16x32_bf16 v[104:107], a[8:11], v[24:27], v[104:107]
    v_xor_b32 v78, 68, v1
    s_waitcnt vmcnt(11)
    v_mul_f32 v6, v100, v100
    s_waitcnt lgkmcnt(9)
    v_mfma_f32_16x16x32_bf16 v[112:115], a[8:11], v[40:43], v[112:115]
    s_waitcnt vmcnt(10)
    v_lshl_add_u32 v252, v252, 8, v7
    buffer_load_dwordx4 v2, s[8:11], s27 offen lds
    s_waitcnt lgkmcnt(6)
    v_mfma_f32_16x16x32_bf16 v[104:107], a[12:15], v[28:31], v[104:107]
    s_add_u32 m0, s25, 49152
    s_add_u32 s27, s26, 49152
    v_lshl_add_u32 v253, v253, 8, v7
    s_waitcnt lgkmcnt(4)
    v_mfma_f32_16x16x32_bf16 v[112:115], a[12:15], v[44:47], v[112:115]
    s_waitcnt lgkmcnt(3)
    v_mfma_f32_16x16x32_bf16 v[108:111], a[16:19], v[16:19], 0
    s_nop 0
    v_cvt_pk_bf16_f32 v136, v104, v105
    v_mfma_f32_16x16x32_bf16 v[116:119], a[16:19], v[32:35], 0
    v_cvt_pk_bf16_f32 v137, v106, v107
    s_waitcnt lgkmcnt(2)
    v_mfma_f32_16x16x32_bf16 v[108:111], a[20:23], v[20:23], v[108:111]
    buffer_load_dwordx4 v2, s[8:11], s27 offen lds
    v_mfma_f32_16x16x32_bf16 v[116:119], a[20:23], v[36:39], v[116:119]
    s_add_u32 m0, s25, 53248
    s_add_u32 s27, s26, 53248
    v_cvt_pk_bf16_f32 v140, v112, v113
    s_waitcnt lgkmcnt(1)
    v_mfma_f32_16x16x32_bf16 v[108:111], a[24:27], v[24:27], v[108:111]
    v_cvt_pk_bf16_f32 v141, v114, v115
    v_mfma_f32_16x16x32_bf16 v[116:119], a[24:27], v[40:43], v[116:119]
    v_mfma_f32_16x16x32_bf16 v[120:123], v[16:19], v[16:19], 0
    v_mfma_f32_16x16x32_bf16 v[120:123], v[20:23], v[20:23], v[120:123]
    buffer_load_dwordx4 v2, s[8:11], s27 offen lds
    s_waitcnt lgkmcnt(0)
    v_mfma_f32_16x16x32_bf16 v[108:111], a[28:31], v[28:31], v[108:111]
    s_add_u32 m0, s25, 57344
    s_add_u32 s27, s26, 57344
    v_mfma_f32_16x16x32_bf16 v[120:123], v[24:27], v[24:27], v[120:123]
    v_mfma_f32_16x16x32_bf16 v[116:119], a[28:31], v[44:47], v[116:119]
    s_nop 3
    v_cvt_pk_bf16_f32 v138, v108, v109
    v_mfma_f32_16x16x32_bf16 v[120:123], v[28:31], v[28:31], v[120:123]
    v_cvt_pk_bf16_f32 v139, v110, v111
    v_mfma_f32_16x16x32_bf16 v[124:127], v[32:35], v[32:35], 0
    buffer_load_dwordx4 v2, s[8:11], s27 offen lds
    v_mfma_f32_16x16x32_bf16 v[124:127], v[36:39], v[36:39], v[124:127]
    s_add_u32 m0, s25, 61440
    s_add_u32 s27, s26, 61440
    s_waitcnt vmcnt(7)
    s_barrier
    v_mfma_f32_16x16x32_bf16 v[124:127], v[40:43], v[40:43], v[124:127]
    ds_read_b128 v[80:83], v15 offset:0
    ds_read_b128 v[84:87], v15 offset:1024
    ds_read_b128 a[32:35], v0 offset:8192
    v_mfma_f32_16x16x32_bf16 v[124:127], v[44:47], v[44:47], v[124:127]
    ds_read_b128 a[36:39], v0 offset:9216
    v_cvt_pk_bf16_f32 v142, v116, v117
    v_cvt_pk_bf16_f32 v143, v118, v119
    v_mfma_f32_16x16x32_bf16 v[152:155], v[136:139], v[16:19], 0
    ds_read_b128 a[40:43], v0 offset:10240
    v_cndmask_b32 v120, v120, v121, s[32:33]
    v_cndmask_b32 v120, v120, v122, s[34:35]
    v_mfma_f32_16x16x32_bf16 v[156:159], v[140:143], v[32:35], 0
    buffer_load_dwordx4 v2, s[8:11], s27 offen lds
    v_cndmask_b32 v124, v124, v125, s[32:33]
    v_cndmask_b32 v124, v124, v126, s[34:35]
    v_cndmask_b32 v120, v120, v123, s[36:37]
    v_cndmask_b32 v124, v124, v127, s[36:37]
    v_cndmask_b32 v11, 0, v120, s[38:39]
    v_cndmask_b32 v2, 0, v120, s[38:39]
    v_cndmask_b32 v122, 0, v124, s[38:39]
    ds_read_b128 a[44:47], v0 offset:11264
    ds_read_b128 a[48:51], v0 offset:12288
    s_waitcnt lgkmcnt(6)
    v_mfma_f32_16x16x32_bf16 v[248:251], v[80:83], v[16:19], 0
    ds_read_b128 a[52:55], v0 offset:13312
    v_mov_b32_dpp v11, v122 row_ror:8 row_mask:0xf bank_mask:0xc
    v_mov_b32_dpp v2, v122 row_ror:8 row_mask:0xf bank_mask:0x3
    v_mfma_f32_16x16x32_bf16 v[96:99], v[80:83], v[32:35], 0
    ds_read_b128 v[80:83], v15 offset:2048
    ds_read_b128 a[56:59], v0 offset:14336
    ds_read_b128 a[60:63], v0 offset:15360
    s_waitcnt lgkmcnt(9)
    v_mfma_f32_16x16x32_bf16 v[248:251], v[84:87], v[20:23], v[248:251]
    ds_read_b128 a[64:67], v0 offset:16384
    ds_read_b128 a[68:71], v0 offset:17408
    ds_read_b128 a[72:75], v0 offset:18432
    v_mfma_f32_16x16x32_bf16 v[96:99], v[84:87], v[36:39], v[96:99]
    ds_read_b128 v[84:87], v15 offset:3072
    ds_read_b128 a[76:79], v0 offset:19456
    ds_read_b128 a[80:83], v0 offset:20480
    s_waitcnt lgkmcnt(14)
    v_mfma_f32_16x16x32_bf16 v[120:123], a[32:35], v[16:19], 0
    ds_read_b128 a[84:87], v0 offset:21504
    ds_read_b128 a[88:91], v0 offset:22528
    ds_read_b128 a[92:95], v0 offset:23552
    v_mfma_f32_16x16x32_bf16 v[128:131], a[32:35], v[32:35], 0
    ds_read_b128 a[96:99], v0 offset:24576
    ds_read_b128 a[100:103], v0 offset:25600
    ds_read_b128 a[104:107], v0 offset:26624
    s_waitcnt lgkmcnt(15)
    v_mfma_f32_16x16x32_bf16 v[120:123], a[36:39], v[20:23], v[120:123]
    ds_read_b128 a[108:111], v0 offset:27648
    ds_read_b128 a[112:115], v0 offset:28672
    ds_read_b128 a[116:119], v0 offset:29696
    s_waitcnt lgkmcnt(15)
    v_mfma_f32_16x16x32_bf16 v[248:251], v[80:83], v[24:27], v[248:251]
    ds_read_b128 a[120:123], v0 offset:30720
    ds_read_b128 a[124:127], v0 offset:31744
    v_permlane32_swap_b32 v11, v2
    v_mfma_f32_16x16x32_bf16 v[96:99], v[80:83], v[40:43], v[96:99]
    s_lshl_b32 s23, s53, 4
    v_add_f32 v11, v11, v2
    v_mov_b32 v2, v11
    s_waitcnt lgkmcnt(13)
    v_mfma_f32_16x16x32_bf16 v[248:251], v[84:87], v[28:31], v[248:251]
    s_add_u32 s23, s23, 131072
    v_permlane16_swap_b32 v11, v2
    v_mfma_f32_16x16x32_bf16 v[96:99], v[84:87], v[44:47], v[96:99]
    buffer_load_dword v101, v102, s[8:11], s23 offen
    v_add_f32 v11, v11, v2
    ds_read_b128 v[80:83], v15 offset:0
    v_mfma_f32_16x16x32_bf16 v[128:131], a[36:39], v[36:39], v[128:131]
    ds_read_b128 v[84:87], v15 offset:1024
    s_add_u32 s21, s21, s44
    s_add_u32 s21, s21, 65011712
    v_mfma_f32_16x16x32_bf16 v[120:123], a[40:43], v[24:27], v[120:123]
    s_add_u32 m0, s44, 65536
    v_cndmask_b32_dpp v248, v96, v248, vcc row_ror:8 row_mask:0xf bank_mask:0xf
    v_mul_f32 v2, s28, v248
    v_mfma_f32_16x16x32_bf16 v[128:131], a[40:43], v[40:43], v[128:131]
    buffer_load_dwordx2 v[254:255], v3, s[8:11], s23 offen
    v_mul_f32 v2, v2, v2
    v_fma_f32 v11, v11, s28, -v2
    v_mfma_f32_16x16x32_bf16 v[120:123], a[44:47], v[28:31], v[120:123]
    v_mul_f32 v2, v100, v100
    v_max_f32 v11, 0, v11
    v_mfma_f32_16x16x32_bf16 v[128:131], a[44:47], v[44:47], v[128:131]
    v_fma_f32 v11, v11, v2, s29
    v_rsq_f32 v11, v11
    v_mfma_f32_16x16x32_bf16 v[124:127], a[48:51], v[16:19], 0
    v_mul_f32 v11, v11, v100
    ds_write_b32 v4, v11
    v_mfma_f32_16x16x32_bf16 v[132:135], a[48:51], v[32:35], 0
    ds_read_b128 v[244:247], v8
    v_cvt_pk_bf16_f32 v144, v120, v121
    v_cvt_pk_bf16_f32 v145, v122, v123
    v_mfma_f32_16x16x32_bf16 v[124:127], a[52:55], v[20:23], v[124:127]
    v_cvt_pk_bf16_f32 v148, v128, v129
    v_cvt_pk_bf16_f32 v149, v130, v131
    v_mfma_f32_16x16x32_bf16 v[132:135], a[52:55], v[36:39], v[132:135]
    v_cndmask_b32_dpp v250, v98, v250, vcc row_ror:8 row_mask:0xf bank_mask:0xf
    v_cndmask_b32_dpp v251, v99, v251, vcc row_ror:8 row_mask:0xf bank_mask:0xf
    v_mfma_f32_16x16x32_bf16 v[124:127], a[56:59], v[24:27], v[124:127]
    ds_write_b32 v4, v250 offset:128
    ds_write_b32 v4, v251 offset:256
    ds_read_b128 v[160:163], v8 offset:128
    v_mfma_f32_16x16x32_bf16 v[132:135], a[56:59], v[40:43], v[132:135]
    ds_read_b128 v[164:167], v8 offset:256
    v_cndmask_b32_dpp v249, v97, v249, vcc row_ror:8 row_mask:0xf bank_mask:0xf
    v_mfma_f32_16x16x32_bf16 v[124:127], a[60:63], v[28:31], v[124:127]
    v_mfma_f32_16x16x32_bf16 v[132:135], a[60:63], v[44:47], v[132:135]
    v_mfma_f32_16x16x32_bf16 v[104:107], a[64:67], v[16:19], 0
    s_nop 5
    v_cvt_pk_bf16_f32 v146, v124, v125
    v_mfma_f32_16x16x32_bf16 v[112:115], a[64:67], v[32:35], 0
    v_cvt_pk_bf16_f32 v147, v126, v127
    v_mfma_f32_16x16x32_bf16 v[104:107], a[68:71], v[20:23], v[104:107]
    v_cvt_pk_bf16_f32 v150, v132, v133
    v_mfma_f32_16x16x32_bf16 v[152:155], v[144:147], v[20:23], v[152:155]
    v_cvt_pk_bf16_f32 v151, v134, v135
    v_mfma_f32_16x16x32_bf16 v[112:115], a[68:71], v[36:39], v[112:115]
    v_mfma_f32_16x16x32_bf16 v[104:107], a[72:75], v[24:27], v[104:107]
    v_mfma_f32_16x16x32_bf16 v[156:159], v[148:151], v[36:39], v[156:159]
    v_mfma_f32_16x16x32_bf16 v[112:115], a[72:75], v[40:43], v[112:115]
    s_waitcnt lgkmcnt(15)
    v_mfma_f32_16x16x32_bf16 v[104:107], a[76:79], v[28:31], v[104:107]
    v_mfma_f32_16x16x32_bf16 v[112:115], a[76:79], v[44:47], v[112:115]
    v_mfma_f32_16x16x32_bf16 v[108:111], a[80:83], v[16:19], 0
    s_nop 5
    v_cvt_pk_bf16_f32 v136, v104, v105
    v_mfma_f32_16x16x32_bf16 v[116:119], a[80:83], v[32:35], 0
    v_cvt_pk_bf16_f32 v137, v106, v107
    v_mfma_f32_16x16x32_bf16 v[108:111], a[84:87], v[20:23], v[108:111]
    v_cvt_pk_bf16_f32 v140, v112, v113
    v_mfma_f32_16x16x32_bf16 v[116:119], a[84:87], v[36:39], v[116:119]
    v_cvt_pk_bf16_f32 v141, v114, v115
    v_mfma_f32_16x16x32_bf16 v[108:111], a[88:91], v[24:27], v[108:111]
    v_mfma_f32_16x16x32_bf16 v[116:119], a[88:91], v[40:43], v[116:119]
    v_mfma_f32_16x16x32_bf16 v[108:111], a[92:95], v[28:31], v[108:111]
    v_mfma_f32_16x16x32_bf16 v[116:119], a[92:95], v[44:47], v[116:119]
    v_mfma_f32_16x16x32_bf16 v[120:123], a[96:99], v[16:19], 0
    s_nop 5
    v_cvt_pk_bf16_f32 v138, v108, v109
    v_mfma_f32_16x16x32_bf16 v[128:131], a[96:99], v[32:35], 0
    v_cvt_pk_bf16_f32 v139, v110, v111
    s_waitcnt lgkmcnt(14)
    v_mfma_f32_16x16x32_bf16 v[120:123], a[100:103], v[20:23], v[120:123]
    v_cvt_pk_bf16_f32 v142, v116, v117
    v_mfma_f32_16x16x32_bf16 v[152:155], v[136:139], v[24:27], v[152:155]
    v_cvt_pk_bf16_f32 v143, v118, v119
    v_mfma_f32_16x16x32_bf16 v[128:131], a[100:103], v[36:39], v[128:131]
    s_waitcnt lgkmcnt(13)
    v_mfma_f32_16x16x32_bf16 v[120:123], a[104:107], v[24:27], v[120:123]
    v_mfma_f32_16x16x32_bf16 v[156:159], v[140:143], v[40:43], v[156:159]
    v_mfma_f32_16x16x32_bf16 v[128:131], a[104:107], v[40:43], v[128:131]
    s_waitcnt lgkmcnt(12)
    v_mfma_f32_16x16x32_bf16 v[120:123], a[108:111], v[28:31], v[120:123]
    v_mfma_f32_16x16x32_bf16 v[128:131], a[108:111], v[44:47], v[128:131]
    s_waitcnt lgkmcnt(11)
    v_mfma_f32_16x16x32_bf16 v[124:127], a[112:115], v[16:19], 0
    s_nop 4
    v_cvt_pk_bf16_f32 v144, v120, v121
    v_mfma_f32_16x16x32_bf16 v[132:135], a[112:115], v[32:35], 0
    v_cvt_pk_bf16_f32 v145, v122, v123
    s_waitcnt lgkmcnt(10)
    v_mfma_f32_16x16x32_bf16 v[124:127], a[116:119], v[20:23], v[124:127]
    v_cvt_pk_bf16_f32 v148, v128, v129
    v_mfma_f32_16x16x32_bf16 v[132:135], a[116:119], v[36:39], v[132:135]
    v_cvt_pk_bf16_f32 v149, v130, v131
    s_waitcnt lgkmcnt(9)
    v_mfma_f32_16x16x32_bf16 v[124:127], a[120:123], v[24:27], v[124:127]
    v_mfma_f32_16x16x32_bf16 v[132:135], a[120:123], v[40:43], v[132:135]
    s_waitcnt lgkmcnt(8)
    v_mfma_f32_16x16x32_bf16 v[124:127], a[124:127], v[28:31], v[124:127]
    v_mfma_f32_16x16x32_bf16 v[132:135], a[124:127], v[44:47], v[132:135]
    v_mfma_f32_16x16x32_bf16 v[168:171], v[16:19], v[232:235], 0
    s_nop 5
    v_cvt_pk_bf16_f32 v146, v124, v125
    v_mfma_f32_16x16x32_bf16 v[172:175], v[16:19], v[236:239], 0
    v_cvt_pk_bf16_f32 v147, v126, v127
    v_mfma_f32_16x16x32_bf16 v[200:203], v[32:35], v[232:235], 0
    v_cvt_pk_bf16_f32 v150, v132, v133
    v_mfma_f32_16x16x32_bf16 v[152:155], v[144:147], v[28:31], v[152:155]
    v_cvt_pk_bf16_f32 v151, v134, v135
    v_mfma_f32_16x16x32_bf16 v[204:207], v[32:35], v[236:239], 0
    v_mfma_f32_16x16x32_bf16 v[176:179], v[20:23], v[232:235], 0
    v_mfma_f32_16x16x32_bf16 v[156:159], v[148:151], v[44:47], v[156:159]
    v_mfma_f32_16x16x32_bf16 v[180:183], v[20:23], v[236:239], 0
    v_mfma_f32_16x16x32_bf16 v[208:211], v[36:39], v[232:235], 0
    s_nop 5
    v_cndmask_b32_dpp v152, v156, v152, vcc row_ror:8 row_mask:0xf bank_mask:0xf
    s_waitcnt vmcnt(2)
    s_barrier
    ds_read_b128 a[128:131], v0 offset:32768
    ds_read_b128 a[132:135], v0 offset:33792
    ds_read_b128 a[136:139], v0 offset:34816
    ds_read_b128 a[140:143], v0 offset:35840
    ds_read_b128 a[144:147], v0 offset:36864
    ds_read_b128 a[148:151], v0 offset:37888
    ds_read_b128 a[152:155], v0 offset:38912
    ds_read_b128 a[156:159], v0 offset:39936
    v_mfma_f32_16x16x32_bf16 v[212:215], v[36:39], v[236:239], 0
    ds_read_b128 a[160:163], v0 offset:40960
    ds_read_b128 a[164:167], v0 offset:41984
    ds_read_b128 a[168:171], v0 offset:43008
    ds_read_b128 a[172:175], v0 offset:44032
    ds_read_b128 a[176:179], v0 offset:45056
    ds_read_b128 a[180:183], v0 offset:46080
    ds_read_b128 a[184:187], v0 offset:47104
    v_mfma_f32_16x16x32_bf16 v[184:187], v[24:27], v[232:235], 0
    ds_read_b128 a[188:191], v0 offset:48128
    v_cndmask_b32_dpp v153, v157, v153, vcc row_ror:8 row_mask:0xf bank_mask:0xf
    v_cndmask_b32_dpp v154, v158, v154, vcc row_ror:8 row_mask:0xf bank_mask:0xf
    v_mfma_f32_16x16x32_bf16 v[188:191], v[24:27], v[236:239], 0
    ds_read_b128 a[192:195], v0 offset:49152
    v_cndmask_b32_dpp v155, v159, v155, vcc row_ror:8 row_mask:0xf bank_mask:0xf
    s_waitcnt lgkmcnt(15)
    v_mul_f32 v152, v152, v244
    v_mfma_f32_16x16x32_bf16 v[104:107], v[16:19], a[128:131], 0
    ds_read_b128 a[196:199], v0 offset:50176
    v_mul_f32 v153, v153, v245
    v_mul_f32 v154, v154, v246
    v_mfma_f32_16x16x32_bf16 v[112:115], v[32:35], a[128:131], 0
    ds_read_b128 a[200:203], v0 offset:51200
    v_max3_f32 v156, v152, v153, v154
    v_mul_f32 v155, v155, v247
    v_mfma_f32_16x16x32_bf16 v[104:107], v[20:23], a[132:135], v[104:107]
    ds_read_b128 a[204:207], v0 offset:52224
    v_max_f32 v156, v156, v155
    v_mov_b32 v157, v156
    v_mfma_f32_16x16x32_bf16 v[112:115], v[36:39], a[132:135], v[112:115]
    ds_read_b128 a[208:211], v0 offset:53248
    v_permlane16_swap_b32 v156, v157
    s_waitcnt lgkmcnt(15)
    v_mfma_f32_16x16x32_bf16 v[104:107], v[24:27], a[136:139], v[104:107]
    ds_read_b128 a[212:215], v0 offset:54272
    v_max_f32 v156, v156, v157
    v_mul_f32 v156, v156, v11
    v_mfma_f32_16x16x32_bf16 v[112:115], v[40:43], a[136:139], v[112:115]
    ds_read_b128 a[216:219], v0 offset:55296
    v_fma_f32 v152, v152, v11, -v156
    v_fma_f32 v153, v153, v11, -v156
    v_mfma_f32_16x16x32_bf16 v[104:107], v[28:31], a[140:143], v[104:107]
    ds_read_b128 a[220:223], v0 offset:56320
    v_fma_f32 v154, v154, v11, -v156
    v_fma_f32 v155, v155, v11, -v156
    v_mfma_f32_16x16x32_bf16 v[112:115], v[44:47], a[140:143], v[112:115]
    ds_read_b128 a[224:227], v0 offset:57344
    v_exp_f32 v152, v152
    v_mfma_f32_16x16x32_bf16 v[108:111], v[16:19], a[144:147], 0
    ds_read_b128 a[228:231], v0 offset:58368
    v_exp_f32 v153, v153
    v_mfma_f32_16x16x32_bf16 v[116:119], v[32:35], a[144:147], 0
    ds_read_b128 a[232:235], v0 offset:59392
    v_exp_f32 v154, v154
    v_mfma_f32_16x16x32_bf16 v[108:111], v[20:23], a[148:151], v[108:111]
    ds_read_b128 a[236:239], v0 offset:60416
    v_exp_f32 v155, v155
    v_mfma_f32_16x16x32_bf16 v[116:119], v[36:39], a[148:151], v[116:119]
    ds_read_b128 a[240:243], v0 offset:61440
    v_add_f32 v156, v152, v153
    v_add_f32 v157, v154, v155
    s_waitcnt lgkmcnt(15)
    v_mfma_f32_16x16x32_bf16 v[108:111], v[24:27], a[152:155], v[108:111]
    ds_read_b128 a[244:247], v0 offset:62464
    v_add_f32 v156, v156, v157
    v_mov_b32 v157, v156
    v_mfma_f32_16x16x32_bf16 v[116:119], v[40:43], a[152:155], v[116:119]
    ds_read_b128 a[248:251], v0 offset:63488
    v_permlane16_swap_b32 v156, v157
    v_mfma_f32_16x16x32_bf16 v[108:111], v[28:31], a[156:159], v[108:111]
    ds_read_b128 a[252:255], v0 offset:64512
    v_add_f32 v156, v156, v157
    v_mul_f32 v156, v156, v100
    v_mfma_f32_16x16x32_bf16 v[116:119], v[44:47], a[156:159], v[116:119]
    v_rcp_f32 v156, v156
    v_mfma_f32_16x16x32_bf16 v[120:123], v[16:19], a[160:163], 0
    v_mul_f32 v152, v152, v244
    v_mul_f32 v153, v153, v245
    v_mfma_f32_16x16x32_bf16 v[128:131], v[32:35], a[160:163], 0
    v_mul_f32 v154, v154, v246
    v_mul_f32 v155, v155, v247
    v_mfma_f32_16x16x32_bf16 v[120:123], v[20:23], a[164:167], v[120:123]
    v_mul_f32 v152, v152, v156
    v_mul_f32 v153, v153, v156
    v_mfma_f32_16x16x32_bf16 v[128:131], v[36:39], a[164:167], v[128:131]
    v_mul_f32 v154, v154, v156
    v_mul_f32 v155, v155, v156
    v_mfma_f32_16x16x32_bf16 v[120:123], v[24:27], a[168:171], v[120:123]
    v_cvt_pk_bf16_f32 v158, v152, v153
    v_cvt_pk_bf16_f32 v159, v154, v155
    v_mfma_f32_16x16x32_bf16 v[128:131], v[40:43], a[168:171], v[128:131]
    s_waitcnt lgkmcnt(0)
    s_barrier
    v_cvt_pk_bf16_f32 v136, v104, v105
    v_mfma_f32_16x16x32_bf16 v[120:123], v[28:31], a[172:175], v[120:123]
    buffer_load_dwordx4 v103, s[8:11], s21 offen offset:0 lds
    v_mfma_f32_16x16x32_bf16 v[128:131], v[44:47], a[172:175], v[128:131]
    v_cvt_pk_bf16_f32 v137, v106, v107
    v_and_b32 v240, v158, v10
    v_mfma_f32_16x16x32_bf16 v[124:127], v[16:19], a[176:179], 0
    v_and_b32 v241, v159, v10
    v_cvt_pk_bf16_f32 v138, v108, v109
    v_mfma_f32_16x16x32_bf16 v[132:135], v[32:35], a[176:179], 0
    v_cvt_pk_bf16_f32 v139, v110, v111
    v_cvt_pk_bf16_f32 v140, v112, v113
    v_mfma_f32_16x16x32_bf16 v[124:127], v[20:23], a[180:183], v[124:127]
    v_cvt_pk_bf16_f32 v141, v114, v115
    v_and_b32_dpp v242, v158, v10 row_ror:8 row_mask:0xf bank_mask:0xf
    v_mfma_f32_16x16x32_bf16 v[132:135], v[36:39], a[180:183], v[132:135]
    v_and_b32_dpp v243, v159, v10 row_ror:8 row_mask:0xf bank_mask:0xf
    v_cvt_pk_bf16_f32 v142, v116, v117
    v_mfma_f32_16x16x32_bf16 v[124:127], v[24:27], a[184:187], v[124:127]
    buffer_load_dwordx4 v103, s[8:11], s21 offen offset:1024 lds
    v_mfma_f32_16x16x32_bf16 v[132:135], v[40:43], a[184:187], v[132:135]
    v_cvt_pk_bf16_f32 v143, v118, v119
    v_cvt_pk_bf16_f32 v144, v120, v121
    v_mfma_f32_16x16x32_bf16 v[124:127], v[28:31], a[188:191], v[124:127]
    v_cvt_pk_bf16_f32 v145, v122, v123
    v_cvt_pk_bf16_f32 v148, v128, v129
    v_mfma_f32_16x16x32_bf16 v[132:135], v[44:47], a[188:191], v[132:135]
    v_cvt_pk_bf16_f32 v149, v130, v131
    v_mul_f32 v13, v152, v160
    v_mfma_f32_16x16x32_bf16 v[216:219], v[40:43], v[232:235], 0
    v_mul_f32 v14, v152, v164
    v_fmac_f32 v13, v153, v161
    v_mfma_f32_16x16x32_bf16 v[220:223], v[40:43], v[236:239], 0
    v_cvt_pk_bf16_f32 v146, v124, v125
    v_cvt_pk_bf16_f32 v147, v126, v127
    v_mfma_f32_16x16x32_bf16 v[192:195], v[28:31], v[232:235], 0
    buffer_load_dwordx4 v103, s[8:11], s21 offen offset:2048 lds
    v_mfma_f32_16x16x32_bf16 v[196:199], v[28:31], v[236:239], 0
    v_cvt_pk_bf16_f32 v150, v132, v133
    v_cvt_pk_bf16_f32 v151, v134, v135
    v_mfma_f32_16x16x32_bf16 v[224:227], v[44:47], v[232:235], 0
    v_fmac_f32 v14, v153, v165
    v_fmac_f32 v13, v154, v162
    v_mfma_f32_16x16x32_bf16 v[228:231], v[44:47], v[236:239], 0
    v_fmac_f32 v14, v154, v166
    v_fmac_f32 v13, v155, v163
    v_mfma_f32_16x16x16_bf16 v[168:171], v[240:241], v[136:137], v[168:171]
    v_fmac_f32 v14, v155, v167
    s_waitcnt vmcnt(3)
    v_lshl_add_u32 v254, v254, 8, v7
    v_mfma_f32_16x16x16_bf16 v[172:175], v[240:241], v[138:139], v[172:175]
    v_permlane16_swap_b32 v13, v14
    v_mfma_f32_16x16x16_bf16 v[200:203], v[242:243], v[140:141], v[200:203]
    buffer_load_dwordx4 v103, s[8:11], s21 offen offset:3072 lds
    v_mfma_f32_16x16x16_bf16 v[204:207], v[242:243], v[142:143], v[204:207]
    s_add_u32 s21, s21, 4096
    v_mul_f32 v48, v168, v168
    v_mul_f32 v49, v169, v169
    v_mfma_f32_16x16x32_bf16 v[104:107], v[16:19], a[192:195], 0
    s_add_u32 m0, s44, 69632
    v_mul_f32 v50, v170, v170
    v_mul_f32 v51, v171, v171
    v_mfma_f32_16x16x32_bf16 v[112:115], v[32:35], a[192:195], 0
    v_mul_f32 v52, v200, v200
    v_mul_f32 v53, v201, v201
    v_mfma_f32_16x16x32_bf16 v[104:107], v[20:23], a[196:199], v[104:107]
    v_mul_f32 v54, v202, v202
    v_mul_f32 v55, v203, v203
    v_mfma_f32_16x16x32_bf16 v[112:115], v[36:39], a[196:199], v[112:115]
    v_fmac_f32 v48, v172, v172
    v_fmac_f32 v49, v173, v173
    v_mfma_f32_16x16x32_bf16 v[104:107], v[24:27], a[200:203], v[104:107]
    buffer_load_dwordx4 v103, s[8:11], s21 offen offset:0 lds
    v_mfma_f32_16x16x32_bf16 v[112:115], v[40:43], a[200:203], v[112:115]
    v_fmac_f32 v50, v174, v174
    v_fmac_f32 v51, v175, v175
    v_mfma_f32_16x16x32_bf16 v[104:107], v[28:31], a[204:207], v[104:107]
    v_fmac_f32 v52, v204, v204
    v_fmac_f32 v53, v205, v205
    v_mfma_f32_16x16x32_bf16 v[112:115], v[44:47], a[204:207], v[112:115]
    v_fmac_f32 v54, v206, v206
    v_fmac_f32 v55, v207, v207
    v_mfma_f32_16x16x32_bf16 v[108:111], v[16:19], a[208:211], 0
    v_add_f32 v13, v13, v14
    v_mov_b32 v14, v13
    v_mfma_f32_16x16x32_bf16 v[116:119], v[32:35], a[208:211], 0
    v_cvt_pk_bf16_f32 v136, v104, v105
    v_cvt_pk_bf16_f32 v137, v106, v107
    v_mfma_f32_16x16x32_bf16 v[108:111], v[20:23], a[212:215], v[108:111]
    buffer_load_dwordx4 v103, s[8:11], s21 offen offset:1024 lds
    v_mfma_f32_16x16x32_bf16 v[116:119], v[36:39], a[212:215], v[116:119]
    v_cvt_pk_bf16_f32 v140, v112, v113
    v_cvt_pk_bf16_f32 v141, v114, v115
    v_mfma_f32_16x16x32_bf16 v[108:111], v[24:27], a[216:219], v[108:111]
    v_permlane16_swap_b32 v13, v14
    v_mfma_f32_16x16x32_bf16 v[116:119], v[40:43], a[216:219], v[116:119]
    v_add_f32 v13, v13, v248
    v_add_f32 v14, v14, v249
    v_mfma_f32_16x16x32_bf16 v[108:111], v[28:31], a[220:223], v[108:111]
    v_mul_f32 v13, s28, v13
    v_fma_f32 v14, -v13, s24, v14
    v_mfma_f32_16x16x32_bf16 v[116:119], v[44:47], a[220:223], v[116:119]
    v_mul_f32 v13, v13, v13
    v_mul_f32 v14, s30, v14
    v_mfma_f32_16x16x16_bf16 v[176:179], v[240:241], v[144:145], v[176:179]
    buffer_load_dwordx4 v103, s[8:11], s21 offen offset:2048 lds
    v_mfma_f32_16x16x16_bf16 v[180:183], v[240:241], v[146:147], v[180:183]
    v_cvt_pk_bf16_f32 v138, v108, v109
    v_cvt_pk_bf16_f32 v139, v110, v111
    v_mfma_f32_16x16x16_bf16 v[208:211], v[242:243], v[148:149], v[208:211]
    v_cvt_pk_bf16_f32 v142, v116, v117
    v_cvt_pk_bf16_f32 v143, v118, v119
    v_mfma_f32_16x16x16_bf16 v[212:215], v[242:243], v[150:151], v[212:215]
    v_fmac_f32 v48, v176, v176
    v_fmac_f32 v49, v177, v177
    v_mfma_f32_16x16x32_bf16 v[120:123], v[16:19], a[224:227], 0
    v_fmac_f32 v50, v178, v178
    v_fmac_f32 v51, v179, v179
    v_mfma_f32_16x16x32_bf16 v[128:131], v[32:35], a[224:227], 0
    v_fmac_f32 v52, v208, v208
    v_fmac_f32 v53, v209, v209
    v_mfma_f32_16x16x32_bf16 v[120:123], v[20:23], a[228:231], v[120:123]
    buffer_load_dwordx4 v103, s[8:11], s21 offen offset:3072 lds
    v_mfma_f32_16x16x32_bf16 v[128:131], v[36:39], a[228:231], v[128:131]
    s_add_u32 s21, s21, 4096
    v_fmac_f32 v54, v210, v210
    v_fmac_f32 v55, v211, v211
    v_mfma_f32_16x16x32_bf16 v[120:123], v[24:27], a[232:235], v[120:123]
    s_add_u32 m0, s44, 73728
    v_fmac_f32 v48, v180, v180
    v_fmac_f32 v49, v181, v181
    v_mfma_f32_16x16x32_bf16 v[128:131], v[40:43], a[232:235], v[128:131]
    v_fmac_f32 v50, v182, v182
    v_fmac_f32 v51, v183, v183
    v_mfma_f32_16x16x32_bf16 v[120:123], v[28:31], a[236:239], v[120:123]
    v_fmac_f32 v52, v212, v212
    v_fmac_f32 v53, v213, v213
    v_mfma_f32_16x16x32_bf16 v[128:131], v[44:47], a[236:239], v[128:131]
    v_fmac_f32 v54, v214, v214
    v_fmac_f32 v55, v215, v215
    v_mfma_f32_16x16x32_bf16 v[124:127], v[16:19], a[240:243], 0
    ds_read2st64_b32 v[16:17], v76 offset0:0 offset1:4
    ds_read2st64_b32 v[18:19], v77 offset0:0 offset1:4
    v_cvt_pk_bf16_f32 v144, v120, v121
    v_mfma_f32_16x16x32_bf16 v[132:135], v[32:35], a[240:243], 0
    ds_read2st64_b32 v[32:33], v78 offset0:0 offset1:4
    v_cvt_pk_bf16_f32 v145, v122, v123
    v_cvt_pk_bf16_f32 v148, v128, v129
    v_mfma_f32_16x16x32_bf16 v[124:127], v[20:23], a[244:247], v[124:127]
    ds_read2st64_b32 v[34:35], v79 offset0:0 offset1:4
    v_cvt_pk_bf16_f32 v149, v130, v131
    ds_read2st64_b32 v[20:21], v76 offset0:8 offset1:12
    v_mfma_f32_16x16x32_bf16 v[132:135], v[36:39], a[244:247], v[132:135]
    ds_read2st64_b32 v[22:23], v77 offset0:8 offset1:12
    ds_read2st64_b32 v[36:37], v78 offset0:8 offset1:12
    ds_read2st64_b32 v[38:39], v79 offset0:8 offset1:12
    v_mfma_f32_16x16x32_bf16 v[124:127], v[24:27], a[248:251], v[124:127]
    ds_read2st64_b32 v[24:25], v76 offset0:16 offset1:20
    ds_read2st64_b32 v[26:27], v77 offset0:16 offset1:20
    buffer_load_dwordx4 v12, s[8:11], s21 offen offset:0 lds
    v_mfma_f32_16x16x32_bf16 v[132:135], v[40:43], a[248:251], v[132:135]
    ds_read2st64_b32 v[40:41], v78 offset0:16 offset1:20
    ds_read2st64_b32 v[42:43], v79 offset0:16 offset1:20
    v_mul_f32 v14, v14, v100
    v_mfma_f32_16x16x32_bf16 v[124:127], v[28:31], a[252:255], v[124:127]
    ds_read2st64_b32 v[28:29], v76 offset0:24 offset1:28
    ds_read2st64_b32 v[30:31], v77 offset0:24 offset1:28
    v_xor_b32 v76, 65536, v1
    v_mfma_f32_16x16x32_bf16 v[132:135], v[44:47], a[252:255], v[132:135]
    ds_read2st64_b32 v[44:45], v78 offset0:24 offset1:28
    ds_read2st64_b32 v[46:47], v79 offset0:24 offset1:28
    v_xor_b32 v77, 66112, v1
    v_mfma_f32_16x16x16_bf16 v[184:187], v[240:241], v[136:137], v[184:187]
    v_cvt_pk_bf16_f32 v146, v124, v125
    v_cvt_pk_bf16_f32 v147, v126, v127
    v_mfma_f32_16x16x16_bf16 v[188:191], v[240:241], v[138:139], v[188:191]
    v_xor_b32 v78, 65540, v1
    v_cvt_pk_bf16_f32 v150, v132, v133
    v_mfma_f32_16x16x16_bf16 v[216:219], v[242:243], v[140:141], v[216:219]
    buffer_load_dwordx4 v12, s[8:11], s21 offen offset:1024 lds
    v_mfma_f32_16x16x16_bf16 v[220:223], v[242:243], v[142:143], v[220:223]
    v_cvt_pk_bf16_f32 v151, v134, v135
    v_fmac_f32 v48, v184, v184
    v_mfma_f32_16x16x16_bf16 v[192:195], v[240:241], v[144:145], v[192:195]
    v_fmac_f32 v49, v185, v185
    v_fmac_f32 v50, v186, v186
    v_mfma_f32_16x16x16_bf16 v[196:199], v[240:241], v[146:147], v[196:199]
    v_fmac_f32 v51, v187, v187
    v_fmac_f32 v52, v216, v216
    v_mfma_f32_16x16x16_bf16 v[224:227], v[242:243], v[148:149], v[224:227]
    v_fmac_f32 v53, v217, v217
    v_fmac_f32 v54, v218, v218
    v_mfma_f32_16x16x16_bf16 v[228:231], v[242:243], v[150:151], v[228:231]
    v_fmac_f32 v55, v219, v219
    v_fmac_f32 v48, v188, v188
    s_waitcnt lgkmcnt(14)
    v_mfma_f32_16x16x32_bf16 v[104:107], a[0:3], v[16:19], 0
    buffer_load_dwordx4 v12, s[8:11], s21 offen offset:2048 lds
    s_waitcnt lgkmcnt(12)
    v_mfma_f32_16x16x32_bf16 v[112:115], a[0:3], v[32:35], 0
    v_fmac_f32 v49, v189, v189
    v_fmac_f32 v50, v190, v190
    s_waitcnt lgkmcnt(10)
    v_mfma_f32_16x16x32_bf16 v[104:107], a[4:7], v[20:23], v[104:107]
    v_fmac_f32 v51, v191, v191
    v_fmac_f32 v52, v220, v220
    s_waitcnt lgkmcnt(8)
    v_mfma_f32_16x16x32_bf16 v[112:115], a[4:7], v[36:39], v[112:115]
    v_fmac_f32 v53, v221, v221
    v_fmac_f32 v54, v222, v222
    s_waitcnt lgkmcnt(6)
    v_mfma_f32_16x16x32_bf16 v[104:107], a[8:11], v[24:27], v[104:107]
    v_fmac_f32 v55, v223, v223
    v_fmac_f32 v48, v192, v192
    s_waitcnt lgkmcnt(4)
    v_mfma_f32_16x16x32_bf16 v[112:115], a[8:11], v[40:43], v[112:115]
    buffer_load_dwordx4 v12, s[8:11], s21 offen offset:3072 lds
    s_waitcnt lgkmcnt(2)
    v_mfma_f32_16x16x32_bf16 v[104:107], a[12:15], v[28:31], v[104:107]
    s_add_u32 s21, s21, 4096
    v_fmac_f32 v49, v193, v193
    v_fmac_f32 v50, v194, v194
    s_waitcnt lgkmcnt(0)
    v_mfma_f32_16x16x32_bf16 v[112:115], a[12:15], v[44:47], v[112:115]
    s_add_u32 m0, s44, 77824
    v_fmac_f32 v51, v195, v195
    v_fmac_f32 v52, v224, v224
    v_mfma_f32_16x16x32_bf16 v[108:111], a[16:19], v[16:19], 0
    s_lshl_b32 s23, s54, 4
    v_fmac_f32 v53, v225, v225
    v_fmac_f32 v54, v226, v226
    v_mfma_f32_16x16x32_bf16 v[116:119], a[16:19], v[32:35], 0
    s_add_u32 s23, s23, 131072
    v_fmac_f32 v55, v227, v227
    v_fmac_f32 v48, v196, v196
    v_mfma_f32_16x16x32_bf16 v[108:111], a[20:23], v[20:23], v[108:111]
    buffer_load_dwordx4 v12, s[8:11], s21 offen offset:0 lds
    v_mfma_f32_16x16x32_bf16 v[116:119], a[20:23], v[36:39], v[116:119]
    v_fmac_f32 v49, v197, v197
    v_fmac_f32 v50, v198, v198
    v_mfma_f32_16x16x32_bf16 v[108:111], a[24:27], v[24:27], v[108:111]
    v_fmac_f32 v51, v199, v199
    v_fmac_f32 v52, v228, v228
    v_mfma_f32_16x16x32_bf16 v[116:119], a[24:27], v[40:43], v[116:119]
    v_fmac_f32 v53, v229, v229
    v_fmac_f32 v54, v230, v230
    v_mfma_f32_16x16x32_bf16 v[108:111], a[28:31], v[28:31], v[108:111]
    v_fmac_f32 v55, v231, v231
    v_cvt_pk_bf16_f32 v64, v48, v49
    v_mfma_f32_16x16x32_bf16 v[116:119], a[28:31], v[44:47], v[116:119]
    v_cvt_pk_bf16_f32 v65, v50, v51
    v_cvt_pk_bf16_f32 v66, v52, v53
    v_mfma_f32_16x16x32_bf16 v[120:123], v[16:19], v[16:19], 0
    buffer_load_dwordx4 v12, s[8:11], s21 offen offset:1024 lds
    v_mfma_f32_16x16x32_bf16 v[124:127], v[32:35], v[32:35], 0
    v_cvt_pk_bf16_f32 v67, v54, v55
    v_cvt_pk_bf16_f32 v136, v104, v105
    v_mfma_f32_16x16x32_bf16 v[120:123], v[20:23], v[20:23], v[120:123]
    v_cvt_pk_bf16_f32 v137, v106, v107
    v_cvt_pk_bf16_f32 v138, v108, v109
    v_mfma_f32_16x16x32_bf16 v[68:71], v[64:67], v[88:91], 0
    v_cvt_pk_bf16_f32 v139, v110, v111
    v_cvt_pk_bf16_f32 v140, v112, v113
    v_mfma_f32_16x16x32_bf16 v[72:75], v[64:67], v[92:95], 0
    v_cvt_pk_bf16_f32 v141, v114, v115
    v_cvt_pk_bf16_f32 v142, v116, v117
    v_mfma_f32_16x16x32_bf16 v[124:127], v[36:39], v[36:39], v[124:127]
    v_cvt_pk_bf16_f32 v143, v118, v119
    buffer_load_dwordx4 v12, s[8:11], s21 offen offset:2048 lds
    v_mfma_f32_16x16x32_bf16 v[120:123], v[24:27], v[24:27], v[120:123]
    v_add_f32 v68, v68, v69
    v_add_f32 v70, v70, v71
    v_mfma_f32_16x16x32_bf16 v[124:127], v[40:43], v[40:43], v[124:127]
    v_add_f32 v72, v72, v73
    v_add_f32 v74, v74, v75
    v_mfma_f32_16x16x32_bf16 v[120:123], v[28:31], v[28:31], v[120:123]
    v_add_f32 v68, v68, v70
    v_add_f32 v72, v72, v74
    v_mfma_f32_16x16x32_bf16 v[248:251], v[80:83], v[16:19], 0
    v_xor_b32 v79, 66116, v1
    v_permlane32_swap_b32 v68, v72
    v_mfma_f32_16x16x32_bf16 v[96:99], v[80:83], v[32:35], 0
    ds_read_b128 v[80:83], v15 offset:2048
    v_add_f32 v5, v68, v72
    v_cndmask_b32 v120, v120, v121, s[32:33]
    v_mfma_f32_16x16x32_bf16 v[124:127], v[44:47], v[44:47], v[124:127]
    buffer_load_dwordx4 v12, s[8:11], s21 offen offset:3072 lds
    v_mfma_f32_16x16x32_bf16 v[248:251], v[84:87], v[20:23], v[248:251]
    s_mul_i32 s21, s62, 65664
    v_cndmask_b32 v120, v120, v122, s[34:35]
    v_cndmask_b32 v120, v120, v123, s[36:37]
    v_mfma_f32_16x16x32_bf16 v[96:99], v[84:87], v[36:39], v[96:99]
    ds_read_b128 v[84:87], v15 offset:3072
    v_cndmask_b32 v11, 0, v120, s[38:39]
    v_cndmask_b32 v124, v124, v125, s[32:33]
    v_mfma_f32_16x16x32_bf16 v[152:155], v[136:139], v[16:19], 0
    s_add_u32 s21, s21, s44
    v_cndmask_b32 v124, v124, v126, s[34:35]
    v_cndmask_b32 v124, v124, v127, s[36:37]
    v_mfma_f32_16x16x32_bf16 v[156:159], v[140:143], v[32:35], 0
    s_add_u32 s21, s21, 65011712
    v_cndmask_b32 v2, 0, v120, s[38:39]
    v_cndmask_b32 v122, 0, v124, s[38:39]
    v_mfma_f32_16x16x32_bf16 v[128:131], a[32:35], v[32:35], 0
    s_add_u32 m0, s44, 0
    v_mov_b32_dpp v11, v122 row_ror:8 row_mask:0xf bank_mask:0xc
    v_mov_b32_dpp v2, v122 row_ror:8 row_mask:0xf bank_mask:0x3
    s_waitcnt lgkmcnt(1)
    v_mfma_f32_16x16x32_bf16 v[248:251], v[80:83], v[24:27], v[248:251]
    v_mov_b32 v72, v5
    v_permlane32_swap_b32 v11, v2
    v_mfma_f32_16x16x32_bf16 v[96:99], v[80:83], v[40:43], v[96:99]
    ds_read_b128 v[80:83], v15 offset:0
    v_permlane16_swap_b32 v5, v72
    v_mfma_f32_16x16x32_bf16 v[120:123], a[32:35], v[16:19], 0
    v_add_f32 v5, v5, v72
    v_fma_f32 v5, v5, s28, -v13
    s_waitcnt lgkmcnt(1)
    v_mfma_f32_16x16x32_bf16 v[248:251], v[84:87], v[28:31], v[248:251]
    v_max_f32 v5, 0, v5
    v_fma_f32 v5, v5, v6, s29
    v_mfma_f32_16x16x32_bf16 v[96:99], v[84:87], v[44:47], v[96:99]
    ds_read_b128 v[84:87], v15 offset:1024
    v_rsq_f32 v5, v5
    v_mfma_f32_16x16x32_bf16 v[120:123], a[36:39], v[20:23], v[120:123]
    v_mul_f32 v5, v5, v14
    v_add_f32 v11, v11, v2
    v_mfma_f32_16x16x32_bf16 v[128:131], a[36:39], v[36:39], v[128:131]
    v_max_f32_dpp v6, v5, v5 quad_perm:[1,0,3,2] row_mask:0xf bank_mask:0xf
    v_mov_b32 v2, v11
    v_mfma_f32_16x16x32_bf16 v[120:123], a[40:43], v[24:27], v[120:123]
    v_max_f32_dpp v6, v6, v6 quad_perm:[2,3,0,1] row_mask:0xf bank_mask:0xf
    v_permlane16_swap_b32 v11, v2
    v_mfma_f32_16x16x32_bf16 v[128:131], a[40:43], v[40:43], v[128:131]
    v_max_f32_dpp v6, v6, v6 row_half_mirror row_mask:0xf bank_mask:0xf
    v_sub_f32 v5, v5, v6
    v_mfma_f32_16x16x32_bf16 v[120:123], a[44:47], v[28:31], v[120:123]
    v_exp_f32 v5, v5
    v_mfma_f32_16x16x32_bf16 v[128:131], a[44:47], v[44:47], v[128:131]
    v_cndmask_b32_dpp v248, v96, v248, vcc row_ror:8 row_mask:0xf bank_mask:0xf
    v_add_f32_dpp v6, v5, v5 quad_perm:[1,0,3,2] row_mask:0xf bank_mask:0xf
    v_mfma_f32_16x16x32_bf16 v[124:127], a[48:51], v[16:19], 0
    v_mul_f32 v5, v5, v100
    v_add_f32_dpp v6, v6, v6 quad_perm:[2,3,0,1] row_mask:0xf bank_mask:0xf
    v_mfma_f32_16x16x32_bf16 v[132:135], a[48:51], v[32:35], 0
    buffer_load_dword v100, v102, s[8:11], s23 offen
    v_cvt_pk_bf16_f32 v144, v120, v121
    v_cvt_pk_bf16_f32 v145, v122, v123
    v_mfma_f32_16x16x32_bf16 v[124:127], a[52:55], v[20:23], v[124:127]
    v_cvt_pk_bf16_f32 v148, v128, v129
    v_cvt_pk_bf16_f32 v149, v130, v131
    v_mfma_f32_16x16x32_bf16 v[132:135], a[52:55], v[36:39], v[132:135]
    v_add_f32_dpp v6, v6, v6 row_half_mirror row_mask:0xf bank_mask:0xf
    v_rcp_f32 v6, v6
    v_mfma_f32_16x16x32_bf16 v[124:127], a[56:59], v[24:27], v[124:127]
    v_mul_f32 v5, v5, v6
    ds_write_b32 v4, v5 offset:512
    v_mfma_f32_16x16x32_bf16 v[132:135], a[56:59], v[40:43], v[132:135]
    ds_read_b128 v[64:67], v9 offset:512
    ds_read_b128 v[68:71], v9 offset:576
    v_add_f32 v11, v11, v2
    v_mfma_f32_16x16x32_bf16 v[124:127], a[60:63], v[28:31], v[124:127]
    v_mul_f32 v2, s28, v248
    v_mul_f32 v2, v2, v2
    v_mfma_f32_16x16x32_bf16 v[132:135], a[60:63], v[44:47], v[132:135]
    v_fma_f32 v11, v11, s28, -v2
    v_mul_f32 v2, v101, v101
    v_mfma_f32_16x16x32_bf16 v[104:107], a[64:67], v[16:19], 0
    v_max_f32 v11, 0, v11
    v_fma_f32 v11, v11, v2, s29
    v_mfma_f32_16x16x32_bf16 v[112:115], a[64:67], v[32:35], 0
    v_cvt_pk_bf16_f32 v146, v124, v125
    v_cvt_pk_bf16_f32 v147, v126, v127
    v_mfma_f32_16x16x32_bf16 v[104:107], a[68:71], v[20:23], v[104:107]
    v_cvt_pk_bf16_f32 v150, v132, v133
    v_cvt_pk_bf16_f32 v151, v134, v135
    v_mfma_f32_16x16x32_bf16 v[152:155], v[144:147], v[20:23], v[152:155]
    v_rsq_f32 v11, v11
    v_mfma_f32_16x16x32_bf16 v[156:159], v[148:151], v[36:39], v[156:159]
    s_waitcnt lgkmcnt(1)
    v_mul_f32 v48, v64, v168
    v_mfma_f32_16x16x32_bf16 v[112:115], a[68:71], v[36:39], v[112:115]
    v_fmac_f32 v48, v65, v169
    v_fmac_f32 v48, v66, v170
    v_mfma_f32_16x16x32_bf16 v[104:107], a[72:75], v[24:27], v[104:107]
    v_fmac_f32 v48, v67, v171
    v_mul_f32 v49, v64, v172
    v_mfma_f32_16x16x32_bf16 v[112:115], a[72:75], v[40:43], v[112:115]
    v_fmac_f32 v49, v65, v173
    v_fmac_f32 v49, v66, v174
    v_mfma_f32_16x16x32_bf16 v[104:107], a[76:79], v[28:31], v[104:107]
    v_fmac_f32 v49, v67, v175
    s_waitcnt lgkmcnt(0)
    v_mul_f32 v56, v68, v200
    v_mfma_f32_16x16x32_bf16 v[112:115], a[76:79], v[44:47], v[112:115]
    v_fmac_f32 v56, v69, v201
    v_fmac_f32 v56, v70, v202
    v_mfma_f32_16x16x32_bf16 v[108:111], a[80:83], v[16:19], 0
    v_fmac_f32 v56, v71, v203
    v_mul_f32 v57, v68, v204
    v_mfma_f32_16x16x32_bf16 v[116:119], a[80:83], v[32:35], 0
    v_cvt_pk_bf16_f32 v136, v104, v105
    v_cvt_pk_bf16_f32 v137, v106, v107
    v_mfma_f32_16x16x32_bf16 v[108:111], a[84:87], v[20:23], v[108:111]
    v_cvt_pk_bf16_f32 v140, v112, v113
    v_cvt_pk_bf16_f32 v141, v114, v115
    v_mfma_f32_16x16x32_bf16 v[116:119], a[84:87], v[36:39], v[116:119]
    v_fmac_f32 v57, v69, v205
    v_fmac_f32 v57, v70, v206
    v_mfma_f32_16x16x32_bf16 v[108:111], a[88:91], v[24:27], v[108:111]
    v_fmac_f32 v57, v71, v207
    v_mul_f32 v50, v64, v176
    v_mfma_f32_16x16x32_bf16 v[116:119], a[88:91], v[40:43], v[116:119]
    v_fmac_f32 v50, v65, v177
    v_fmac_f32 v50, v66, v178
    v_mfma_f32_16x16x32_bf16 v[108:111], a[92:95], v[28:31], v[108:111]
    v_fmac_f32 v50, v67, v179
    v_mul_f32 v51, v64, v180
    v_mfma_f32_16x16x32_bf16 v[116:119], a[92:95], v[44:47], v[116:119]
    v_fmac_f32 v51, v65, v181
    v_fmac_f32 v51, v66, v182
    v_mfma_f32_16x16x32_bf16 v[120:123], a[96:99], v[16:19], 0
    v_fmac_f32 v51, v67, v183
    v_mul_f32 v58, v68, v208
    v_mfma_f32_16x16x32_bf16 v[128:131], a[96:99], v[32:35], 0
    v_cvt_pk_bf16_f32 v138, v108, v109
    v_cvt_pk_bf16_f32 v139, v110, v111
    v_mfma_f32_16x16x32_bf16 v[120:123], a[100:103], v[20:23], v[120:123]
    v_cvt_pk_bf16_f32 v142, v116, v117
    v_cvt_pk_bf16_f32 v143, v118, v119
    v_mfma_f32_16x16x32_bf16 v[152:155], v[136:139], v[24:27], v[152:155]
    v_fmac_f32 v58, v69, v209
    v_fmac_f32 v58, v70, v210
    v_mfma_f32_16x16x32_bf16 v[156:159], v[140:143], v[40:43], v[156:159]
    v_fmac_f32 v58, v71, v211
    v_mul_f32 v59, v68, v212
    v_mfma_f32_16x16x32_bf16 v[128:131], a[100:103], v[36:39], v[128:131]
    v_fmac_f32 v59, v69, v213
    v_fmac_f32 v59, v70, v214
    v_mfma_f32_16x16x32_bf16 v[120:123], a[104:107], v[24:27], v[120:123]
    v_fmac_f32 v59, v71, v215
    v_mul_f32 v11, v11, v101
    v_mfma_f32_16x16x32_bf16 v[128:131], a[104:107], v[40:43], v[128:131]
    ds_write_b32 v4, v11
    ds_read_b128 v[244:247], v8
    v_mul_f32 v52, v64, v184
    v_mfma_f32_16x16x32_bf16 v[120:123], a[108:111], v[28:31], v[120:123]
    v_fmac_f32 v52, v65, v185
    v_fmac_f32 v52, v66, v186
    v_mfma_f32_16x16x32_bf16 v[128:131], a[108:111], v[44:47], v[128:131]
    v_fmac_f32 v52, v67, v187
    v_mul_f32 v53, v64, v188
    v_mfma_f32_16x16x32_bf16 v[124:127], a[112:115], v[16:19], 0
    v_fmac_f32 v53, v65, v189
    v_fmac_f32 v53, v66, v190
    v_mfma_f32_16x16x32_bf16 v[132:135], a[112:115], v[32:35], 0
    v_cvt_pk_bf16_f32 v144, v120, v121
    v_cvt_pk_bf16_f32 v145, v122, v123
    v_mfma_f32_16x16x32_bf16 v[124:127], a[116:119], v[20:23], v[124:127]
    v_cvt_pk_bf16_f32 v148, v128, v129
    v_cvt_pk_bf16_f32 v149, v130, v131
    v_mfma_f32_16x16x32_bf16 v[132:135], a[116:119], v[36:39], v[132:135]
    v_fmac_f32 v53, v67, v191
    v_mul_f32 v60, v68, v216
    v_mfma_f32_16x16x32_bf16 v[124:127], a[120:123], v[24:27], v[124:127]
    v_fmac_f32 v60, v69, v217
    v_fmac_f32 v60, v70, v218
    v_mfma_f32_16x16x32_bf16 v[132:135], a[120:123], v[40:43], v[132:135]
    v_fmac_f32 v60, v71, v219
    v_mul_f32 v61, v68, v220
    v_mfma_f32_16x16x32_bf16 v[124:127], a[124:127], v[28:31], v[124:127]
    v_fmac_f32 v61, v69, v221
    v_fmac_f32 v61, v70, v222
    v_mfma_f32_16x16x32_bf16 v[132:135], a[124:127], v[44:47], v[132:135]
    v_fmac_f32 v61, v71, v223
    v_mul_f32 v54, v64, v192
    v_mfma_f32_16x16x32_bf16 v[104:107], v[16:19], a[128:131], 0
    v_fmac_f32 v54, v65, v193
    v_fmac_f32 v54, v66, v194
    v_mfma_f32_16x16x32_bf16 v[112:115], v[32:35], a[128:131], 0
    v_cvt_pk_bf16_f32 v146, v124, v125
    v_cvt_pk_bf16_f32 v147, v126, v127
    v_mfma_f32_16x16x32_bf16 v[104:107], v[20:23], a[132:135], v[104:107]
    v_cvt_pk_bf16_f32 v150, v132, v133
    v_cvt_pk_bf16_f32 v151, v134, v135
    v_mfma_f32_16x16x32_bf16 v[152:155], v[144:147], v[28:31], v[152:155]
    v_fmac_f32 v54, v67, v195
    v_mul_f32 v55, v64, v196
    v_mfma_f32_16x16x32_bf16 v[156:159], v[148:151], v[44:47], v[156:159]
    v_fmac_f32 v55, v65, v197
    v_fmac_f32 v55, v66, v198
    v_mfma_f32_16x16x32_bf16 v[112:115], v[36:39], a[132:135], v[112:115]
    v_fmac_f32 v55, v67, v199
    v_mul_f32 v62, v68, v224
    v_mfma_f32_16x16x32_bf16 v[104:107], v[24:27], a[136:139], v[104:107]
    v_fmac_f32 v62, v69, v225
    v_fmac_f32 v62, v70, v226
    v_mfma_f32_16x16x32_bf16 v[112:115], v[40:43], a[136:139], v[112:115]
    v_cndmask_b32_dpp v152, v156, v152, vcc row_ror:8 row_mask:0xf bank_mask:0xf
    v_cndmask_b32_dpp v153, v157, v153, vcc row_ror:8 row_mask:0xf bank_mask:0xf
    v_mfma_f32_16x16x32_bf16 v[104:107], v[28:31], a[140:143], v[104:107]
    v_cndmask_b32_dpp v154, v158, v154, vcc row_ror:8 row_mask:0xf bank_mask:0xf
    v_cndmask_b32_dpp v155, v159, v155, vcc row_ror:8 row_mask:0xf bank_mask:0xf
    v_mfma_f32_16x16x32_bf16 v[112:115], v[44:47], a[140:143], v[112:115]
    s_waitcnt lgkmcnt(0)
    v_mul_f32 v152, v152, v244
    v_mfma_f32_16x16x32_bf16 v[108:111], v[16:19], a[144:147], 0
    v_mul_f32 v153, v153, v245
    v_mul_f32 v154, v154, v246
    v_mfma_f32_16x16x32_bf16 v[116:119], v[32:35], a[144:147], 0
    v_max3_f32 v156, v152, v153, v154
    v_mul_f32 v155, v155, v247
    v_mfma_f32_16x16x32_bf16 v[108:111], v[20:23], a[148:151], v[108:111]
    v_max_f32 v156, v156, v155
    v_mov_b32 v157, v156
    v_mfma_f32_16x16x32_bf16 v[116:119], v[36:39], a[148:151], v[116:119]
    v_fmac_f32 v62, v71, v227
    v_permlane16_swap_b32 v156, v157
    v_mfma_f32_16x16x32_bf16 v[108:111], v[24:27], a[152:155], v[108:111]
    v_max_f32 v156, v156, v157
    v_mul_f32 v156, v156, v11
    v_mfma_f32_16x16x32_bf16 v[116:119], v[40:43], a[152:155], v[116:119]
    v_fma_f32 v152, v152, v11, -v156
    v_fma_f32 v153, v153, v11, -v156
    v_mfma_f32_16x16x32_bf16 v[108:111], v[28:31], a[156:159], v[108:111]
    v_fma_f32 v154, v154, v11, -v156
    v_fma_f32 v155, v155, v11, -v156
    v_mfma_f32_16x16x32_bf16 v[116:119], v[44:47], a[156:159], v[116:119]
    v_exp_f32 v152, v152
    v_mfma_f32_16x16x32_bf16 v[168:171], v[16:19], v[232:235], 0
    v_exp_f32 v153, v153
    v_mfma_f32_16x16x32_bf16 v[172:175], v[16:19], v[236:239], 0
    v_exp_f32 v154, v154
    v_mfma_f32_16x16x32_bf16 v[200:203], v[32:35], v[232:235], 0
    v_exp_f32 v155, v155
    v_mfma_f32_16x16x32_bf16 v[204:207], v[32:35], v[236:239], 0
    v_add_f32 v156, v152, v153
    v_add_f32 v157, v154, v155
    v_mfma_f32_16x16x32_bf16 v[176:179], v[20:23], v[232:235], 0
    v_add_f32 v156, v156, v157
    v_mov_b32 v157, v156
    v_mfma_f32_16x16x32_bf16 v[180:183], v[20:23], v[236:239], 0
    v_mul_f32 v63, v68, v228
    v_permlane16_swap_b32 v156, v157
    v_mfma_f32_16x16x32_bf16 v[208:211], v[36:39], v[232:235], 0
    v_add_f32 v156, v156, v157
    v_mul_f32 v156, v156, v101
    v_mfma_f32_16x16x32_bf16 v[212:215], v[36:39], v[236:239], 0
    v_fmac_f32 v63, v69, v229
    v_rcp_f32 v156, v156
    v_mfma_f32_16x16x32_bf16 v[120:123], v[16:19], a[160:163], 0
    s_waitcnt vmcnt(1)
    s_barrier
    v_fmac_f32 v63, v70, v230
    v_fmac_f32 v63, v71, v231
    v_mfma_f32_16x16x32_bf16 v[128:131], v[32:35], a[160:163], 0
    buffer_load_dwordx4 v103, s[8:11], s21 offen offset:0 lds
    v_mfma_f32_16x16x32_bf16 v[120:123], v[20:23], a[164:167], v[120:123]
    v_mul_f32 v152, v152, v244
    v_mul_f32 v153, v153, v245
    v_mfma_f32_16x16x32_bf16 v[128:131], v[36:39], a[164:167], v[128:131]
    v_mul_f32 v154, v154, v246
    v_mul_f32 v155, v155, v247
    v_mfma_f32_16x16x32_bf16 v[120:123], v[24:27], a[168:171], v[120:123]
    v_mul_f32 v152, v152, v156
    v_mul_f32 v153, v153, v156
    v_mfma_f32_16x16x32_bf16 v[128:131], v[40:43], a[168:171], v[128:131]
    v_mul_f32 v154, v154, v156
    v_mul_f32 v155, v155, v156
    v_mfma_f32_16x16x32_bf16 v[120:123], v[28:31], a[172:175], v[120:123]
    v_cvt_pk_bf16_f32 v158, v152, v153
    v_cvt_pk_bf16_f32 v159, v154, v155
    v_mfma_f32_16x16x32_bf16 v[128:131], v[44:47], a[172:175], v[128:131]
    buffer_load_dwordx4 v103, s[8:11], s21 offen offset:1024 lds
    v_mfma_f32_16x16x32_bf16 v[124:127], v[16:19], a[176:179], 0
    v_cvt_pk_bf16_f32 v136, v104, v105
    v_cvt_pk_bf16_f32 v137, v106, v107
    v_mfma_f32_16x16x32_bf16 v[132:135], v[32:35], a[176:179], 0
    v_and_b32 v240, v158, v10
    v_and_b32 v241, v159, v10
    v_mfma_f32_16x16x32_bf16 v[124:127], v[20:23], a[180:183], v[124:127]
    v_cvt_pk_bf16_f32 v138, v108, v109
    v_cvt_pk_bf16_f32 v139, v110, v111
    v_mfma_f32_16x16x32_bf16 v[132:135], v[36:39], a[180:183], v[132:135]
    v_cvt_pk_bf16_f32 v140, v112, v113
    v_cvt_pk_bf16_f32 v141, v114, v115
    v_mfma_f32_16x16x32_bf16 v[124:127], v[24:27], a[184:187], v[124:127]
    v_and_b32_dpp v242, v158, v10 row_ror:8 row_mask:0xf bank_mask:0xf
    v_and_b32_dpp v243, v159, v10 row_ror:8 row_mask:0xf bank_mask:0xf
    v_mfma_f32_16x16x32_bf16 v[132:135], v[40:43], a[184:187], v[132:135]
    buffer_load_dwordx4 v103, s[8:11], s21 offen offset:2048 lds
    v_mfma_f32_16x16x32_bf16 v[124:127], v[28:31], a[188:191], v[124:127]
    v_cvt_pk_bf16_f32 v142, v116, v117
    v_cvt_pk_bf16_f32 v143, v118, v119
    v_mfma_f32_16x16x32_bf16 v[132:135], v[44:47], a[188:191], v[132:135]
    v_cvt_pk_bf16_f32 v144, v120, v121
    v_cvt_pk_bf16_f32 v145, v122, v123
    v_mfma_f32_16x16x32_bf16 v[184:187], v[24:27], v[232:235], 0
    v_cvt_pk_bf16_f32 v148, v128, v129
    v_cvt_pk_bf16_f32 v149, v130, v131
    v_mfma_f32_16x16x32_bf16 v[188:191], v[24:27], v[236:239], 0
    v_cvt_pk_bf16_f32 v146, v124, v125
    v_cvt_pk_bf16_f32 v147, v126, v127
    v_mfma_f32_16x16x32_bf16 v[216:219], v[40:43], v[232:235], 0
    v_cvt_pk_bf16_f32 v150, v132, v133
    v_cvt_pk_bf16_f32 v151, v134, v135
    v_mfma_f32_16x16x32_bf16 v[220:223], v[40:43], v[236:239], 0
    buffer_load_dwordx4 v103, s[8:11], s21 offen offset:3072 lds
    v_mfma_f32_16x16x32_bf16 v[192:195], v[28:31], v[232:235], 0
    s_add_u32 s21, s21, 4096
    v_permlane16_swap_b32 v48, v52
    v_mfma_f32_16x16x32_bf16 v[196:199], v[28:31], v[236:239], 0
    s_add_u32 m0, s44, 4096
    v_permlane16_swap_b32 v49, v53
    v_mfma_f32_16x16x32_bf16 v[224:227], v[44:47], v[232:235], 0
    v_permlane16_swap_b32 v50, v54
    v_mfma_f32_16x16x32_bf16 v[228:231], v[44:47], v[236:239], 0
    v_permlane16_swap_b32 v51, v55
    v_mfma_f32_16x16x16_bf16 v[168:171], v[240:241], v[136:137], v[168:171]
    v_add_f32 v48, v48, v52
    v_add_f32 v49, v49, v53
    v_mfma_f32_16x16x16_bf16 v[172:175], v[240:241], v[138:139], v[172:175]
    buffer_load_dwordx4 v103, s[8:11], s21 offen offset:0 lds
    v_mfma_f32_16x16x16_bf16 v[200:203], v[242:243], v[140:141], v[200:203]
    v_add_f32 v50, v50, v54
    v_add_f32 v51, v51, v55
    v_mfma_f32_16x16x16_bf16 v[204:207], v[242:243], v[142:143], v[204:207]
    v_cvt_pk_bf16_f32 v53, v48, v49
    v_cvt_pk_bf16_f32 v55, v50, v51
    v_mfma_f32_16x16x32_bf16 v[104:107], v[16:19], a[192:195], 0
    buffer_store_dword v53, v252, s[12:15], 0 offen offset:0 sc1
    buffer_store_dword v55, v252, s[12:15], 0 offen offset:64 sc1
    v_mul_f32 v48, v168, v168
    v_mfma_f32_16x16x32_bf16 v[112:115], v[32:35], a[192:195], 0
    v_mul_f32 v49, v169, v169
    v_mul_f32 v50, v170, v170
    v_mfma_f32_16x16x32_bf16 v[104:107], v[20:23], a[196:199], v[104:107]
    v_mul_f32 v51, v171, v171
    v_mul_f32 v52, v200, v200
    v_mfma_f32_16x16x32_bf16 v[112:115], v[36:39], a[196:199], v[112:115]
    buffer_load_dwordx4 v103, s[8:11], s21 offen offset:1024 lds
    v_mfma_f32_16x16x32_bf16 v[104:107], v[24:27], a[200:203], v[104:107]
    v_mul_f32 v53, v201, v201
    v_mul_f32 v54, v202, v202
    v_mfma_f32_16x16x32_bf16 v[112:115], v[40:43], a[200:203], v[112:115]
    v_mul_f32 v55, v203, v203
    v_fmac_f32 v48, v172, v172
    v_mfma_f32_16x16x32_bf16 v[104:107], v[28:31], a[204:207], v[104:107]
    v_fmac_f32 v49, v173, v173
    v_fmac_f32 v50, v174, v174
    v_mfma_f32_16x16x32_bf16 v[112:115], v[44:47], a[204:207], v[112:115]
    v_fmac_f32 v51, v175, v175
    v_fmac_f32 v52, v204, v204
    v_mfma_f32_16x16x32_bf16 v[108:111], v[16:19], a[208:211], 0
    v_fmac_f32 v53, v205, v205
    v_fmac_f32 v54, v206, v206
    v_mfma_f32_16x16x32_bf16 v[116:119], v[32:35], a[208:211], 0
    buffer_load_dwordx4 v103, s[8:11], s21 offen offset:2048 lds
    v_mfma_f32_16x16x32_bf16 v[108:111], v[20:23], a[212:215], v[108:111]
    v_cvt_pk_bf16_f32 v136, v104, v105
    v_cvt_pk_bf16_f32 v137, v106, v107
    v_mfma_f32_16x16x32_bf16 v[116:119], v[36:39], a[212:215], v[116:119]
    v_cvt_pk_bf16_f32 v140, v112, v113
    v_cvt_pk_bf16_f32 v141, v114, v115
    v_mfma_f32_16x16x32_bf16 v[108:111], v[24:27], a[216:219], v[108:111]
    v_fmac_f32 v55, v207, v207
    v_cndmask_b32_dpp v250, v98, v250, vcc row_ror:8 row_mask:0xf bank_mask:0xf
    v_mfma_f32_16x16x32_bf16 v[116:119], v[40:43], a[216:219], v[116:119]
    ds_write_b32 v4, v250 offset:128
    v_cndmask_b32_dpp v251, v99, v251, vcc row_ror:8 row_mask:0xf bank_mask:0xf
    ds_write_b32 v4, v251 offset:256
    v_mfma_f32_16x16x32_bf16 v[108:111], v[28:31], a[220:223], v[108:111]
    ds_read_b128 v[160:163], v8 offset:128
    ds_read_b128 v[164:167], v8 offset:256
    v_cndmask_b32_dpp v249, v97, v249, vcc row_ror:8 row_mask:0xf bank_mask:0xf
    v_mfma_f32_16x16x32_bf16 v[116:119], v[44:47], a[220:223], v[116:119]
    buffer_load_dwordx4 v103, s[8:11], s21 offen offset:3072 lds
    v_mfma_f32_16x16x16_bf16 v[176:179], v[240:241], v[144:145], v[176:179]
    s_add_u32 s21, s21, 4096
    v_permlane16_swap_b32 v56, v60
    v_mfma_f32_16x16x16_bf16 v[180:183], v[240:241], v[146:147], v[180:183]
    s_add_u32 m0, s44, 8192
    v_cvt_pk_bf16_f32 v138, v108, v109
    v_cvt_pk_bf16_f32 v139, v110, v111
    v_mfma_f32_16x16x16_bf16 v[208:211], v[242:243], v[148:149], v[208:211]
    v_cvt_pk_bf16_f32 v142, v116, v117
    v_cvt_pk_bf16_f32 v143, v118, v119
    v_mfma_f32_16x16x16_bf16 v[212:215], v[242:243], v[150:151], v[212:215]
    v_fmac_f32 v48, v176, v176
    v_fmac_f32 v49, v177, v177
    v_mfma_f32_16x16x32_bf16 v[120:123], v[16:19], a[224:227], 0
    v_fmac_f32 v50, v178, v178
    v_fmac_f32 v51, v179, v179
    v_mfma_f32_16x16x32_bf16 v[128:131], v[32:35], a[224:227], 0
    buffer_load_dwordx4 v12, s[8:11], s21 offen offset:0 lds
    v_mfma_f32_16x16x32_bf16 v[120:123], v[20:23], a[228:231], v[120:123]
    v_fmac_f32 v52, v208, v208
    v_fmac_f32 v53, v209, v209
    v_mfma_f32_16x16x32_bf16 v[128:131], v[36:39], a[228:231], v[128:131]
    v_fmac_f32 v54, v210, v210
    v_fmac_f32 v55, v211, v211
    v_mfma_f32_16x16x32_bf16 v[120:123], v[24:27], a[232:235], v[120:123]
    v_fmac_f32 v48, v180, v180
    v_fmac_f32 v49, v181, v181
    v_mfma_f32_16x16x32_bf16 v[128:131], v[40:43], a[232:235], v[128:131]
    v_fmac_f32 v50, v182, v182
    v_fmac_f32 v51, v183, v183
    v_mfma_f32_16x16x32_bf16 v[120:123], v[28:31], a[236:239], v[120:123]
    v_fmac_f32 v52, v212, v212
    v_fmac_f32 v53, v213, v213
    v_mfma_f32_16x16x32_bf16 v[128:131], v[44:47], a[236:239], v[128:131]
    buffer_load_dwordx4 v12, s[8:11], s21 offen offset:1024 lds
    v_mfma_f32_16x16x32_bf16 v[124:127], v[16:19], a[240:243], 0
    ds_read2st64_b32 v[16:17], v76 offset0:0 offset1:4
    ds_read2st64_b32 v[18:19], v77 offset0:0 offset1:4
    v_fmac_f32 v54, v214, v214
    v_mfma_f32_16x16x32_bf16 v[132:135], v[32:35], a[240:243], 0
    ds_read2st64_b32 v[32:33], v78 offset0:0 offset1:4
    v_cvt_pk_bf16_f32 v144, v120, v121
    v_cvt_pk_bf16_f32 v145, v122, v123
    v_mfma_f32_16x16x32_bf16 v[124:127], v[20:23], a[244:247], v[124:127]
    ds_read2st64_b32 v[34:35], v79 offset0:0 offset1:4
    v_cvt_pk_bf16_f32 v148, v128, v129
    v_cvt_pk_bf16_f32 v149, v130, v131
    v_mfma_f32_16x16x32_bf16 v[132:135], v[36:39], a[244:247], v[132:135]
    ds_read2st64_b32 v[20:21], v76 offset0:8 offset1:12
    ds_read2st64_b32 v[22:23], v77 offset0:8 offset1:12
    ds_read2st64_b32 v[36:37], v78 offset0:8 offset1:12
    v_mfma_f32_16x16x32_bf16 v[124:127], v[24:27], a[248:251], v[124:127]
    ds_read2st64_b32 v[38:39], v79 offset0:8 offset1:12
    ds_read2st64_b32 v[24:25], v76 offset0:16 offset1:20
    ds_read2st64_b32 v[26:27], v77 offset0:16 offset1:20
    v_mfma_f32_16x16x32_bf16 v[132:135], v[40:43], a[248:251], v[132:135]
    ds_read2st64_b32 v[40:41], v78 offset0:16 offset1:20
    ds_read2st64_b32 v[42:43], v79 offset0:16 offset1:20
    v_fmac_f32 v55, v215, v215
    v_mfma_f32_16x16x32_bf16 v[124:127], v[28:31], a[252:255], v[124:127]
    ds_read2st64_b32 v[28:29], v76 offset0:24 offset1:28
    ds_read2st64_b32 v[30:31], v77 offset0:24 offset1:28
    s_waitcnt lgkmcnt(15)
    v_mul_f32 v13, v152, v160
    v_mfma_f32_16x16x32_bf16 v[132:135], v[44:47], a[252:255], v[132:135]
    ds_read2st64_b32 v[44:45], v78 offset0:24 offset1:28
    ds_read2st64_b32 v[46:47], v79 offset0:24 offset1:28
    s_waitcnt lgkmcnt(15)
    v_mul_f32 v14, v152, v164
    v_mfma_f32_16x16x16_bf16 v[184:187], v[240:241], v[136:137], v[184:187]
    buffer_load_dwordx4 v12, s[8:11], s21 offen offset:2048 lds
    v_mfma_f32_16x16x16_bf16 v[188:191], v[240:241], v[138:139], v[188:191]
    v_cvt_pk_bf16_f32 v146, v124, v125
    v_cvt_pk_bf16_f32 v147, v126, v127
    v_mfma_f32_16x16x16_bf16 v[216:219], v[242:243], v[140:141], v[216:219]
    v_cvt_pk_bf16_f32 v150, v132, v133
    v_cvt_pk_bf16_f32 v151, v134, v135
    v_mfma_f32_16x16x16_bf16 v[220:223], v[242:243], v[142:143], v[220:223]
    v_fmac_f32 v48, v184, v184
    v_fmac_f32 v49, v185, v185
    v_mfma_f32_16x16x16_bf16 v[192:195], v[240:241], v[144:145], v[192:195]
    v_fmac_f32 v50, v186, v186
    v_fmac_f32 v51, v187, v187
    v_mfma_f32_16x16x16_bf16 v[196:199], v[240:241], v[146:147], v[196:199]
    v_fmac_f32 v52, v216, v216
    v_fmac_f32 v53, v217, v217
    v_mfma_f32_16x16x16_bf16 v[224:227], v[242:243], v[148:149], v[224:227]
    buffer_load_dwordx4 v12, s[8:11], s21 offen offset:3072 lds
    v_mfma_f32_16x16x16_bf16 v[228:231], v[242:243], v[150:151], v[228:231]
    s_add_u32 s21, s21, 4096
    v_fmac_f32 v54, v218, v218
    v_fmac_f32 v55, v219, v219
    s_waitcnt lgkmcnt(14)
    v_mfma_f32_16x16x32_bf16 v[104:107], a[0:3], v[16:19], 0
    s_add_u32 m0, s44, 12288
    v_fmac_f32 v48, v188, v188
    v_fmac_f32 v49, v189, v189
    s_waitcnt lgkmcnt(12)
    v_mfma_f32_16x16x32_bf16 v[112:115], a[0:3], v[32:35], 0
    v_fmac_f32 v50, v190, v190
    v_fmac_f32 v51, v191, v191
    s_waitcnt lgkmcnt(10)
    v_mfma_f32_16x16x32_bf16 v[104:107], a[4:7], v[20:23], v[104:107]
    v_fmac_f32 v52, v220, v220
    v_fmac_f32 v53, v221, v221
    s_waitcnt lgkmcnt(8)
    v_mfma_f32_16x16x32_bf16 v[112:115], a[4:7], v[36:39], v[112:115]
    buffer_load_dwordx4 v12, s[8:11], s21 offen offset:0 lds
    s_waitcnt lgkmcnt(6)
    v_mfma_f32_16x16x32_bf16 v[104:107], a[8:11], v[24:27], v[104:107]
    v_fmac_f32 v54, v222, v222
    v_fmac_f32 v55, v223, v223
    s_waitcnt lgkmcnt(4)
    v_mfma_f32_16x16x32_bf16 v[112:115], a[8:11], v[40:43], v[112:115]
    v_fmac_f32 v48, v192, v192
    v_fmac_f32 v49, v193, v193
    s_waitcnt lgkmcnt(2)
    v_mfma_f32_16x16x32_bf16 v[104:107], a[12:15], v[28:31], v[104:107]
    v_fmac_f32 v50, v194, v194
    v_fmac_f32 v51, v195, v195
    s_waitcnt lgkmcnt(0)
    v_mfma_f32_16x16x32_bf16 v[112:115], a[12:15], v[44:47], v[112:115]
    v_fmac_f32 v52, v224, v224
    v_fmac_f32 v53, v225, v225
    v_mfma_f32_16x16x32_bf16 v[108:111], a[16:19], v[16:19], 0
    buffer_load_dwordx4 v12, s[8:11], s21 offen offset:1024 lds
    v_mfma_f32_16x16x32_bf16 v[116:119], a[16:19], v[32:35], 0
    v_fmac_f32 v54, v226, v226
    v_fmac_f32 v55, v227, v227
    v_mfma_f32_16x16x32_bf16 v[108:111], a[20:23], v[20:23], v[108:111]
    v_fmac_f32 v48, v196, v196
    v_fmac_f32 v49, v197, v197
    v_mfma_f32_16x16x32_bf16 v[116:119], a[20:23], v[36:39], v[116:119]
    v_fmac_f32 v50, v198, v198
    v_fmac_f32 v51, v199, v199
    v_mfma_f32_16x16x32_bf16 v[108:111], a[24:27], v[24:27], v[108:111]
    v_fmac_f32 v52, v228, v228
    v_fmac_f32 v53, v229, v229
    v_mfma_f32_16x16x32_bf16 v[116:119], a[24:27], v[40:43], v[116:119]
    v_fmac_f32 v54, v230, v230
    v_fmac_f32 v55, v231, v231
    v_mfma_f32_16x16x32_bf16 v[108:111], a[28:31], v[28:31], v[108:111]
    buffer_load_dwordx4 v12, s[8:11], s21 offen offset:2048 lds
    v_mfma_f32_16x16x32_bf16 v[116:119], a[28:31], v[44:47], v[116:119]
    v_cvt_pk_bf16_f32 v64, v48, v49
    v_cvt_pk_bf16_f32 v65, v50, v51
    v_mfma_f32_16x16x32_bf16 v[120:123], v[16:19], v[16:19], 0
    v_cvt_pk_bf16_f32 v66, v52, v53
    v_cvt_pk_bf16_f32 v67, v54, v55
    v_mfma_f32_16x16x32_bf16 v[124:127], v[32:35], v[32:35], 0
    v_fmac_f32 v13, v153, v161
    v_fmac_f32 v14, v153, v165
    v_mfma_f32_16x16x32_bf16 v[68:71], v[64:67], v[88:91], 0
    v_fmac_f32 v13, v154, v162
    v_fmac_f32 v14, v154, v166
    v_mfma_f32_16x16x32_bf16 v[72:75], v[64:67], v[92:95], 0
    v_fmac_f32 v13, v155, v163
    v_fmac_f32 v14, v155, v167
    v_mfma_f32_16x16x32_bf16 v[120:123], v[20:23], v[20:23], v[120:123]
    buffer_load_dwordx4 v12, s[8:11], s21 offen offset:3072 lds
    v_mfma_f32_16x16x32_bf16 v[124:127], v[36:39], v[36:39], v[124:127]
    s_mul_i32 s21, s63, 65664
    v_permlane16_swap_b32 v13, v14
    v_mfma_f32_16x16x32_bf16 v[120:123], v[24:27], v[24:27], v[120:123]
    v_add_f32 v13, v13, v14
    v_mov_b32 v14, v13
    v_mfma_f32_16x16x32_bf16 v[124:127], v[40:43], v[40:43], v[124:127]
    v_cvt_pk_bf16_f32 v136, v104, v105
    v_permlane16_swap_b32 v13, v14
    v_mfma_f32_16x16x32_bf16 v[120:123], v[28:31], v[28:31], v[120:123]
    v_add_f32 v13, v13, v248
    v_add_f32 v14, v14, v249
    v_mfma_f32_16x16x32_bf16 v[248:251], v[80:83], v[16:19], 0
    v_cvt_pk_bf16_f32 v137, v106, v107
    v_cvt_pk_bf16_f32 v138, v108, v109
    v_mfma_f32_16x16x32_bf16 v[96:99], v[80:83], v[32:35], 0
    ds_read_b128 v[80:83], v15 offset:2048
    v_cvt_pk_bf16_f32 v139, v110, v111
    v_cvt_pk_bf16_f32 v140, v112, v113
    v_mfma_f32_16x16x32_bf16 v[124:127], v[44:47], v[44:47], v[124:127]
    v_cvt_pk_bf16_f32 v141, v114, v115
    v_cvt_pk_bf16_f32 v142, v116, v117
    v_mfma_f32_16x16x32_bf16 v[248:251], v[84:87], v[20:23], v[248:251]
    v_cvt_pk_bf16_f32 v143, v118, v119
    v_cndmask_b32 v120, v120, v121, s[32:33]
    v_mfma_f32_16x16x32_bf16 v[96:99], v[84:87], v[36:39], v[96:99]
    ds_read_b128 v[84:87], v15 offset:3072
    v_cndmask_b32 v120, v120, v122, s[34:35]
    v_cndmask_b32 v124, v124, v125, s[32:33]
    v_mfma_f32_16x16x32_bf16 v[152:155], v[136:139], v[16:19], 0
    v_cndmask_b32 v124, v124, v126, s[34:35]
    v_cndmask_b32 v120, v120, v123, s[36:37]
    v_mfma_f32_16x16x32_bf16 v[156:159], v[140:143], v[32:35], 0
    v_cndmask_b32 v124, v124, v127, s[36:37]
    v_cndmask_b32 v11, 0, v120, s[38:39]
    v_mfma_f32_16x16x32_bf16 v[128:131], a[32:35], v[32:35], 0
    v_cndmask_b32 v2, 0, v120, s[38:39]
    v_cndmask_b32 v122, 0, v124, s[38:39]
    s_waitcnt lgkmcnt(1)
    v_mfma_f32_16x16x32_bf16 v[248:251], v[80:83], v[24:27], v[248:251]
    v_permlane16_swap_b32 v57, v61
    v_mfma_f32_16x16x32_bf16 v[96:99], v[80:83], v[40:43], v[96:99]
    ds_read_b128 v[80:83], v15 offset:0
    v_mov_b32_dpp v11, v122 row_ror:8 row_mask:0xf bank_mask:0xc
    v_mov_b32_dpp v2, v122 row_ror:8 row_mask:0xf bank_mask:0x3
    v_mfma_f32_16x16x32_bf16 v[120:123], a[32:35], v[16:19], 0
    v_permlane16_swap_b32 v58, v62
    s_waitcnt lgkmcnt(1)
    v_mfma_f32_16x16x32_bf16 v[248:251], v[84:87], v[28:31], v[248:251]
    v_permlane16_swap_b32 v59, v63
    v_mfma_f32_16x16x32_bf16 v[96:99], v[84:87], v[44:47], v[96:99]
    ds_read_b128 v[84:87], v15 offset:1024
    v_add_f32 v56, v56, v60
    v_add_f32 v57, v57, v61
    v_mfma_f32_16x16x32_bf16 v[120:123], a[36:39], v[20:23], v[120:123]
    v_add_f32 v58, v58, v62
    v_add_f32 v59, v59, v63
    v_mfma_f32_16x16x32_bf16 v[128:131], a[36:39], v[36:39], v[128:131]
    v_cvt_pk_bf16_f32 v61, v56, v57
    v_cvt_pk_bf16_f32 v63, v58, v59
    v_mfma_f32_16x16x32_bf16 v[120:123], a[40:43], v[24:27], v[120:123]
    buffer_store_dword v61, v253, s[12:15], 0 offen offset:0 sc1
    buffer_store_dword v63, v253, s[12:15], 0 offen offset:64 sc1
    buffer_load_dwordx2 v[252:253], v3, s[8:11], s23 offen
    v_mfma_f32_16x16x32_bf16 v[128:131], a[40:43], v[40:43], v[128:131]
    s_lshl_b32 s23, s55, 4
    v_add_f32 v68, v68, v69
    v_add_f32 v70, v70, v71
    v_mfma_f32_16x16x32_bf16 v[120:123], a[44:47], v[28:31], v[120:123]
    s_add_u32 s23, s23, 131072
    v_add_f32 v72, v72, v73
    v_add_f32 v74, v74, v75
    v_mfma_f32_16x16x32_bf16 v[128:131], a[44:47], v[44:47], v[128:131]
    v_add_f32 v68, v68, v70
    v_add_f32 v72, v72, v74
    v_mfma_f32_16x16x32_bf16 v[124:127], a[48:51], v[16:19], 0
    v_mul_f32 v13, s28, v13
    v_cvt_pk_bf16_f32 v144, v120, v121
    v_mfma_f32_16x16x32_bf16 v[132:135], a[48:51], v[32:35], 0
    v_cvt_pk_bf16_f32 v145, v122, v123
    v_permlane32_swap_b32 v68, v72
    v_mfma_f32_16x16x32_bf16 v[124:127], a[52:55], v[20:23], v[124:127]
    v_cvt_pk_bf16_f32 v148, v128, v129
    v_cvt_pk_bf16_f32 v149, v130, v131
    v_mfma_f32_16x16x32_bf16 v[132:135], a[52:55], v[36:39], v[132:135]
    v_add_f32 v5, v68, v72
    v_mov_b32 v72, v5
    v_mfma_f32_16x16x32_bf16 v[124:127], a[56:59], v[24:27], v[124:127]
    v_fma_f32 v14, -v13, s24, v14
    v_permlane16_swap_b32 v5, v72
    v_mfma_f32_16x16x32_bf16 v[132:135], a[56:59], v[40:43], v[132:135]
    v_add_f32 v5, v5, v72
    v_mul_f32 v13, v13, v13
    v_mfma_f32_16x16x32_bf16 v[124:127], a[60:63], v[28:31], v[124:127]
    v_fma_f32 v5, v5, s28, -v13
    v_mul_f32 v6, v101, v101
    v_mfma_f32_16x16x32_bf16 v[132:135], a[60:63], v[44:47], v[132:135]
    v_max_f32 v5, 0, v5
    v_fma_f32 v5, v5, v6, s29
    v_mfma_f32_16x16x32_bf16 v[104:107], a[64:67], v[16:19], 0
    v_rsq_f32 v5, v5
    v_mfma_f32_16x16x32_bf16 v[112:115], a[64:67], v[32:35], 0
    v_cvt_pk_bf16_f32 v146, v124, v125
    v_cvt_pk_bf16_f32 v147, v126, v127
    v_mfma_f32_16x16x32_bf16 v[104:107], a[68:71], v[20:23], v[104:107]
    v_cvt_pk_bf16_f32 v150, v132, v133
    v_cvt_pk_bf16_f32 v151, v134, v135
    v_mfma_f32_16x16x32_bf16 v[152:155], v[144:147], v[20:23], v[152:155]
    v_mul_f32 v14, s30, v14
    v_mul_f32 v14, v14, v101
    v_mfma_f32_16x16x32_bf16 v[156:159], v[148:151], v[36:39], v[156:159]
    v_mul_f32 v5, v5, v14
    v_permlane32_swap_b32 v11, v2
    v_mfma_f32_16x16x32_bf16 v[112:115], a[68:71], v[36:39], v[112:115]
    v_max_f32_dpp v6, v5, v5 quad_perm:[1,0,3,2] row_mask:0xf bank_mask:0xf
    v_add_f32 v11, v11, v2
    v_mfma_f32_16x16x32_bf16 v[104:107], a[72:75], v[24:27], v[104:107]
    v_max_f32_dpp v6, v6, v6 quad_perm:[2,3,0,1] row_mask:0xf bank_mask:0xf
    v_mov_b32 v2, v11
    v_mfma_f32_16x16x32_bf16 v[112:115], a[72:75], v[40:43], v[112:115]
    v_max_f32_dpp v6, v6, v6 row_half_mirror row_mask:0xf bank_mask:0xf
    v_sub_f32 v5, v5, v6
    v_mfma_f32_16x16x32_bf16 v[104:107], a[76:79], v[28:31], v[104:107]
    v_exp_f32 v5, v5
    v_mfma_f32_16x16x32_bf16 v[112:115], a[76:79], v[44:47], v[112:115]
    v_permlane16_swap_b32 v11, v2
    v_mfma_f32_16x16x32_bf16 v[108:111], a[80:83], v[16:19], 0
    v_add_f32_dpp v6, v5, v5 quad_perm:[1,0,3,2] row_mask:0xf bank_mask:0xf
    v_mul_f32 v5, v5, v101
    v_mfma_f32_16x16x32_bf16 v[116:119], a[80:83], v[32:35], 0
    buffer_load_dword v101, v102, s[8:11], s23 offen
    v_cvt_pk_bf16_f32 v136, v104, v105
    v_cvt_pk_bf16_f32 v137, v106, v107
    v_mfma_f32_16x16x32_bf16 v[108:111], a[84:87], v[20:23], v[108:111]
    v_cvt_pk_bf16_f32 v140, v112, v113
    v_cvt_pk_bf16_f32 v141, v114, v115
    v_mfma_f32_16x16x32_bf16 v[116:119], a[84:87], v[36:39], v[116:119]
    v_add_f32_dpp v6, v6, v6 quad_perm:[2,3,0,1] row_mask:0xf bank_mask:0xf
    v_cndmask_b32_dpp v248, v96, v248, vcc row_ror:8 row_mask:0xf bank_mask:0xf
    v_mfma_f32_16x16x32_bf16 v[108:111], a[88:91], v[24:27], v[108:111]
    v_add_f32_dpp v6, v6, v6 row_half_mirror row_mask:0xf bank_mask:0xf
    v_rcp_f32 v6, v6
    v_mfma_f32_16x16x32_bf16 v[116:119], a[88:91], v[40:43], v[116:119]
    v_mul_f32 v5, v5, v6
    ds_write_b32 v4, v5 offset:512
    v_mfma_f32_16x16x32_bf16 v[108:111], a[92:95], v[28:31], v[108:111]
    ds_read_b128 v[64:67], v9 offset:512
    ds_read_b128 v[68:71], v9 offset:576
    v_add_f32 v11, v11, v2
    v_mfma_f32_16x16x32_bf16 v[116:119], a[92:95], v[44:47], v[116:119]
    v_mul_f32 v2, s28, v248
    v_mul_f32 v2, v2, v2
    v_mfma_f32_16x16x32_bf16 v[120:123], a[96:99], v[16:19], 0
    v_fma_f32 v11, v11, s28, -v2
    v_cvt_pk_bf16_f32 v138, v108, v109
    v_mfma_f32_16x16x32_bf16 v[128:131], a[96:99], v[32:35], 0
    v_cvt_pk_bf16_f32 v139, v110, v111
    s_waitcnt vmcnt(22)
    v_mul_f32 v2, v100, v100
    v_mfma_f32_16x16x32_bf16 v[120:123], a[100:103], v[20:23], v[120:123]
    v_cvt_pk_bf16_f32 v142, v116, v117
    v_cvt_pk_bf16_f32 v143, v118, v119
    v_mfma_f32_16x16x32_bf16 v[152:155], v[136:139], v[24:27], v[152:155]
    v_max_f32 v11, 0, v11
    v_fma_f32 v11, v11, v2, s29
    v_mfma_f32_16x16x32_bf16 v[156:159], v[140:143], v[40:43], v[156:159]
    v_rsq_f32 v11, v11
    v_mfma_f32_16x16x32_bf16 v[128:131], a[100:103], v[36:39], v[128:131]
    s_waitcnt lgkmcnt(1)
    v_mul_f32 v48, v64, v168
    v_mfma_f32_16x16x32_bf16 v[120:123], a[104:107], v[24:27], v[120:123]
    v_fmac_f32 v48, v65, v169
    v_fmac_f32 v48, v66, v170
    v_mfma_f32_16x16x32_bf16 v[128:131], a[104:107], v[40:43], v[128:131]
    v_fmac_f32 v48, v67, v171
    v_mul_f32 v49, v64, v172
    v_mfma_f32_16x16x32_bf16 v[120:123], a[108:111], v[28:31], v[120:123]
    v_fmac_f32 v49, v65, v173
    v_fmac_f32 v49, v66, v174
    v_mfma_f32_16x16x32_bf16 v[128:131], a[108:111], v[44:47], v[128:131]
    v_fmac_f32 v49, v67, v175
    s_waitcnt lgkmcnt(0)
    v_mul_f32 v56, v68, v200
    v_mfma_f32_16x16x32_bf16 v[124:127], a[112:115], v[16:19], 0
    v_fmac_f32 v56, v69, v201
    v_fmac_f32 v56, v70, v202
    v_mfma_f32_16x16x32_bf16 v[132:135], a[112:115], v[32:35], 0
    v_cvt_pk_bf16_f32 v144, v120, v121
    v_cvt_pk_bf16_f32 v145, v122, v123
    v_mfma_f32_16x16x32_bf16 v[124:127], a[116:119], v[20:23], v[124:127]
    v_cvt_pk_bf16_f32 v148, v128, v129
    v_cvt_pk_bf16_f32 v149, v130, v131
    v_mfma_f32_16x16x32_bf16 v[132:135], a[116:119], v[36:39], v[132:135]
    v_fmac_f32 v56, v71, v203
    v_mul_f32 v57, v68, v204
    v_mfma_f32_16x16x32_bf16 v[124:127], a[120:123], v[24:27], v[124:127]
    v_fmac_f32 v57, v69, v205
    v_fmac_f32 v57, v70, v206
    v_mfma_f32_16x16x32_bf16 v[132:135], a[120:123], v[40:43], v[132:135]
    v_fmac_f32 v57, v71, v207
    v_mul_f32 v50, v64, v176
    v_mfma_f32_16x16x32_bf16 v[124:127], a[124:127], v[28:31], v[124:127]
    v_fmac_f32 v50, v65, v177
    v_fmac_f32 v50, v66, v178
    v_mfma_f32_16x16x32_bf16 v[132:135], a[124:127], v[44:47], v[132:135]
    v_fmac_f32 v50, v67, v179
    v_mul_f32 v51, v64, v180
    v_mfma_f32_16x16x32_bf16 v[104:107], v[16:19], a[128:131], 0
    v_fmac_f32 v51, v65, v181
    v_fmac_f32 v51, v66, v182
    v_mfma_f32_16x16x32_bf16 v[112:115], v[32:35], a[128:131], 0
    v_cvt_pk_bf16_f32 v146, v124, v125
    v_cvt_pk_bf16_f32 v147, v126, v127
    v_mfma_f32_16x16x32_bf16 v[104:107], v[20:23], a[132:135], v[104:107]
    v_cvt_pk_bf16_f32 v150, v132, v133
    v_cvt_pk_bf16_f32 v151, v134, v135
    v_mfma_f32_16x16x32_bf16 v[152:155], v[144:147], v[28:31], v[152:155]
    v_fmac_f32 v51, v67, v183
    v_mul_f32 v58, v68, v208
    v_mfma_f32_16x16x32_bf16 v[156:159], v[148:151], v[44:47], v[156:159]
    v_fmac_f32 v58, v69, v209
    v_fmac_f32 v58, v70, v210
    v_mfma_f32_16x16x32_bf16 v[112:115], v[36:39], a[132:135], v[112:115]
    v_fmac_f32 v58, v71, v211
    v_mul_f32 v59, v68, v212
    v_mfma_f32_16x16x32_bf16 v[104:107], v[24:27], a[136:139], v[104:107]
    v_fmac_f32 v59, v69, v213
    v_fmac_f32 v59, v70, v214
    v_mfma_f32_16x16x32_bf16 v[112:115], v[40:43], a[136:139], v[112:115]
    v_fmac_f32 v59, v71, v215
    v_mul_f32 v11, v11, v100
    v_mfma_f32_16x16x32_bf16 v[104:107], v[28:31], a[140:143], v[104:107]
    ds_write_b32 v4, v11
    ds_read_b128 v[244:247], v8
    v_mul_f32 v52, v64, v184
    v_mfma_f32_16x16x32_bf16 v[112:115], v[44:47], a[140:143], v[112:115]
    v_fmac_f32 v52, v65, v185
    v_fmac_f32 v52, v66, v186
    v_mfma_f32_16x16x32_bf16 v[108:111], v[16:19], a[144:147], 0
    v_fmac_f32 v52, v67, v187
    v_mul_f32 v53, v64, v188
    v_mfma_f32_16x16x32_bf16 v[116:119], v[32:35], a[144:147], 0
    v_fmac_f32 v53, v65, v189
    v_fmac_f32 v53, v66, v190
    v_mfma_f32_16x16x32_bf16 v[108:111], v[20:23], a[148:151], v[108:111]
    v_fmac_f32 v53, v67, v191
    v_mul_f32 v60, v68, v216
    v_mfma_f32_16x16x32_bf16 v[116:119], v[36:39], a[148:151], v[116:119]
    v_fmac_f32 v60, v69, v217
    v_fmac_f32 v60, v70, v218
    v_mfma_f32_16x16x32_bf16 v[108:111], v[24:27], a[152:155], v[108:111]
    v_fmac_f32 v60, v71, v219
    v_cndmask_b32_dpp v152, v156, v152, vcc row_ror:8 row_mask:0xf bank_mask:0xf
    v_mfma_f32_16x16x32_bf16 v[116:119], v[40:43], a[152:155], v[116:119]
    v_cndmask_b32_dpp v153, v157, v153, vcc row_ror:8 row_mask:0xf bank_mask:0xf
    v_cndmask_b32_dpp v154, v158, v154, vcc row_ror:8 row_mask:0xf bank_mask:0xf
    v_mfma_f32_16x16x32_bf16 v[108:111], v[28:31], a[156:159], v[108:111]
    v_mul_f32 v61, v68, v220
    v_cndmask_b32_dpp v155, v159, v155, vcc row_ror:8 row_mask:0xf bank_mask:0xf
    v_mfma_f32_16x16x32_bf16 v[116:119], v[44:47], a[156:159], v[116:119]
    s_waitcnt lgkmcnt(0)
    v_mul_f32 v152, v152, v244
    v_mfma_f32_16x16x32_bf16 v[168:171], v[16:19], v[232:235], 0
    v_mul_f32 v153, v153, v245
    v_mul_f32 v154, v154, v246
    v_mfma_f32_16x16x32_bf16 v[172:175], v[16:19], v[236:239], 0
    v_fmac_f32 v61, v69, v221
    v_max3_f32 v156, v152, v153, v154
    v_mfma_f32_16x16x32_bf16 v[200:203], v[32:35], v[232:235], 0
    v_mul_f32 v155, v155, v247
    v_fmac_f32 v61, v70, v222
    v_mfma_f32_16x16x32_bf16 v[204:207], v[32:35], v[236:239], 0
    v_max_f32 v156, v156, v155
    v_fmac_f32 v61, v71, v223
    v_mfma_f32_16x16x32_bf16 v[176:179], v[20:23], v[232:235], 0
    v_mov_b32 v157, v156
    v_mul_f32 v54, v64, v192
    v_mfma_f32_16x16x32_bf16 v[180:183], v[20:23], v[236:239], 0
    v_permlane16_swap_b32 v156, v157
    v_mfma_f32_16x16x32_bf16 v[208:211], v[36:39], v[232:235], 0
    v_fmac_f32 v54, v65, v193
    v_fmac_f32 v54, v66, v194
    v_mfma_f32_16x16x32_bf16 v[212:215], v[36:39], v[236:239], 0
    v_max_f32 v156, v156, v157
    v_fmac_f32 v54, v67, v195
    v_mfma_f32_16x16x32_bf16 v[120:123], v[16:19], a[160:163], 0
    v_mul_f32 v156, v156, v11
    v_fma_f32 v152, v152, v11, -v156
    v_mfma_f32_16x16x32_bf16 v[128:131], v[32:35], a[160:163], 0
    v_fma_f32 v153, v153, v11, -v156
    v_fma_f32 v154, v154, v11, -v156
    v_mfma_f32_16x16x32_bf16 v[120:123], v[20:23], a[164:167], v[120:123]
    v_fma_f32 v155, v155, v11, -v156
    v_mul_f32 v55, v64, v196
    v_mfma_f32_16x16x32_bf16 v[128:131], v[36:39], a[164:167], v[128:131]
    v_exp_f32 v152, v152
    v_mfma_f32_16x16x32_bf16 v[120:123], v[24:27], a[168:171], v[120:123]
    v_exp_f32 v153, v153
    v_mfma_f32_16x16x32_bf16 v[128:131], v[40:43], a[168:171], v[128:131]
    v_exp_f32 v154, v154
    v_mfma_f32_16x16x32_bf16 v[120:123], v[28:31], a[172:175], v[120:123]
    v_exp_f32 v155, v155
    v_mfma_f32_16x16x32_bf16 v[128:131], v[44:47], a[172:175], v[128:131]
    v_fmac_f32 v55, v65, v197
    v_fmac_f32 v55, v66, v198
    v_mfma_f32_16x16x32_bf16 v[124:127], v[16:19], a[176:179], 0
    v_fmac_f32 v55, v67, v199
    v_add_f32 v156, v152, v153
    v_mfma_f32_16x16x32_bf16 v[132:135], v[32:35], a[176:179], 0
    v_add_f32 v157, v154, v155
    v_add_f32 v156, v156, v157
    v_mfma_f32_16x16x32_bf16 v[124:127], v[20:23], a[180:183], v[124:127]
    v_mov_b32 v157, v156
    v_mul_f32 v62, v68, v224
    v_mfma_f32_16x16x32_bf16 v[132:135], v[36:39], a[180:183], v[132:135]
    v_fmac_f32 v62, v69, v225
    v_fmac_f32 v62, v70, v226
    v_mfma_f32_16x16x32_bf16 v[124:127], v[24:27], a[184:187], v[124:127]
    v_permlane16_swap_b32 v156, v157
    v_mfma_f32_16x16x32_bf16 v[132:135], v[40:43], a[184:187], v[132:135]
    v_fmac_f32 v62, v71, v227
    v_add_f32 v156, v156, v157
    v_mfma_f32_16x16x32_bf16 v[124:127], v[28:31], a[188:191], v[124:127]
    v_mul_f32 v63, v68, v228
    v_mul_f32 v156, v156, v100
    v_mfma_f32_16x16x32_bf16 v[132:135], v[44:47], a[188:191], v[132:135]
    v_fmac_f32 v63, v69, v229
    v_rcp_f32 v156, v156
    v_mfma_f32_16x16x32_bf16 v[184:187], v[24:27], v[232:235], 0
    v_fmac_f32 v63, v70, v230
    v_fmac_f32 v63, v71, v231
    v_mfma_f32_16x16x32_bf16 v[188:191], v[24:27], v[236:239], 0
    v_mul_f32 v152, v152, v244
    v_mul_f32 v153, v153, v245
    v_mfma_f32_16x16x32_bf16 v[216:219], v[40:43], v[232:235], 0
    v_mul_f32 v154, v154, v246
    v_mul_f32 v155, v155, v247
    v_mfma_f32_16x16x32_bf16 v[220:223], v[40:43], v[236:239], 0
    v_mul_f32 v152, v152, v156
    v_mul_f32 v153, v153, v156
    v_mfma_f32_16x16x32_bf16 v[192:195], v[28:31], v[232:235], 0
    v_mul_f32 v154, v154, v156
    v_mul_f32 v155, v155, v156
    v_mfma_f32_16x16x32_bf16 v[196:199], v[28:31], v[236:239], 0
    v_cvt_pk_bf16_f32 v158, v152, v153
    v_cvt_pk_bf16_f32 v159, v154, v155
    v_mfma_f32_16x16x32_bf16 v[224:227], v[44:47], v[232:235], 0
    v_cvt_pk_bf16_f32 v136, v104, v105
    v_cvt_pk_bf16_f32 v137, v106, v107
    v_mfma_f32_16x16x32_bf16 v[228:231], v[44:47], v[236:239], 0
    v_and_b32 v240, v158, v10
    v_and_b32 v241, v159, v10
    v_mfma_f32_16x16x32_bf16 v[104:107], v[16:19], a[192:195], 0
    v_cvt_pk_bf16_f32 v138, v108, v109
    v_cvt_pk_bf16_f32 v139, v110, v111
    v_mfma_f32_16x16x16_bf16 v[168:171], v[240:241], v[136:137], v[168:171]
    v_cvt_pk_bf16_f32 v140, v112, v113
    v_cvt_pk_bf16_f32 v141, v114, v115
    v_mfma_f32_16x16x16_bf16 v[172:175], v[240:241], v[138:139], v[172:175]
    v_and_b32_dpp v242, v158, v10 row_ror:8 row_mask:0xf bank_mask:0xf
    v_and_b32_dpp v243, v159, v10 row_ror:8 row_mask:0xf bank_mask:0xf
    v_mfma_f32_16x16x32_bf16 v[112:115], v[32:35], a[192:195], 0
    v_cvt_pk_bf16_f32 v142, v116, v117
    v_cvt_pk_bf16_f32 v143, v118, v119
    v_mfma_f32_16x16x16_bf16 v[200:203], v[242:243], v[140:141], v[200:203]
    v_cvt_pk_bf16_f32 v144, v120, v121
    v_cvt_pk_bf16_f32 v145, v122, v123
    v_mfma_f32_16x16x16_bf16 v[204:207], v[242:243], v[142:143], v[204:207]
    v_cvt_pk_bf16_f32 v146, v124, v125
    v_cvt_pk_bf16_f32 v147, v126, v127
    v_mfma_f32_16x16x32_bf16 v[104:107], v[20:23], a[196:199], v[104:107]
    v_cvt_pk_bf16_f32 v148, v128, v129
    v_cvt_pk_bf16_f32 v149, v130, v131
    v_mfma_f32_16x16x32_bf16 v[112:115], v[36:39], a[196:199], v[112:115]
    v_cvt_pk_bf16_f32 v150, v132, v133
    v_cvt_pk_bf16_f32 v151, v134, v135
    v_mfma_f32_16x16x32_bf16 v[104:107], v[24:27], a[200:203], v[104:107]
    v_xor_b32 v76, 65600, v1
    v_xor_b32 v77, 66048, v1
    v_mfma_f32_16x16x32_bf16 v[112:115], v[40:43], a[200:203], v[112:115]
    v_xor_b32 v78, 65604, v1
    v_xor_b32 v79, 66052, v1
    v_mfma_f32_16x16x32_bf16 v[104:107], v[28:31], a[204:207], v[104:107]
    v_permlane16_swap_b32 v48, v52
    v_mfma_f32_16x16x32_bf16 v[112:115], v[44:47], a[204:207], v[112:115]
    v_permlane16_swap_b32 v49, v53
    v_mfma_f32_16x16x32_bf16 v[108:111], v[16:19], a[208:211], 0
    v_permlane16_swap_b32 v50, v54
    v_mfma_f32_16x16x32_bf16 v[116:119], v[32:35], a[208:211], 0
    v_permlane16_swap_b32 v51, v55
    v_mfma_f32_16x16x32_bf16 v[108:111], v[20:23], a[212:215], v[108:111]
    v_cvt_pk_bf16_f32 v136, v104, v105
    v_cvt_pk_bf16_f32 v137, v106, v107
    v_mfma_f32_16x16x32_bf16 v[116:119], v[36:39], a[212:215], v[116:119]
    v_cvt_pk_bf16_f32 v140, v112, v113
    v_cvt_pk_bf16_f32 v141, v114, v115
    v_mfma_f32_16x16x32_bf16 v[108:111], v[24:27], a[216:219], v[108:111]
    v_add_f32 v48, v48, v52
    v_add_f32 v49, v49, v53
    v_mfma_f32_16x16x32_bf16 v[116:119], v[40:43], a[216:219], v[116:119]
    v_add_f32 v50, v50, v54
    v_add_f32 v51, v51, v55
    v_mfma_f32_16x16x32_bf16 v[108:111], v[28:31], a[220:223], v[108:111]
    v_cvt_pk_bf16_f32 v53, v48, v49
    v_cvt_pk_bf16_f32 v55, v50, v51
    v_mfma_f32_16x16x32_bf16 v[116:119], v[44:47], a[220:223], v[116:119]
    buffer_store_dword v53, v254, s[12:15], 0 offen offset:0 sc1
    buffer_store_dword v55, v254, s[12:15], 0 offen offset:64 sc1
    v_mul_f32 v48, v168, v168
    v_mfma_f32_16x16x16_bf16 v[176:179], v[240:241], v[144:145], v[176:179]
    v_mul_f32 v49, v169, v169
    v_cvt_pk_bf16_f32 v138, v108, v109
    v_mfma_f32_16x16x16_bf16 v[180:183], v[240:241], v[146:147], v[180:183]
    v_cvt_pk_bf16_f32 v139, v110, v111
    v_cvt_pk_bf16_f32 v142, v116, v117
    v_mfma_f32_16x16x16_bf16 v[208:211], v[242:243], v[148:149], v[208:211]
    v_cvt_pk_bf16_f32 v143, v118, v119
    v_mul_f32 v50, v170, v170
    v_mfma_f32_16x16x16_bf16 v[212:215], v[242:243], v[150:151], v[212:215]
    v_mul_f32 v51, v171, v171
    v_mul_f32 v52, v200, v200
    v_mfma_f32_16x16x32_bf16 v[120:123], v[16:19], a[224:227], 0
    v_mul_f32 v53, v201, v201
    v_mul_f32 v54, v202, v202
    v_mfma_f32_16x16x32_bf16 v[128:131], v[32:35], a[224:227], 0
    v_mul_f32 v55, v203, v203
    v_fmac_f32 v48, v172, v172
    v_mfma_f32_16x16x32_bf16 v[120:123], v[20:23], a[228:231], v[120:123]
    v_fmac_f32 v49, v173, v173
    v_fmac_f32 v50, v174, v174
    v_mfma_f32_16x16x32_bf16 v[128:131], v[36:39], a[228:231], v[128:131]
    v_fmac_f32 v51, v175, v175
    v_fmac_f32 v52, v204, v204
    v_mfma_f32_16x16x32_bf16 v[120:123], v[24:27], a[232:235], v[120:123]
    v_fmac_f32 v53, v205, v205
    v_fmac_f32 v54, v206, v206
    v_mfma_f32_16x16x32_bf16 v[128:131], v[40:43], a[232:235], v[128:131]
    v_fmac_f32 v55, v207, v207
    v_fmac_f32 v48, v176, v176
    v_mfma_f32_16x16x32_bf16 v[120:123], v[28:31], a[236:239], v[120:123]
    v_fmac_f32 v49, v177, v177
    v_fmac_f32 v50, v178, v178
    v_mfma_f32_16x16x32_bf16 v[128:131], v[44:47], a[236:239], v[128:131]
    v_fmac_f32 v51, v179, v179
    v_fmac_f32 v52, v208, v208
    v_mfma_f32_16x16x32_bf16 v[124:127], v[16:19], a[240:243], 0
    ds_read2st64_b32 v[16:17], v76 offset0:0 offset1:4
    ds_read2st64_b32 v[18:19], v77 offset0:0 offset1:4
    v_cvt_pk_bf16_f32 v144, v120, v121
    v_mfma_f32_16x16x32_bf16 v[132:135], v[32:35], a[240:243], 0
    ds_read2st64_b32 v[32:33], v78 offset0:0 offset1:4
    v_cvt_pk_bf16_f32 v145, v122, v123
    v_cvt_pk_bf16_f32 v148, v128, v129
    v_mfma_f32_16x16x32_bf16 v[124:127], v[20:23], a[244:247], v[124:127]
    ds_read2st64_b32 v[34:35], v79 offset0:0 offset1:4
    v_cvt_pk_bf16_f32 v149, v130, v131
    ds_read2st64_b32 v[20:21], v76 offset0:8 offset1:12
    v_mfma_f32_16x16x32_bf16 v[132:135], v[36:39], a[244:247], v[132:135]
    ds_read2st64_b32 v[22:23], v77 offset0:8 offset1:12
    ds_read2st64_b32 v[36:37], v78 offset0:8 offset1:12
    ds_read2st64_b32 v[38:39], v79 offset0:8 offset1:12
    v_mfma_f32_16x16x32_bf16 v[124:127], v[24:27], a[248:251], v[124:127]
    ds_read2st64_b32 v[24:25], v76 offset0:16 offset1:20
    ds_read2st64_b32 v[26:27], v77 offset0:16 offset1:20
    v_fmac_f32 v53, v209, v209
    v_mfma_f32_16x16x32_bf16 v[132:135], v[40:43], a[248:251], v[132:135]
    ds_read2st64_b32 v[40:41], v78 offset0:16 offset1:20
    ds_read2st64_b32 v[42:43], v79 offset0:16 offset1:20
    v_fmac_f32 v54, v210, v210
    v_mfma_f32_16x16x32_bf16 v[124:127], v[28:31], a[252:255], v[124:127]
    ds_read2st64_b32 v[28:29], v76 offset0:24 offset1:28
    ds_read2st64_b32 v[30:31], v77 offset0:24 offset1:28
    v_fmac_f32 v55, v211, v211
    v_mfma_f32_16x16x32_bf16 v[132:135], v[44:47], a[252:255], v[132:135]
    ds_read2st64_b32 v[44:45], v78 offset0:24 offset1:28
    ds_read2st64_b32 v[46:47], v79 offset0:24 offset1:28
    v_fmac_f32 v48, v180, v180
    v_mfma_f32_16x16x16_bf16 v[184:187], v[240:241], v[136:137], v[184:187]
    v_cvt_pk_bf16_f32 v146, v124, v125
    v_cvt_pk_bf16_f32 v147, v126, v127
    v_mfma_f32_16x16x16_bf16 v[188:191], v[240:241], v[138:139], v[188:191]
    v_fmac_f32 v49, v181, v181
    v_cvt_pk_bf16_f32 v150, v132, v133
    v_mfma_f32_16x16x16_bf16 v[216:219], v[242:243], v[140:141], v[216:219]
    v_cvt_pk_bf16_f32 v151, v134, v135
    v_fmac_f32 v50, v182, v182
    v_mfma_f32_16x16x16_bf16 v[220:223], v[242:243], v[142:143], v[220:223]
    v_fmac_f32 v51, v183, v183
    v_fmac_f32 v52, v212, v212
    v_mfma_f32_16x16x16_bf16 v[192:195], v[240:241], v[144:145], v[192:195]
    v_fmac_f32 v53, v213, v213
    v_fmac_f32 v54, v214, v214
    v_mfma_f32_16x16x16_bf16 v[196:199], v[240:241], v[146:147], v[196:199]
    v_fmac_f32 v55, v215, v215
    v_fmac_f32 v48, v184, v184
    v_mfma_f32_16x16x16_bf16 v[224:227], v[242:243], v[148:149], v[224:227]
    v_fmac_f32 v49, v185, v185
    v_fmac_f32 v50, v186, v186
    v_mfma_f32_16x16x16_bf16 v[228:231], v[242:243], v[150:151], v[228:231]
    s_waitcnt lgkmcnt(0) vmcnt(6)
    s_barrier
    v_fmac_f32 v51, v187, v187
    v_mfma_f32_16x16x32_bf16 v[104:107], a[0:3], v[16:19], 0
    v_fmac_f32 v52, v216, v216
    v_fmac_f32 v53, v217, v217
    v_mfma_f32_16x16x32_bf16 v[112:115], a[0:3], v[32:35], 0
    v_fmac_f32 v54, v218, v218
    v_fmac_f32 v55, v219, v219
    v_mfma_f32_16x16x32_bf16 v[104:107], a[4:7], v[20:23], v[104:107]
    v_fmac_f32 v48, v188, v188
    v_fmac_f32 v49, v189, v189
    v_mfma_f32_16x16x32_bf16 v[112:115], a[4:7], v[36:39], v[112:115]
    v_fmac_f32 v50, v190, v190
    v_fmac_f32 v51, v191, v191
    v_mfma_f32_16x16x32_bf16 v[104:107], a[8:11], v[24:27], v[104:107]
    v_fmac_f32 v52, v220, v220
    v_fmac_f32 v53, v221, v221
    v_mfma_f32_16x16x32_bf16 v[112:115], a[8:11], v[40:43], v[112:115]
    v_fmac_f32 v54, v222, v222
    v_fmac_f32 v55, v223, v223
    v_mfma_f32_16x16x32_bf16 v[104:107], a[12:15], v[28:31], v[104:107]
    v_fmac_f32 v48, v192, v192
    v_fmac_f32 v49, v193, v193
    v_mfma_f32_16x16x32_bf16 v[112:115], a[12:15], v[44:47], v[112:115]
    v_fmac_f32 v50, v194, v194
    v_fmac_f32 v51, v195, v195
    v_mfma_f32_16x16x32_bf16 v[108:111], a[16:19], v[16:19], 0
    v_fmac_f32 v52, v224, v224
    v_fmac_f32 v53, v225, v225
    v_mfma_f32_16x16x32_bf16 v[116:119], a[16:19], v[32:35], 0
    v_fmac_f32 v54, v226, v226
    v_fmac_f32 v55, v227, v227
    v_mfma_f32_16x16x32_bf16 v[108:111], a[20:23], v[20:23], v[108:111]
    v_fmac_f32 v48, v196, v196
    v_fmac_f32 v49, v197, v197
    v_mfma_f32_16x16x32_bf16 v[116:119], a[20:23], v[36:39], v[116:119]
    v_fmac_f32 v50, v198, v198
    v_fmac_f32 v51, v199, v199
    v_mfma_f32_16x16x32_bf16 v[108:111], a[24:27], v[24:27], v[108:111]
    v_fmac_f32 v52, v228, v228
    v_fmac_f32 v53, v229, v229
    v_mfma_f32_16x16x32_bf16 v[116:119], a[24:27], v[40:43], v[116:119]
    v_fmac_f32 v54, v230, v230
    v_fmac_f32 v55, v231, v231
    v_mfma_f32_16x16x32_bf16 v[108:111], a[28:31], v[28:31], v[108:111]
    v_cvt_pk_bf16_f32 v64, v48, v49
    v_cvt_pk_bf16_f32 v65, v50, v51
    v_mfma_f32_16x16x32_bf16 v[116:119], a[28:31], v[44:47], v[116:119]
    v_cvt_pk_bf16_f32 v66, v52, v53
    v_cvt_pk_bf16_f32 v67, v54, v55
    v_mfma_f32_16x16x32_bf16 v[120:123], v[16:19], v[16:19], 0
    v_cndmask_b32_dpp v250, v98, v250, vcc row_ror:8 row_mask:0xf bank_mask:0xf
    v_cndmask_b32_dpp v251, v99, v251, vcc row_ror:8 row_mask:0xf bank_mask:0xf
    v_mfma_f32_16x16x32_bf16 v[68:71], v[64:67], v[88:91], 0
    ds_write_b32 v4, v250 offset:128
    ds_write_b32 v4, v251 offset:256
    ds_read_b128 v[160:163], v8 offset:128
    v_mfma_f32_16x16x32_bf16 v[72:75], v[64:67], v[92:95], 0
    ds_read_b128 v[164:167], v8 offset:256
    v_cndmask_b32_dpp v249, v97, v249, vcc row_ror:8 row_mask:0xf bank_mask:0xf
    v_cvt_pk_bf16_f32 v136, v104, v105
    v_mfma_f32_16x16x32_bf16 v[124:127], v[32:35], v[32:35], 0
    v_cvt_pk_bf16_f32 v137, v106, v107
    v_cvt_pk_bf16_f32 v138, v108, v109
    v_mfma_f32_16x16x32_bf16 v[120:123], v[20:23], v[20:23], v[120:123]
    v_cvt_pk_bf16_f32 v139, v110, v111
    v_cvt_pk_bf16_f32 v140, v112, v113
    v_mfma_f32_16x16x32_bf16 v[124:127], v[36:39], v[36:39], v[124:127]
    v_cvt_pk_bf16_f32 v141, v114, v115
    v_cvt_pk_bf16_f32 v142, v116, v117
    v_mfma_f32_16x16x32_bf16 v[120:123], v[24:27], v[24:27], v[120:123]
    v_cvt_pk_bf16_f32 v143, v118, v119
    v_permlane16_swap_b32 v56, v60
    v_mfma_f32_16x16x32_bf16 v[124:127], v[40:43], v[40:43], v[124:127]
    v_permlane16_swap_b32 v57, v61
    v_mfma_f32_16x16x32_bf16 v[120:123], v[28:31], v[28:31], v[120:123]
    s_waitcnt lgkmcnt(1)
    v_mul_f32 v13, v152, v160
    v_mfma_f32_16x16x32_bf16 v[96:99], v[80:83], v[32:35], 0
    s_waitcnt lgkmcnt(0)
    v_mul_f32 v14, v152, v164
    v_mfma_f32_16x16x32_bf16 v[124:127], v[44:47], v[44:47], v[124:127]
    v_fmac_f32 v13, v153, v161
    v_fmac_f32 v14, v153, v165
    v_mfma_f32_16x16x32_bf16 v[96:99], v[84:87], v[36:39], v[96:99]
    v_fmac_f32 v13, v154, v162
    v_fmac_f32 v14, v154, v166
    v_fmac_f32 v13, v155, v163
    v_fmac_f32 v14, v155, v167
    v_mfma_f32_16x16x32_bf16 v[152:155], v[136:139], v[16:19], 0
    v_cndmask_b32 v120, v120, v121, s[32:33]
    v_permlane16_swap_b32 v13, v14
    v_add_f32 v13, v13, v14
    v_mov_b32 v14, v13
    v_mfma_f32_16x16x32_bf16 v[156:159], v[140:143], v[32:35], 0
    v_cndmask_b32 v124, v124, v125, s[32:33]
    v_permlane16_swap_b32 v13, v14
    v_add_f32 v13, v13, v248
    v_add_f32 v14, v14, v249
    v_mfma_f32_16x16x32_bf16 v[248:251], v[80:83], v[16:19], 0
    ds_read_b128 v[80:83], v15 offset:2048
    v_cndmask_b32 v120, v120, v122, s[34:35]
    v_cndmask_b32 v124, v124, v126, s[34:35]
    v_mfma_f32_16x16x32_bf16 v[248:251], v[84:87], v[20:23], v[248:251]
    ds_read_b128 v[84:87], v15 offset:3072
    v_cndmask_b32 v120, v120, v123, s[36:37]
    v_cndmask_b32 v124, v124, v127, s[36:37]
    v_mfma_f32_16x16x32_bf16 v[128:131], a[32:35], v[32:35], 0
    v_cndmask_b32 v11, 0, v120, s[38:39]
    v_cndmask_b32 v2, 0, v120, s[38:39]
    v_mfma_f32_16x16x32_bf16 v[128:131], a[36:39], v[36:39], v[128:131]
    v_cndmask_b32 v122, 0, v124, s[38:39]
    v_permlane16_swap_b32 v58, v62
    v_mfma_f32_16x16x32_bf16 v[128:131], a[40:43], v[40:43], v[128:131]
    v_mov_b32_dpp v11, v122 row_ror:8 row_mask:0xf bank_mask:0xc
    v_mov_b32_dpp v2, v122 row_ror:8 row_mask:0xf bank_mask:0x3
    v_mfma_f32_16x16x32_bf16 v[120:123], a[32:35], v[16:19], 0
    v_permlane16_swap_b32 v59, v63
    v_mfma_f32_16x16x32_bf16 v[120:123], a[36:39], v[20:23], v[120:123]
    v_add_f32 v56, v56, v60
    v_add_f32 v57, v57, v61
    s_waitcnt lgkmcnt(1)
    v_mfma_f32_16x16x32_bf16 v[248:251], v[80:83], v[24:27], v[248:251]
    v_add_f32 v58, v58, v62
    v_add_f32 v59, v59, v63
    v_mfma_f32_16x16x32_bf16 v[96:99], v[80:83], v[40:43], v[96:99]
    ds_read_b128 v[80:83], v15 offset:0
    v_lshl_add_u32 v255, v255, 8, v7
    v_cvt_pk_bf16_f32 v61, v56, v57
    s_waitcnt lgkmcnt(1)
    v_mfma_f32_16x16x32_bf16 v[248:251], v[84:87], v[28:31], v[248:251]
    buffer_store_dword v61, v255, s[12:15], 0 offen offset:0 sc1
    v_cvt_pk_bf16_f32 v63, v58, v59
    buffer_store_dword v63, v255, s[12:15], 0 offen offset:64 sc1
    v_mfma_f32_16x16x32_bf16 v[96:99], v[84:87], v[44:47], v[96:99]
    buffer_load_dwordx2 v[254:255], v3, s[8:11], s23 offen
    v_add_f32 v68, v68, v69
    v_add_f32 v70, v70, v71
    v_mfma_f32_16x16x32_bf16 v[120:123], a[40:43], v[24:27], v[120:123]
    s_lshl_b32 s23, s56, 4
    v_add_f32 v72, v72, v73
    v_add_f32 v74, v74, v75
    v_mfma_f32_16x16x32_bf16 v[120:123], a[44:47], v[28:31], v[120:123]
    s_add_u32 s23, s23, 131072
    v_add_f32 v68, v68, v70
    v_add_f32 v72, v72, v74
    v_mfma_f32_16x16x32_bf16 v[128:131], a[44:47], v[44:47], v[128:131]
    ds_read_b128 v[84:87], v15 offset:1024
    v_permlane32_swap_b32 v68, v72
    v_mfma_f32_16x16x32_bf16 v[124:127], a[48:51], v[16:19], 0
    s_add_u32 s21, s21, s44
    v_cvt_pk_bf16_f32 v144, v120, v121
    v_cvt_pk_bf16_f32 v145, v122, v123
    v_mfma_f32_16x16x32_bf16 v[132:135], a[48:51], v[32:35], 0
    s_add_u32 s21, s21, 65011712
    v_cvt_pk_bf16_f32 v148, v128, v129
    v_cvt_pk_bf16_f32 v149, v130, v131
    v_mfma_f32_16x16x32_bf16 v[124:127], a[52:55], v[20:23], v[124:127]
    s_add_u32 m0, s44, 65536
    v_add_f32 v5, v68, v72
    v_mov_b32 v72, v5
    v_mfma_f32_16x16x32_bf16 v[132:135], a[52:55], v[36:39], v[132:135]
    buffer_load_dwordx4 v103, s[8:11], s21 offen offset:0 lds
    v_mfma_f32_16x16x32_bf16 v[124:127], a[56:59], v[24:27], v[124:127]
    v_mul_f32 v13, s28, v13
    v_permlane16_swap_b32 v5, v72
    v_mfma_f32_16x16x32_bf16 v[132:135], a[56:59], v[40:43], v[132:135]
    v_fma_f32 v14, -v13, s24, v14
    v_add_f32 v5, v5, v72
    v_mfma_f32_16x16x32_bf16 v[124:127], a[60:63], v[28:31], v[124:127]
    v_mul_f32 v13, v13, v13
    v_fma_f32 v5, v5, s28, -v13
    v_mfma_f32_16x16x32_bf16 v[132:135], a[60:63], v[44:47], v[132:135]
    v_mul_f32 v6, v100, v100
    v_max_f32 v5, 0, v5
    v_mfma_f32_16x16x32_bf16 v[104:107], a[64:67], v[16:19], 0
    v_fma_f32 v5, v5, v6, s29
    v_rsq_f32 v5, v5
    v_mfma_f32_16x16x32_bf16 v[112:115], a[64:67], v[32:35], 0
    buffer_load_dwordx4 v103, s[8:11], s21 offen offset:1024 lds
    v_mfma_f32_16x16x32_bf16 v[104:107], a[68:71], v[20:23], v[104:107]
    v_cvt_pk_bf16_f32 v146, v124, v125
    v_cvt_pk_bf16_f32 v147, v126, v127
    v_mfma_f32_16x16x32_bf16 v[112:115], a[68:71], v[36:39], v[112:115]
    v_cvt_pk_bf16_f32 v150, v132, v133
    v_cvt_pk_bf16_f32 v151, v134, v135
    v_mfma_f32_16x16x32_bf16 v[152:155], v[144:147], v[20:23], v[152:155]
    v_mul_f32 v14, s30, v14
    v_mul_f32 v14, v14, v100
    v_mfma_f32_16x16x32_bf16 v[156:159], v[148:151], v[36:39], v[156:159]
    v_mul_f32 v5, v5, v14
    v_permlane32_swap_b32 v11, v2
    v_mfma_f32_16x16x32_bf16 v[104:107], a[72:75], v[24:27], v[104:107]
    v_max_f32_dpp v6, v5, v5 quad_perm:[1,0,3,2] row_mask:0xf bank_mask:0xf
    v_add_f32 v11, v11, v2
    v_mfma_f32_16x16x32_bf16 v[112:115], a[72:75], v[40:43], v[112:115]
    buffer_load_dwordx4 v103, s[8:11], s21 offen offset:2048 lds
    v_mfma_f32_16x16x32_bf16 v[104:107], a[76:79], v[28:31], v[104:107]
    v_max_f32_dpp v6, v6, v6 quad_perm:[2,3,0,1] row_mask:0xf bank_mask:0xf
    v_mov_b32 v2, v11
    v_mfma_f32_16x16x32_bf16 v[112:115], a[76:79], v[44:47], v[112:115]
    v_max_f32_dpp v6, v6, v6 row_half_mirror row_mask:0xf bank_mask:0xf
    v_sub_f32 v5, v5, v6
    v_mfma_f32_16x16x32_bf16 v[108:111], a[80:83], v[16:19], 0
    v_exp_f32 v5, v5
    v_mfma_f32_16x16x32_bf16 v[116:119], a[80:83], v[32:35], 0
    v_cvt_pk_bf16_f32 v136, v104, v105
    v_cvt_pk_bf16_f32 v137, v106, v107
    v_mfma_f32_16x16x32_bf16 v[108:111], a[84:87], v[20:23], v[108:111]
    v_cvt_pk_bf16_f32 v140, v112, v113
    v_cvt_pk_bf16_f32 v141, v114, v115
    v_mfma_f32_16x16x32_bf16 v[116:119], a[84:87], v[36:39], v[116:119]
    buffer_load_dwordx4 v103, s[8:11], s21 offen offset:3072 lds
    v_mfma_f32_16x16x32_bf16 v[108:111], a[88:91], v[24:27], v[108:111]
    s_add_u32 s21, s21, 4096
    v_add_f32_dpp v6, v5, v5 quad_perm:[1,0,3,2] row_mask:0xf bank_mask:0xf
    v_mul_f32 v5, v5, v100
    v_mfma_f32_16x16x32_bf16 v[116:119], a[88:91], v[40:43], v[116:119]
    buffer_load_dword v100, v102, s[8:11], s23 offen
    v_add_f32_dpp v6, v6, v6 quad_perm:[2,3,0,1] row_mask:0xf bank_mask:0xf
    v_permlane16_swap_b32 v11, v2
    v_mfma_f32_16x16x32_bf16 v[108:111], a[92:95], v[28:31], v[108:111]
    s_add_u32 m0, s44, 69632
    v_add_f32_dpp v6, v6, v6 row_half_mirror row_mask:0xf bank_mask:0xf
    v_rcp_f32 v6, v6
    v_mfma_f32_16x16x32_bf16 v[116:119], a[92:95], v[44:47], v[116:119]
    v_mul_f32 v5, v5, v6
    ds_write_b32 v4, v5 offset:512
    v_mfma_f32_16x16x32_bf16 v[120:123], a[96:99], v[16:19], 0
    ds_read_b128 v[64:67], v9 offset:512
    v_cvt_pk_bf16_f32 v138, v108, v109
    v_cvt_pk_bf16_f32 v139, v110, v111
    v_mfma_f32_16x16x32_bf16 v[128:131], a[96:99], v[32:35], 0
    ds_read_b128 v[68:71], v9 offset:576
    v_cvt_pk_bf16_f32 v142, v116, v117
    v_cvt_pk_bf16_f32 v143, v118, v119
    v_mfma_f32_16x16x32_bf16 v[152:155], v[136:139], v[24:27], v[152:155]
    buffer_load_dwordx4 v103, s[8:11], s21 offen offset:0 lds
    v_mfma_f32_16x16x32_bf16 v[156:159], v[140:143], v[40:43], v[156:159]
    v_cndmask_b32_dpp v248, v96, v248, vcc row_ror:8 row_mask:0xf bank_mask:0xf
    v_add_f32 v11, v11, v2
    v_mfma_f32_16x16x32_bf16 v[120:123], a[100:103], v[20:23], v[120:123]
    v_mul_f32 v2, s28, v248
    v_mul_f32 v2, v2, v2
    v_mfma_f32_16x16x32_bf16 v[128:131], a[100:103], v[36:39], v[128:131]
    v_fma_f32 v11, v11, s28, -v2
    s_waitcnt vmcnt(11)
    v_mul_f32 v2, v101, v101
    v_mfma_f32_16x16x32_bf16 v[120:123], a[104:107], v[24:27], v[120:123]
    v_max_f32 v11, 0, v11
    v_fma_f32 v11, v11, v2, s29
    v_mfma_f32_16x16x32_bf16 v[128:131], a[104:107], v[40:43], v[128:131]
    s_waitcnt lgkmcnt(1)
    v_mul_f32 v48, v64, v168
    v_mfma_f32_16x16x32_bf16 v[120:123], a[108:111], v[28:31], v[120:123]
    buffer_load_dwordx4 v103, s[8:11], s21 offen offset:1024 lds
    v_mfma_f32_16x16x32_bf16 v[128:131], a[108:111], v[44:47], v[128:131]
    v_fmac_f32 v48, v65, v169
    v_fmac_f32 v48, v66, v170
    v_mfma_f32_16x16x32_bf16 v[124:127], a[112:115], v[16:19], 0
    v_fmac_f32 v48, v67, v171
    v_mul_f32 v49, v64, v172
    v_mfma_f32_16x16x32_bf16 v[132:135], a[112:115], v[32:35], 0
    v_cvt_pk_bf16_f32 v144, v120, v121
    v_cvt_pk_bf16_f32 v145, v122, v123
    v_mfma_f32_16x16x32_bf16 v[124:127], a[116:119], v[20:23], v[124:127]
    v_cvt_pk_bf16_f32 v148, v128, v129
    v_cvt_pk_bf16_f32 v149, v130, v131
    v_mfma_f32_16x16x32_bf16 v[132:135], a[116:119], v[36:39], v[132:135]
    v_fmac_f32 v49, v65, v173
    v_fmac_f32 v49, v66, v174
    v_mfma_f32_16x16x32_bf16 v[124:127], a[120:123], v[24:27], v[124:127]
    buffer_load_dwordx4 v103, s[8:11], s21 offen offset:2048 lds
    v_mfma_f32_16x16x32_bf16 v[132:135], a[120:123], v[40:43], v[132:135]
    v_fmac_f32 v49, v67, v175
    s_waitcnt lgkmcnt(0)
    v_mul_f32 v56, v68, v200
    v_mfma_f32_16x16x32_bf16 v[124:127], a[124:127], v[28:31], v[124:127]
    v_fmac_f32 v56, v69, v201
    v_fmac_f32 v56, v70, v202
    v_mfma_f32_16x16x32_bf16 v[132:135], a[124:127], v[44:47], v[132:135]
    v_fmac_f32 v56, v71, v203
    v_mul_f32 v57, v68, v204
    v_mfma_f32_16x16x32_bf16 v[104:107], v[16:19], a[128:131], 0
    v_fmac_f32 v57, v69, v205
    v_fmac_f32 v57, v70, v206
    v_mfma_f32_16x16x32_bf16 v[112:115], v[32:35], a[128:131], 0
    v_cvt_pk_bf16_f32 v146, v124, v125
    v_cvt_pk_bf16_f32 v147, v126, v127
    v_mfma_f32_16x16x32_bf16 v[104:107], v[20:23], a[132:135], v[104:107]
    buffer_load_dwordx4 v103, s[8:11], s21 offen offset:3072 lds
    v_mfma_f32_16x16x32_bf16 v[152:155], v[144:147], v[28:31], v[152:155]
    s_add_u32 s21, s21, 4096
    v_cvt_pk_bf16_f32 v150, v132, v133
    v_cvt_pk_bf16_f32 v151, v134, v135
    v_mfma_f32_16x16x32_bf16 v[112:115], v[36:39], a[132:135], v[112:115]
    s_add_u32 m0, s44, 73728
    v_fmac_f32 v57, v71, v207
    v_mul_f32 v50, v64, v176
    v_mfma_f32_16x16x32_bf16 v[156:159], v[148:151], v[44:47], v[156:159]
    v_fmac_f32 v50, v65, v177
    v_fmac_f32 v50, v66, v178
    v_mfma_f32_16x16x32_bf16 v[104:107], v[24:27], a[136:139], v[104:107]
    v_fmac_f32 v50, v67, v179
    v_mul_f32 v51, v64, v180
    v_mfma_f32_16x16x32_bf16 v[112:115], v[40:43], a[136:139], v[112:115]
    v_fmac_f32 v51, v65, v181
    v_fmac_f32 v51, v66, v182
    v_mfma_f32_16x16x32_bf16 v[104:107], v[28:31], a[140:143], v[104:107]
    buffer_load_dwordx4 v12, s[8:11], s21 offen offset:0 lds
    v_mfma_f32_16x16x32_bf16 v[112:115], v[44:47], a[140:143], v[112:115]
    v_fmac_f32 v51, v67, v183
    v_mul_f32 v58, v68, v208
    v_mfma_f32_16x16x32_bf16 v[108:111], v[16:19], a[144:147], 0
    v_fmac_f32 v58, v69, v209
    v_fmac_f32 v58, v70, v210
    v_mfma_f32_16x16x32_bf16 v[116:119], v[32:35], a[144:147], 0
    v_fmac_f32 v58, v71, v211
    v_mul_f32 v59, v68, v212
    v_mfma_f32_16x16x32_bf16 v[108:111], v[20:23], a[148:151], v[108:111]
    v_fmac_f32 v59, v69, v213
    v_fmac_f32 v59, v70, v214
    v_mfma_f32_16x16x32_bf16 v[116:119], v[36:39], a[148:151], v[116:119]
    v_fmac_f32 v59, v71, v215
    v_rsq_f32 v11, v11
    v_mfma_f32_16x16x32_bf16 v[108:111], v[24:27], a[152:155], v[108:111]
    buffer_load_dwordx4 v12, s[8:11], s21 offen offset:1024 lds
    v_mfma_f32_16x16x32_bf16 v[116:119], v[40:43], a[152:155], v[116:119]
    v_mul_f32 v11, v11, v101
    ds_write_b32 v4, v11
    v_mfma_f32_16x16x32_bf16 v[108:111], v[28:31], a[156:159], v[108:111]
    ds_read_b128 v[244:247], v8
    v_mul_f32 v52, v64, v184
    v_fmac_f32 v52, v65, v185
    v_mfma_f32_16x16x32_bf16 v[116:119], v[44:47], a[156:159], v[116:119]
    v_fmac_f32 v52, v66, v186
    v_fmac_f32 v52, v67, v187
    v_mfma_f32_16x16x32_bf16 v[168:171], v[16:19], v[232:235], 0
    v_mul_f32 v53, v64, v188
    v_fmac_f32 v53, v65, v189
    v_mfma_f32_16x16x32_bf16 v[172:175], v[16:19], v[236:239], 0
    v_fmac_f32 v53, v66, v190
    v_fmac_f32 v53, v67, v191
    v_mfma_f32_16x16x32_bf16 v[200:203], v[32:35], v[232:235], 0
    buffer_load_dwordx4 v12, s[8:11], s21 offen offset:2048 lds
    v_mfma_f32_16x16x32_bf16 v[204:207], v[32:35], v[236:239], 0
    v_mul_f32 v60, v68, v216
    v_fmac_f32 v60, v69, v217
    v_mfma_f32_16x16x32_bf16 v[176:179], v[20:23], v[232:235], 0
    v_fmac_f32 v60, v70, v218
    v_fmac_f32 v60, v71, v219
    v_mfma_f32_16x16x32_bf16 v[180:183], v[20:23], v[236:239], 0
    v_cndmask_b32_dpp v152, v156, v152, vcc row_ror:8 row_mask:0xf bank_mask:0xf
    v_cndmask_b32_dpp v153, v157, v153, vcc row_ror:8 row_mask:0xf bank_mask:0xf
    v_mfma_f32_16x16x32_bf16 v[208:211], v[36:39], v[232:235], 0
    v_cndmask_b32_dpp v154, v158, v154, vcc row_ror:8 row_mask:0xf bank_mask:0xf
    v_mul_f32 v61, v68, v220
    v_mfma_f32_16x16x32_bf16 v[212:215], v[36:39], v[236:239], 0
    v_cndmask_b32_dpp v155, v159, v155, vcc row_ror:8 row_mask:0xf bank_mask:0xf
    s_waitcnt lgkmcnt(0)
    v_mul_f32 v152, v152, v244
    v_mfma_f32_16x16x32_bf16 v[120:123], v[16:19], a[160:163], 0
    buffer_load_dwordx4 v12, s[8:11], s21 offen offset:3072 lds
    v_mfma_f32_16x16x32_bf16 v[128:131], v[32:35], a[160:163], 0
    s_add_u32 s21, s21, 4096
    v_mul_f32 v153, v153, v245
    v_mul_f32 v154, v154, v246
    v_mfma_f32_16x16x32_bf16 v[120:123], v[20:23], a[164:167], v[120:123]
    s_add_u32 m0, s44, 77824
    v_fmac_f32 v61, v69, v221
    v_max3_f32 v156, v152, v153, v154
    v_mfma_f32_16x16x32_bf16 v[128:131], v[36:39], a[164:167], v[128:131]
    v_mul_f32 v155, v155, v247
    v_fmac_f32 v61, v70, v222
    v_mfma_f32_16x16x32_bf16 v[120:123], v[24:27], a[168:171], v[120:123]
    v_max_f32 v156, v156, v155
    v_fmac_f32 v61, v71, v223
    v_mfma_f32_16x16x32_bf16 v[128:131], v[40:43], a[168:171], v[128:131]
    v_mov_b32 v157, v156
    v_mul_f32 v54, v64, v192
    v_mfma_f32_16x16x32_bf16 v[120:123], v[28:31], a[172:175], v[120:123]
    buffer_load_dwordx4 v12, s[8:11], s21 offen offset:0 lds
    v_mfma_f32_16x16x32_bf16 v[128:131], v[44:47], a[172:175], v[128:131]
    v_permlane16_swap_b32 v156, v157
    v_mfma_f32_16x16x32_bf16 v[124:127], v[16:19], a[176:179], 0
    v_fmac_f32 v54, v65, v193
    v_fmac_f32 v54, v66, v194
    v_mfma_f32_16x16x32_bf16 v[132:135], v[32:35], a[176:179], 0
    v_max_f32 v156, v156, v157
    v_fmac_f32 v54, v67, v195
    v_mfma_f32_16x16x32_bf16 v[124:127], v[20:23], a[180:183], v[124:127]
    v_mul_f32 v156, v156, v11
    v_fma_f32 v152, v152, v11, -v156
    v_mfma_f32_16x16x32_bf16 v[132:135], v[36:39], a[180:183], v[132:135]
    v_fma_f32 v153, v153, v11, -v156
    v_fma_f32 v154, v154, v11, -v156
    v_mfma_f32_16x16x32_bf16 v[124:127], v[24:27], a[184:187], v[124:127]
    buffer_load_dwordx4 v12, s[8:11], s21 offen offset:1024 lds
    v_mfma_f32_16x16x32_bf16 v[132:135], v[40:43], a[184:187], v[132:135]
    v_fma_f32 v155, v155, v11, -v156
    v_mul_f32 v55, v64, v196
    v_mfma_f32_16x16x32_bf16 v[124:127], v[28:31], a[188:191], v[124:127]
    v_exp_f32 v152, v152
    v_mfma_f32_16x16x32_bf16 v[132:135], v[44:47], a[188:191], v[132:135]
    v_exp_f32 v153, v153
    v_mfma_f32_16x16x32_bf16 v[184:187], v[24:27], v[232:235], 0
    v_exp_f32 v154, v154
    v_mfma_f32_16x16x32_bf16 v[188:191], v[24:27], v[236:239], 0
    v_exp_f32 v155, v155
    v_mfma_f32_16x16x32_bf16 v[216:219], v[40:43], v[232:235], 0
    buffer_load_dwordx4 v12, s[8:11], s21 offen offset:2048 lds
    v_mfma_f32_16x16x32_bf16 v[220:223], v[40:43], v[236:239], 0
    v_fmac_f32 v55, v65, v197
    v_fmac_f32 v55, v66, v198
    v_mfma_f32_16x16x32_bf16 v[192:195], v[28:31], v[232:235], 0
    v_fmac_f32 v55, v67, v199
    v_add_f32 v156, v152, v153
    v_mfma_f32_16x16x32_bf16 v[196:199], v[28:31], v[236:239], 0
    v_add_f32 v157, v154, v155
    v_add_f32 v156, v156, v157
    v_mov_b32 v157, v156
    v_mul_f32 v62, v68, v224
    v_fmac_f32 v62, v69, v225
    v_fmac_f32 v62, v70, v226
    v_permlane16_swap_b32 v156, v157
    v_fmac_f32 v62, v71, v227
    v_mfma_f32_16x16x32_bf16 v[224:227], v[44:47], v[232:235], 0
    v_add_f32 v156, v156, v157
    v_mul_f32 v63, v68, v228
    v_mul_f32 v156, v156, v101
    v_fmac_f32 v63, v69, v229
    v_rcp_f32 v156, v156
    v_fmac_f32 v63, v70, v230
    v_fmac_f32 v63, v71, v231
    v_mfma_f32_16x16x32_bf16 v[228:231], v[44:47], v[236:239], 0
    buffer_load_dwordx4 v12, s[8:11], s21 offen offset:3072 lds
    v_mul_f32 v152, v152, v244
    v_mul_f32 v153, v153, v245
    v_mul_f32 v154, v154, v246
    v_mul_f32 v155, v155, v247
    v_mul_f32 v152, v152, v156
    v_mul_f32 v153, v153, v156
    v_mul_f32 v154, v154, v156
    v_mul_f32 v155, v155, v156
    v_cvt_pk_bf16_f32 v158, v152, v153
    v_cvt_pk_bf16_f32 v159, v154, v155
    v_cvt_pk_bf16_f32 v136, v104, v105
    v_cvt_pk_bf16_f32 v137, v106, v107
    v_mfma_f32_16x16x32_bf16 v[104:107], v[16:19], a[192:195], 0
    v_and_b32 v240, v158, v10
    v_and_b32 v241, v159, v10
    v_mfma_f32_16x16x32_bf16 v[104:107], v[20:23], a[196:199], v[104:107]
    v_cvt_pk_bf16_f32 v138, v108, v109
    v_cvt_pk_bf16_f32 v139, v110, v111
    v_mfma_f32_16x16x16_bf16 v[168:171], v[240:241], v[136:137], v[168:171]
    v_cvt_pk_bf16_f32 v140, v112, v113
    v_cvt_pk_bf16_f32 v141, v114, v115
    v_mfma_f32_16x16x16_bf16 v[172:175], v[240:241], v[138:139], v[172:175]
    v_and_b32_dpp v242, v158, v10 row_ror:8 row_mask:0xf bank_mask:0xf
    v_and_b32_dpp v243, v159, v10 row_ror:8 row_mask:0xf bank_mask:0xf
    v_mfma_f32_16x16x32_bf16 v[112:115], v[32:35], a[192:195], 0
    v_cvt_pk_bf16_f32 v142, v116, v117
    v_cvt_pk_bf16_f32 v143, v118, v119
    v_mfma_f32_16x16x16_bf16 v[200:203], v[242:243], v[140:141], v[200:203]
    v_cvt_pk_bf16_f32 v144, v120, v121
    v_cvt_pk_bf16_f32 v145, v122, v123
    v_mfma_f32_16x16x16_bf16 v[204:207], v[242:243], v[142:143], v[204:207]
    v_cvt_pk_bf16_f32 v146, v124, v125
    v_cvt_pk_bf16_f32 v147, v126, v127
    v_mfma_f32_16x16x32_bf16 v[112:115], v[36:39], a[196:199], v[112:115]
    v_cvt_pk_bf16_f32 v148, v128, v129
    v_cvt_pk_bf16_f32 v149, v130, v131
    v_mfma_f32_16x16x32_bf16 v[104:107], v[24:27], a[200:203], v[104:107]
    v_cvt_pk_bf16_f32 v150, v132, v133
    v_cvt_pk_bf16_f32 v151, v134, v135
    v_mfma_f32_16x16x32_bf16 v[112:115], v[40:43], a[200:203], v[112:115]
    v_xor_b32 v77, 576, v1
    v_xor_b32 v76, 0, v1
    v_mfma_f32_16x16x32_bf16 v[104:107], v[28:31], a[204:207], v[104:107]
    v_xor_b32 v79, 580, v1
    v_xor_b32 v78, 4, v1
    v_mfma_f32_16x16x32_bf16 v[112:115], v[44:47], a[204:207], v[112:115]
    v_permlane16_swap_b32 v48, v52
    v_mfma_f32_16x16x32_bf16 v[108:111], v[16:19], a[208:211], 0
    v_permlane16_swap_b32 v49, v53
    v_mfma_f32_16x16x32_bf16 v[116:119], v[32:35], a[208:211], 0
    v_permlane16_swap_b32 v50, v54
    v_mfma_f32_16x16x32_bf16 v[108:111], v[20:23], a[212:215], v[108:111]
    v_cvt_pk_bf16_f32 v136, v104, v105
    v_cvt_pk_bf16_f32 v137, v106, v107
    v_mfma_f32_16x16x32_bf16 v[116:119], v[36:39], a[212:215], v[116:119]
    v_cvt_pk_bf16_f32 v140, v112, v113
    v_cvt_pk_bf16_f32 v141, v114, v115
    v_mfma_f32_16x16x32_bf16 v[108:111], v[24:27], a[216:219], v[108:111]
    v_permlane16_swap_b32 v51, v55
    v_mfma_f32_16x16x32_bf16 v[116:119], v[40:43], a[216:219], v[116:119]
    v_add_f32 v48, v48, v52
    v_add_f32 v49, v49, v53
    v_mfma_f32_16x16x32_bf16 v[108:111], v[28:31], a[220:223], v[108:111]
    v_add_f32 v50, v50, v54
    v_add_f32 v51, v51, v55
    v_mfma_f32_16x16x32_bf16 v[116:119], v[44:47], a[220:223], v[116:119]
    v_lshl_add_u32 v252, v252, 8, v7
    v_cvt_pk_bf16_f32 v53, v48, v49
    v_mfma_f32_16x16x16_bf16 v[176:179], v[240:241], v[144:145], v[176:179]
    buffer_store_dword v53, v252, s[12:15], 0 offen offset:0 sc1
    v_cvt_pk_bf16_f32 v55, v50, v51
    v_cvt_pk_bf16_f32 v138, v108, v109
    v_mfma_f32_16x16x16_bf16 v[180:183], v[240:241], v[146:147], v[180:183]
    buffer_store_dword v55, v252, s[12:15], 0 offen offset:64 sc1
    v_cvt_pk_bf16_f32 v139, v110, v111
    v_cvt_pk_bf16_f32 v142, v116, v117
    v_mfma_f32_16x16x16_bf16 v[208:211], v[242:243], v[148:149], v[208:211]
    v_cvt_pk_bf16_f32 v143, v118, v119
    v_mul_f32 v48, v168, v168
    v_mfma_f32_16x16x16_bf16 v[212:215], v[242:243], v[150:151], v[212:215]
    v_mul_f32 v49, v169, v169
    v_mul_f32 v50, v170, v170
    v_mfma_f32_16x16x32_bf16 v[120:123], v[16:19], a[224:227], 0
    v_mul_f32 v51, v171, v171
    v_mul_f32 v52, v200, v200
    v_mfma_f32_16x16x32_bf16 v[128:131], v[32:35], a[224:227], 0
    v_mul_f32 v53, v201, v201
    v_mul_f32 v54, v202, v202
    v_mfma_f32_16x16x32_bf16 v[120:123], v[20:23], a[228:231], v[120:123]
    v_mul_f32 v55, v203, v203
    v_fmac_f32 v48, v172, v172
    v_mfma_f32_16x16x32_bf16 v[128:131], v[36:39], a[228:231], v[128:131]
    v_fmac_f32 v49, v173, v173
    v_fmac_f32 v50, v174, v174
    v_mfma_f32_16x16x32_bf16 v[120:123], v[24:27], a[232:235], v[120:123]
    v_fmac_f32 v51, v175, v175
    v_fmac_f32 v52, v204, v204
    v_mfma_f32_16x16x32_bf16 v[128:131], v[40:43], a[232:235], v[128:131]
    v_fmac_f32 v53, v205, v205
    v_fmac_f32 v54, v206, v206
    v_mfma_f32_16x16x32_bf16 v[120:123], v[28:31], a[236:239], v[120:123]
    v_fmac_f32 v55, v207, v207
    v_fmac_f32 v48, v176, v176
    v_mfma_f32_16x16x32_bf16 v[128:131], v[44:47], a[236:239], v[128:131]
    v_fmac_f32 v49, v177, v177
    v_fmac_f32 v50, v178, v178
    v_mfma_f32_16x16x32_bf16 v[124:127], v[16:19], a[240:243], 0
    ds_read2st64_b32 v[16:17], v76 offset0:0 offset1:4
    ds_read2st64_b32 v[18:19], v77 offset0:0 offset1:4
    v_cvt_pk_bf16_f32 v144, v120, v121
    v_mfma_f32_16x16x32_bf16 v[132:135], v[32:35], a[240:243], 0
    ds_read2st64_b32 v[32:33], v78 offset0:0 offset1:4
    v_cvt_pk_bf16_f32 v145, v122, v123
    v_cvt_pk_bf16_f32 v148, v128, v129
    v_mfma_f32_16x16x32_bf16 v[124:127], v[20:23], a[244:247], v[124:127]
    ds_read2st64_b32 v[34:35], v79 offset0:0 offset1:4
    v_cvt_pk_bf16_f32 v149, v130, v131
    ds_read2st64_b32 v[20:21], v76 offset0:8 offset1:12
    v_mfma_f32_16x16x32_bf16 v[132:135], v[36:39], a[244:247], v[132:135]
    ds_read2st64_b32 v[22:23], v77 offset0:8 offset1:12
    ds_read2st64_b32 v[36:37], v78 offset0:8 offset1:12
    ds_read2st64_b32 v[38:39], v79 offset0:8 offset1:12
    v_mfma_f32_16x16x32_bf16 v[124:127], v[24:27], a[248:251], v[124:127]
    ds_read2st64_b32 v[24:25], v76 offset0:16 offset1:20
    ds_read2st64_b32 v[26:27], v77 offset0:16 offset1:20
    v_fmac_f32 v51, v179, v179
    v_mfma_f32_16x16x32_bf16 v[132:135], v[40:43], a[248:251], v[132:135]
    ds_read2st64_b32 v[40:41], v78 offset0:16 offset1:20
    ds_read2st64_b32 v[42:43], v79 offset0:16 offset1:20
    v_fmac_f32 v52, v208, v208
    v_mfma_f32_16x16x32_bf16 v[124:127], v[28:31], a[252:255], v[124:127]
    ds_read2st64_b32 v[28:29], v76 offset0:24 offset1:28
    ds_read2st64_b32 v[30:31], v77 offset0:24 offset1:28
    v_fmac_f32 v53, v209, v209
    v_mfma_f32_16x16x32_bf16 v[132:135], v[44:47], a[252:255], v[132:135]
    ds_read2st64_b32 v[44:45], v78 offset0:24 offset1:28
    ds_read2st64_b32 v[46:47], v79 offset0:24 offset1:28
    v_fmac_f32 v54, v210, v210
    v_mfma_f32_16x16x16_bf16 v[184:187], v[240:241], v[136:137], v[184:187]
    v_cvt_pk_bf16_f32 v146, v124, v125
    v_cvt_pk_bf16_f32 v147, v126, v127
    v_mfma_f32_16x16x16_bf16 v[188:191], v[240:241], v[138:139], v[188:191]
    v_fmac_f32 v55, v211, v211
    v_cvt_pk_bf16_f32 v150, v132, v133
    v_mfma_f32_16x16x16_bf16 v[216:219], v[242:243], v[140:141], v[216:219]
    v_cvt_pk_bf16_f32 v151, v134, v135
    v_fmac_f32 v48, v180, v180
    v_mfma_f32_16x16x16_bf16 v[220:223], v[242:243], v[142:143], v[220:223]
    v_fmac_f32 v49, v181, v181
    v_fmac_f32 v50, v182, v182
    v_mfma_f32_16x16x16_bf16 v[192:195], v[240:241], v[144:145], v[192:195]
    v_fmac_f32 v51, v183, v183
    v_fmac_f32 v52, v212, v212
    v_mfma_f32_16x16x16_bf16 v[196:199], v[240:241], v[146:147], v[196:199]
    v_fmac_f32 v53, v213, v213
    v_fmac_f32 v54, v214, v214
    v_mfma_f32_16x16x16_bf16 v[224:227], v[242:243], v[148:149], v[224:227]
    v_fmac_f32 v55, v215, v215
    v_fmac_f32 v48, v184, v184
    v_mfma_f32_16x16x16_bf16 v[228:231], v[242:243], v[150:151], v[228:231]
    v_fmac_f32 v49, v185, v185
    v_fmac_f32 v50, v186, v186
    s_waitcnt lgkmcnt(14)
    v_mfma_f32_16x16x32_bf16 v[104:107], a[0:3], v[16:19], 0
    v_fmac_f32 v51, v187, v187
    v_fmac_f32 v52, v216, v216
    s_waitcnt lgkmcnt(12)
    v_mfma_f32_16x16x32_bf16 v[112:115], a[0:3], v[32:35], 0
    v_fmac_f32 v53, v217, v217
    v_fmac_f32 v54, v218, v218
    s_waitcnt lgkmcnt(10)
    v_mfma_f32_16x16x32_bf16 v[104:107], a[4:7], v[20:23], v[104:107]
    v_fmac_f32 v55, v219, v219
    v_fmac_f32 v48, v188, v188
    s_waitcnt lgkmcnt(8)
    v_mfma_f32_16x16x32_bf16 v[112:115], a[4:7], v[36:39], v[112:115]
    v_fmac_f32 v49, v189, v189
    v_fmac_f32 v50, v190, v190
    s_waitcnt lgkmcnt(6)
    v_mfma_f32_16x16x32_bf16 v[104:107], a[8:11], v[24:27], v[104:107]
    v_fmac_f32 v51, v191, v191
    v_fmac_f32 v52, v220, v220
    s_waitcnt lgkmcnt(4)
    v_mfma_f32_16x16x32_bf16 v[112:115], a[8:11], v[40:43], v[112:115]
    v_fmac_f32 v53, v221, v221
    v_fmac_f32 v54, v222, v222
    s_waitcnt lgkmcnt(2)
    v_mfma_f32_16x16x32_bf16 v[104:107], a[12:15], v[28:31], v[104:107]
    v_fmac_f32 v55, v223, v223
    v_fmac_f32 v48, v192, v192
    s_waitcnt lgkmcnt(0)
    v_mfma_f32_16x16x32_bf16 v[112:115], a[12:15], v[44:47], v[112:115]
    v_fmac_f32 v49, v193, v193
    v_fmac_f32 v50, v194, v194
    v_mfma_f32_16x16x32_bf16 v[108:111], a[16:19], v[16:19], 0
    v_fmac_f32 v51, v195, v195
    v_fmac_f32 v52, v224, v224
    v_mfma_f32_16x16x32_bf16 v[116:119], a[16:19], v[32:35], 0
    v_fmac_f32 v53, v225, v225
    v_fmac_f32 v54, v226, v226
    v_mfma_f32_16x16x32_bf16 v[108:111], a[20:23], v[20:23], v[108:111]
    v_fmac_f32 v55, v227, v227
    v_fmac_f32 v48, v196, v196
    v_mfma_f32_16x16x32_bf16 v[116:119], a[20:23], v[36:39], v[116:119]
    v_fmac_f32 v49, v197, v197
    v_fmac_f32 v50, v198, v198
    v_mfma_f32_16x16x32_bf16 v[108:111], a[24:27], v[24:27], v[108:111]
    v_fmac_f32 v51, v199, v199
    v_fmac_f32 v52, v228, v228
    v_mfma_f32_16x16x32_bf16 v[116:119], a[24:27], v[40:43], v[116:119]
    v_fmac_f32 v53, v229, v229
    v_fmac_f32 v54, v230, v230
    v_mfma_f32_16x16x32_bf16 v[108:111], a[28:31], v[28:31], v[108:111]
    v_fmac_f32 v55, v231, v231
    v_cvt_pk_bf16_f32 v64, v48, v49
    v_mfma_f32_16x16x32_bf16 v[116:119], a[28:31], v[44:47], v[116:119]
    v_cvt_pk_bf16_f32 v65, v50, v51
    v_cvt_pk_bf16_f32 v66, v52, v53
    v_mfma_f32_16x16x32_bf16 v[120:123], v[16:19], v[16:19], 0
    v_cvt_pk_bf16_f32 v67, v54, v55
    v_cndmask_b32_dpp v250, v98, v250, vcc row_ror:8 row_mask:0xf bank_mask:0xf
    v_mfma_f32_16x16x32_bf16 v[124:127], v[32:35], v[32:35], 0
    ds_write_b32 v4, v250 offset:128
    v_cndmask_b32_dpp v251, v99, v251, vcc row_ror:8 row_mask:0xf bank_mask:0xf
    ds_write_b32 v4, v251 offset:256
    v_mfma_f32_16x16x32_bf16 v[68:71], v[64:67], v[88:91], 0
    ds_read_b128 v[160:163], v8 offset:128
    ds_read_b128 v[164:167], v8 offset:256
    v_cndmask_b32_dpp v249, v97, v249, vcc row_ror:8 row_mask:0xf bank_mask:0xf
    v_mfma_f32_16x16x32_bf16 v[72:75], v[64:67], v[92:95], 0
    v_cvt_pk_bf16_f32 v136, v104, v105
    v_cvt_pk_bf16_f32 v137, v106, v107
    v_mfma_f32_16x16x32_bf16 v[120:123], v[20:23], v[20:23], v[120:123]
    v_cvt_pk_bf16_f32 v138, v108, v109
    v_cvt_pk_bf16_f32 v139, v110, v111
    v_mfma_f32_16x16x32_bf16 v[124:127], v[36:39], v[36:39], v[124:127]
    v_cvt_pk_bf16_f32 v140, v112, v113
    v_cvt_pk_bf16_f32 v141, v114, v115
    v_mfma_f32_16x16x32_bf16 v[120:123], v[24:27], v[24:27], v[120:123]
    v_cvt_pk_bf16_f32 v142, v116, v117
    v_cvt_pk_bf16_f32 v143, v118, v119
    v_mfma_f32_16x16x32_bf16 v[124:127], v[40:43], v[40:43], v[124:127]
    v_permlane16_swap_b32 v56, v60
    v_mfma_f32_16x16x32_bf16 v[120:123], v[28:31], v[28:31], v[120:123]
    v_permlane16_swap_b32 v57, v61
    v_mfma_f32_16x16x32_bf16 v[96:99], v[80:83], v[32:35], 0
    s_waitcnt lgkmcnt(1)
    v_mul_f32 v13, v152, v160
    v_mfma_f32_16x16x32_bf16 v[124:127], v[44:47], v[44:47], v[124:127]
    s_waitcnt lgkmcnt(0)
    v_mul_f32 v14, v152, v164
    v_mfma_f32_16x16x32_bf16 v[96:99], v[84:87], v[36:39], v[96:99]
    v_fmac_f32 v13, v153, v161
    v_fmac_f32 v14, v153, v165
    v_fmac_f32 v13, v154, v162
    v_fmac_f32 v14, v154, v166
    v_fmac_f32 v13, v155, v163
    v_fmac_f32 v14, v155, v167
    v_mfma_f32_16x16x32_bf16 v[152:155], v[136:139], v[16:19], 0
    v_cndmask_b32 v120, v120, v121, s[32:33]
    v_permlane16_swap_b32 v13, v14
    v_add_f32 v13, v13, v14
    v_mov_b32 v14, v13
    v_mfma_f32_16x16x32_bf16 v[156:159], v[140:143], v[32:35], 0
    v_cndmask_b32 v124, v124, v125, s[32:33]
    v_permlane16_swap_b32 v13, v14
    v_add_f32 v13, v13, v248
    v_add_f32 v14, v14, v249
    v_mfma_f32_16x16x32_bf16 v[248:251], v[80:83], v[16:19], 0
    ds_read_b128 v[80:83], v15 offset:2048
    v_cndmask_b32 v120, v120, v122, s[34:35]
    v_cndmask_b32 v124, v124, v126, s[34:35]
    v_mfma_f32_16x16x32_bf16 v[248:251], v[84:87], v[20:23], v[248:251]
    ds_read_b128 v[84:87], v15 offset:3072
    v_cndmask_b32 v120, v120, v123, s[36:37]
    v_cndmask_b32 v124, v124, v127, s[36:37]
    v_mfma_f32_16x16x32_bf16 v[128:131], a[32:35], v[32:35], 0
    v_cndmask_b32 v11, 0, v120, s[38:39]
    v_cndmask_b32 v2, 0, v120, s[38:39]
    v_mfma_f32_16x16x32_bf16 v[128:131], a[36:39], v[36:39], v[128:131]
    v_cndmask_b32 v122, 0, v124, s[38:39]
    v_permlane16_swap_b32 v58, v62
    v_mfma_f32_16x16x32_bf16 v[128:131], a[40:43], v[40:43], v[128:131]
    v_mov_b32_dpp v11, v122 row_ror:8 row_mask:0xf bank_mask:0xc
    v_mov_b32_dpp v2, v122 row_ror:8 row_mask:0xf bank_mask:0x3
    v_mfma_f32_16x16x32_bf16 v[120:123], a[32:35], v[16:19], 0
    v_permlane16_swap_b32 v59, v63
    v_mfma_f32_16x16x32_bf16 v[120:123], a[36:39], v[20:23], v[120:123]
    v_add_f32 v56, v56, v60
    v_add_f32 v57, v57, v61
    s_waitcnt lgkmcnt(1)
    v_mfma_f32_16x16x32_bf16 v[248:251], v[80:83], v[24:27], v[248:251]
    v_add_f32 v58, v58, v62
    v_add_f32 v59, v59, v63
    v_mfma_f32_16x16x32_bf16 v[96:99], v[80:83], v[40:43], v[96:99]
    ds_read_b128 v[80:83], v15 offset:0
    v_lshl_add_u32 v253, v253, 8, v7
    v_cvt_pk_bf16_f32 v61, v56, v57
    s_waitcnt lgkmcnt(1)
    v_mfma_f32_16x16x32_bf16 v[248:251], v[84:87], v[28:31], v[248:251]
    buffer_store_dword v61, v253, s[12:15], 0 offen offset:0 sc1
    v_cvt_pk_bf16_f32 v63, v58, v59
    buffer_store_dword v63, v253, s[12:15], 0 offen offset:64 sc1
    v_mfma_f32_16x16x32_bf16 v[96:99], v[84:87], v[44:47], v[96:99]
    buffer_load_dwordx2 v[252:253], v3, s[8:11], s23 offen
    v_add_f32 v68, v68, v69
    v_add_f32 v70, v70, v71
    v_mfma_f32_16x16x32_bf16 v[120:123], a[40:43], v[24:27], v[120:123]
    s_lshl_b32 s23, s57, 4
    v_add_f32 v72, v72, v73
    v_add_f32 v74, v74, v75
    v_mfma_f32_16x16x32_bf16 v[120:123], a[44:47], v[28:31], v[120:123]
    s_add_u32 s23, s23, 131072
    v_add_f32 v68, v68, v70
    v_add_f32 v72, v72, v74
    v_mfma_f32_16x16x32_bf16 v[128:131], a[44:47], v[44:47], v[128:131]
    ds_read_b128 v[84:87], v15 offset:1024
    v_permlane32_swap_b32 v68, v72
    v_mfma_f32_16x16x32_bf16 v[124:127], a[48:51], v[16:19], 0
    v_add_f32 v5, v68, v72
    v_cvt_pk_bf16_f32 v144, v120, v121
    v_mfma_f32_16x16x32_bf16 v[132:135], a[48:51], v[32:35], 0
    v_cvt_pk_bf16_f32 v145, v122, v123
    v_mov_b32 v72, v5
    v_mfma_f32_16x16x32_bf16 v[124:127], a[52:55], v[20:23], v[124:127]
    v_cvt_pk_bf16_f32 v148, v128, v129
    v_cvt_pk_bf16_f32 v149, v130, v131
    v_mfma_f32_16x16x32_bf16 v[132:135], a[52:55], v[36:39], v[132:135]
    v_mul_f32 v13, s28, v13
    v_permlane16_swap_b32 v5, v72
    v_mfma_f32_16x16x32_bf16 v[124:127], a[56:59], v[24:27], v[124:127]
    v_fma_f32 v14, -v13, s24, v14
    v_add_f32 v5, v5, v72
    v_mfma_f32_16x16x32_bf16 v[132:135], a[56:59], v[40:43], v[132:135]
    v_mul_f32 v13, v13, v13
    v_fma_f32 v5, v5, s28, -v13
    v_mfma_f32_16x16x32_bf16 v[124:127], a[60:63], v[28:31], v[124:127]
    v_mul_f32 v6, v101, v101
    v_max_f32 v5, 0, v5
    v_mfma_f32_16x16x32_bf16 v[132:135], a[60:63], v[44:47], v[132:135]
    v_fma_f32 v5, v5, v6, s29
    v_rsq_f32 v5, v5
    v_mfma_f32_16x16x32_bf16 v[104:107], a[64:67], v[16:19], 0
    v_mul_f32 v14, s30, v14
    v_mul_f32 v14, v14, v101
    v_mfma_f32_16x16x32_bf16 v[112:115], a[64:67], v[32:35], 0
    v_cvt_pk_bf16_f32 v146, v124, v125
    v_cvt_pk_bf16_f32 v147, v126, v127
    v_mfma_f32_16x16x32_bf16 v[104:107], a[68:71], v[20:23], v[104:107]
    v_cvt_pk_bf16_f32 v150, v132, v133
    v_cvt_pk_bf16_f32 v151, v134, v135
    v_mfma_f32_16x16x32_bf16 v[152:155], v[144:147], v[20:23], v[152:155]
    v_mul_f32 v5, v5, v14
    v_permlane32_swap_b32 v11, v2
    v_mfma_f32_16x16x32_bf16 v[156:159], v[148:151], v[36:39], v[156:159]
    v_max_f32_dpp v6, v5, v5 quad_perm:[1,0,3,2] row_mask:0xf bank_mask:0xf
    v_add_f32 v11, v11, v2
    v_mfma_f32_16x16x32_bf16 v[112:115], a[68:71], v[36:39], v[112:115]
    v_max_f32_dpp v6, v6, v6 quad_perm:[2,3,0,1] row_mask:0xf bank_mask:0xf
    v_mov_b32 v2, v11
    v_mfma_f32_16x16x32_bf16 v[104:107], a[72:75], v[24:27], v[104:107]
    v_max_f32_dpp v6, v6, v6 row_half_mirror row_mask:0xf bank_mask:0xf
    v_sub_f32 v5, v5, v6
    v_mfma_f32_16x16x32_bf16 v[112:115], a[72:75], v[40:43], v[112:115]
    v_exp_f32 v5, v5
    v_mfma_f32_16x16x32_bf16 v[104:107], a[76:79], v[28:31], v[104:107]
    v_permlane16_swap_b32 v11, v2
    v_mfma_f32_16x16x32_bf16 v[112:115], a[76:79], v[44:47], v[112:115]
    v_add_f32_dpp v6, v5, v5 quad_perm:[1,0,3,2] row_mask:0xf bank_mask:0xf
    v_mul_f32 v5, v5, v101
    v_mfma_f32_16x16x32_bf16 v[108:111], a[80:83], v[16:19], 0
    buffer_load_dword v101, v102, s[8:11], s23 offen
    v_add_f32_dpp v6, v6, v6 quad_perm:[2,3,0,1] row_mask:0xf bank_mask:0xf
    v_cndmask_b32_dpp v248, v96, v248, vcc row_ror:8 row_mask:0xf bank_mask:0xf
    v_mfma_f32_16x16x32_bf16 v[116:119], a[80:83], v[32:35], 0
    v_cvt_pk_bf16_f32 v136, v104, v105
    v_cvt_pk_bf16_f32 v137, v106, v107
    v_mfma_f32_16x16x32_bf16 v[108:111], a[84:87], v[20:23], v[108:111]
    v_cvt_pk_bf16_f32 v140, v112, v113
    v_cvt_pk_bf16_f32 v141, v114, v115
    v_mfma_f32_16x16x32_bf16 v[116:119], a[84:87], v[36:39], v[116:119]
    v_add_f32_dpp v6, v6, v6 row_half_mirror row_mask:0xf bank_mask:0xf
    v_rcp_f32 v6, v6
    v_mfma_f32_16x16x32_bf16 v[108:111], a[88:91], v[24:27], v[108:111]
    v_mul_f32 v5, v5, v6
    ds_write_b32 v4, v5 offset:512
    v_mfma_f32_16x16x32_bf16 v[116:119], a[88:91], v[40:43], v[116:119]
    ds_read_b128 v[64:67], v9 offset:512
    ds_read_b128 v[68:71], v9 offset:576
    v_add_f32 v11, v11, v2
    v_mfma_f32_16x16x32_bf16 v[108:111], a[92:95], v[28:31], v[108:111]
    v_mul_f32 v2, s28, v248
    v_mul_f32 v2, v2, v2
    v_mfma_f32_16x16x32_bf16 v[116:119], a[92:95], v[44:47], v[116:119]
    v_fma_f32 v11, v11, s28, -v2
    s_waitcnt vmcnt(18)
    v_mul_f32 v2, v100, v100
    v_mfma_f32_16x16x32_bf16 v[120:123], a[96:99], v[16:19], 0
    v_max_f32 v11, 0, v11
    v_fma_f32 v11, v11, v2, s29
    v_mfma_f32_16x16x32_bf16 v[128:131], a[96:99], v[32:35], 0
    v_cvt_pk_bf16_f32 v138, v108, v109
    v_cvt_pk_bf16_f32 v139, v110, v111
    v_mfma_f32_16x16x32_bf16 v[120:123], a[100:103], v[20:23], v[120:123]
    v_cvt_pk_bf16_f32 v142, v116, v117
    v_cvt_pk_bf16_f32 v143, v118, v119
    v_mfma_f32_16x16x32_bf16 v[152:155], v[136:139], v[24:27], v[152:155]
    v_rsq_f32 v11, v11
    v_mfma_f32_16x16x32_bf16 v[156:159], v[140:143], v[40:43], v[156:159]
    s_waitcnt lgkmcnt(1)
    v_mul_f32 v48, v64, v168
    v_mfma_f32_16x16x32_bf16 v[128:131], a[100:103], v[36:39], v[128:131]
    v_fmac_f32 v48, v65, v169
    v_fmac_f32 v48, v66, v170
    v_mfma_f32_16x16x32_bf16 v[120:123], a[104:107], v[24:27], v[120:123]
    v_fmac_f32 v48, v67, v171
    v_mul_f32 v49, v64, v172
    v_mfma_f32_16x16x32_bf16 v[128:131], a[104:107], v[40:43], v[128:131]
    v_fmac_f32 v49, v65, v173
    v_fmac_f32 v49, v66, v174
    v_mfma_f32_16x16x32_bf16 v[120:123], a[108:111], v[28:31], v[120:123]
    v_fmac_f32 v49, v67, v175
    s_waitcnt lgkmcnt(0)
    v_mul_f32 v56, v68, v200
    v_mfma_f32_16x16x32_bf16 v[128:131], a[108:111], v[44:47], v[128:131]
    v_fmac_f32 v56, v69, v201
    v_fmac_f32 v56, v70, v202
    v_mfma_f32_16x16x32_bf16 v[124:127], a[112:115], v[16:19], 0
    v_fmac_f32 v56, v71, v203
    v_mul_f32 v57, v68, v204
    v_mfma_f32_16x16x32_bf16 v[132:135], a[112:115], v[32:35], 0
    v_cvt_pk_bf16_f32 v144, v120, v121
    v_cvt_pk_bf16_f32 v145, v122, v123
    v_mfma_f32_16x16x32_bf16 v[124:127], a[116:119], v[20:23], v[124:127]
    v_cvt_pk_bf16_f32 v148, v128, v129
    v_cvt_pk_bf16_f32 v149, v130, v131
    v_mfma_f32_16x16x32_bf16 v[132:135], a[116:119], v[36:39], v[132:135]
    v_fmac_f32 v57, v69, v205
    v_fmac_f32 v57, v70, v206
    v_mfma_f32_16x16x32_bf16 v[124:127], a[120:123], v[24:27], v[124:127]
    v_fmac_f32 v57, v71, v207
    v_mul_f32 v50, v64, v176
    v_mfma_f32_16x16x32_bf16 v[132:135], a[120:123], v[40:43], v[132:135]
    v_fmac_f32 v50, v65, v177
    v_fmac_f32 v50, v66, v178
    v_mfma_f32_16x16x32_bf16 v[124:127], a[124:127], v[28:31], v[124:127]
    v_fmac_f32 v50, v67, v179
    v_mul_f32 v51, v64, v180
    v_mfma_f32_16x16x32_bf16 v[132:135], a[124:127], v[44:47], v[132:135]
    v_fmac_f32 v51, v65, v181
    v_fmac_f32 v51, v66, v182
    v_mfma_f32_16x16x32_bf16 v[104:107], v[16:19], a[128:131], 0
    v_fmac_f32 v51, v67, v183
    v_mul_f32 v58, v68, v208
    v_mfma_f32_16x16x32_bf16 v[112:115], v[32:35], a[128:131], 0
    v_cvt_pk_bf16_f32 v146, v124, v125
    v_cvt_pk_bf16_f32 v147, v126, v127
    v_mfma_f32_16x16x32_bf16 v[104:107], v[20:23], a[132:135], v[104:107]
    v_cvt_pk_bf16_f32 v150, v132, v133
    v_cvt_pk_bf16_f32 v151, v134, v135
    v_mfma_f32_16x16x32_bf16 v[152:155], v[144:147], v[28:31], v[152:155]
    v_fmac_f32 v58, v69, v209
    v_fmac_f32 v58, v70, v210
    v_mfma_f32_16x16x32_bf16 v[156:159], v[148:151], v[44:47], v[156:159]
    v_fmac_f32 v58, v71, v211
    v_mul_f32 v59, v68, v212
    v_mfma_f32_16x16x32_bf16 v[112:115], v[36:39], a[132:135], v[112:115]
    v_fmac_f32 v59, v69, v213
    v_fmac_f32 v59, v70, v214
    v_mfma_f32_16x16x32_bf16 v[104:107], v[24:27], a[136:139], v[104:107]
    v_fmac_f32 v59, v71, v215
    v_mul_f32 v11, v11, v100
    v_mfma_f32_16x16x32_bf16 v[112:115], v[40:43], a[136:139], v[112:115]
    ds_write_b32 v4, v11
    ds_read_b128 v[244:247], v8
    v_mul_f32 v52, v64, v184
    v_mfma_f32_16x16x32_bf16 v[104:107], v[28:31], a[140:143], v[104:107]
    v_fmac_f32 v52, v65, v185
    v_fmac_f32 v52, v66, v186
    v_mfma_f32_16x16x32_bf16 v[112:115], v[44:47], a[140:143], v[112:115]
    v_fmac_f32 v52, v67, v187
    v_mul_f32 v53, v64, v188
    v_mfma_f32_16x16x32_bf16 v[108:111], v[16:19], a[144:147], 0
    v_fmac_f32 v53, v65, v189
    v_fmac_f32 v53, v66, v190
    v_mfma_f32_16x16x32_bf16 v[116:119], v[32:35], a[144:147], 0
    v_fmac_f32 v53, v67, v191
    v_mul_f32 v60, v68, v216
    v_mfma_f32_16x16x32_bf16 v[108:111], v[20:23], a[148:151], v[108:111]
    v_fmac_f32 v60, v69, v217
    v_fmac_f32 v60, v70, v218
    v_mfma_f32_16x16x32_bf16 v[116:119], v[36:39], a[148:151], v[116:119]
    v_fmac_f32 v60, v71, v219
    v_cndmask_b32_dpp v152, v156, v152, vcc row_ror:8 row_mask:0xf bank_mask:0xf
    v_mfma_f32_16x16x32_bf16 v[108:111], v[24:27], a[152:155], v[108:111]
    v_cndmask_b32_dpp v153, v157, v153, vcc row_ror:8 row_mask:0xf bank_mask:0xf
    v_cndmask_b32_dpp v154, v158, v154, vcc row_ror:8 row_mask:0xf bank_mask:0xf
    v_mfma_f32_16x16x32_bf16 v[116:119], v[40:43], a[152:155], v[116:119]
    v_mul_f32 v61, v68, v220
    v_cndmask_b32_dpp v155, v159, v155, vcc row_ror:8 row_mask:0xf bank_mask:0xf
    v_mfma_f32_16x16x32_bf16 v[108:111], v[28:31], a[156:159], v[108:111]
    s_waitcnt lgkmcnt(0)
    v_mul_f32 v152, v152, v244
    v_mfma_f32_16x16x32_bf16 v[116:119], v[44:47], a[156:159], v[116:119]
    v_mul_f32 v153, v153, v245
    v_mul_f32 v154, v154, v246
    v_mfma_f32_16x16x32_bf16 v[168:171], v[16:19], v[232:235], 0
    v_fmac_f32 v61, v69, v221
    v_max3_f32 v156, v152, v153, v154
    v_mfma_f32_16x16x32_bf16 v[172:175], v[16:19], v[236:239], 0
    v_mul_f32 v155, v155, v247
    v_fmac_f32 v61, v70, v222
    v_mfma_f32_16x16x32_bf16 v[200:203], v[32:35], v[232:235], 0
    v_max_f32 v156, v156, v155
    v_fmac_f32 v61, v71, v223
    v_mfma_f32_16x16x32_bf16 v[204:207], v[32:35], v[236:239], 0
    v_mov_b32 v157, v156
    v_mul_f32 v54, v64, v192
    v_mfma_f32_16x16x32_bf16 v[176:179], v[20:23], v[232:235], 0
    v_permlane16_swap_b32 v156, v157
    v_mfma_f32_16x16x32_bf16 v[180:183], v[20:23], v[236:239], 0
    v_fmac_f32 v54, v65, v193
    v_fmac_f32 v54, v66, v194
    v_mfma_f32_16x16x32_bf16 v[208:211], v[36:39], v[232:235], 0
    v_max_f32 v156, v156, v157
    v_fmac_f32 v54, v67, v195
    v_mfma_f32_16x16x32_bf16 v[212:215], v[36:39], v[236:239], 0
    v_mul_f32 v156, v156, v11
    v_fma_f32 v152, v152, v11, -v156
    v_mfma_f32_16x16x32_bf16 v[120:123], v[16:19], a[160:163], 0
    v_fma_f32 v153, v153, v11, -v156
    v_fma_f32 v154, v154, v11, -v156
    v_mfma_f32_16x16x32_bf16 v[128:131], v[32:35], a[160:163], 0
    v_fma_f32 v155, v155, v11, -v156
    v_mul_f32 v55, v64, v196
    v_mfma_f32_16x16x32_bf16 v[120:123], v[20:23], a[164:167], v[120:123]
    v_exp_f32 v152, v152
    v_mfma_f32_16x16x32_bf16 v[128:131], v[36:39], a[164:167], v[128:131]
    v_exp_f32 v153, v153
    v_mfma_f32_16x16x32_bf16 v[120:123], v[24:27], a[168:171], v[120:123]
    v_exp_f32 v154, v154
    v_mfma_f32_16x16x32_bf16 v[128:131], v[40:43], a[168:171], v[128:131]
    v_exp_f32 v155, v155
    v_mfma_f32_16x16x32_bf16 v[120:123], v[28:31], a[172:175], v[120:123]
    v_fmac_f32 v55, v65, v197
    v_fmac_f32 v55, v66, v198
    v_mfma_f32_16x16x32_bf16 v[128:131], v[44:47], a[172:175], v[128:131]
    v_fmac_f32 v55, v67, v199
    v_add_f32 v156, v152, v153
    v_mfma_f32_16x16x32_bf16 v[124:127], v[16:19], a[176:179], 0
    v_add_f32 v157, v154, v155
    v_add_f32 v156, v156, v157
    v_mfma_f32_16x16x32_bf16 v[132:135], v[32:35], a[176:179], 0
    v_mov_b32 v157, v156
    v_mul_f32 v62, v68, v224
    v_mfma_f32_16x16x32_bf16 v[124:127], v[20:23], a[180:183], v[124:127]
    v_fmac_f32 v62, v69, v225
    v_fmac_f32 v62, v70, v226
    v_mfma_f32_16x16x32_bf16 v[132:135], v[36:39], a[180:183], v[132:135]
    v_permlane16_swap_b32 v156, v157
    v_mfma_f32_16x16x32_bf16 v[124:127], v[24:27], a[184:187], v[124:127]
    v_fmac_f32 v62, v71, v227
    v_add_f32 v156, v156, v157
    v_mfma_f32_16x16x32_bf16 v[132:135], v[40:43], a[184:187], v[132:135]
    v_mul_f32 v63, v68, v228
    v_mul_f32 v156, v156, v100
    v_mfma_f32_16x16x32_bf16 v[124:127], v[28:31], a[188:191], v[124:127]
    v_fmac_f32 v63, v69, v229
    v_rcp_f32 v156, v156
    v_mfma_f32_16x16x32_bf16 v[132:135], v[44:47], a[188:191], v[132:135]
    v_fmac_f32 v63, v70, v230
    v_fmac_f32 v63, v71, v231
    v_mfma_f32_16x16x32_bf16 v[184:187], v[24:27], v[232:235], 0
    v_mul_f32 v152, v152, v244
    v_mul_f32 v153, v153, v245
    v_mfma_f32_16x16x32_bf16 v[188:191], v[24:27], v[236:239], 0
    v_mul_f32 v154, v154, v246
    v_mul_f32 v155, v155, v247
    v_mfma_f32_16x16x32_bf16 v[216:219], v[40:43], v[232:235], 0
    v_mul_f32 v152, v152, v156
    v_mul_f32 v153, v153, v156
    v_mfma_f32_16x16x32_bf16 v[220:223], v[40:43], v[236:239], 0
    v_mul_f32 v154, v154, v156
    v_mul_f32 v155, v155, v156
    v_mfma_f32_16x16x32_bf16 v[192:195], v[28:31], v[232:235], 0
    v_cvt_pk_bf16_f32 v158, v152, v153
    v_cvt_pk_bf16_f32 v159, v154, v155
    v_mfma_f32_16x16x32_bf16 v[196:199], v[28:31], v[236:239], 0
    v_cvt_pk_bf16_f32 v136, v104, v105
    v_cvt_pk_bf16_f32 v137, v106, v107
    v_mfma_f32_16x16x32_bf16 v[224:227], v[44:47], v[232:235], 0
    v_and_b32 v240, v158, v10
    v_and_b32 v241, v159, v10
    v_mfma_f32_16x16x32_bf16 v[228:231], v[44:47], v[236:239], 0
    v_cvt_pk_bf16_f32 v138, v108, v109
    v_cvt_pk_bf16_f32 v139, v110, v111
    v_mfma_f32_16x16x16_bf16 v[168:171], v[240:241], v[136:137], v[168:171]
    v_cvt_pk_bf16_f32 v140, v112, v113
    v_cvt_pk_bf16_f32 v141, v114, v115
    v_mfma_f32_16x16x16_bf16 v[172:175], v[240:241], v[138:139], v[172:175]
    v_and_b32_dpp v242, v158, v10 row_ror:8 row_mask:0xf bank_mask:0xf
    v_and_b32_dpp v243, v159, v10 row_ror:8 row_mask:0xf bank_mask:0xf
    v_mfma_f32_16x16x32_bf16 v[104:107], v[16:19], a[192:195], 0
    v_cvt_pk_bf16_f32 v142, v116, v117
    v_cvt_pk_bf16_f32 v143, v118, v119
    v_mfma_f32_16x16x16_bf16 v[200:203], v[242:243], v[140:141], v[200:203]
    v_cvt_pk_bf16_f32 v144, v120, v121
    v_cvt_pk_bf16_f32 v145, v122, v123
    v_mfma_f32_16x16x16_bf16 v[204:207], v[242:243], v[142:143], v[204:207]
    v_cvt_pk_bf16_f32 v146, v124, v125
    v_cvt_pk_bf16_f32 v147, v126, v127
    v_mfma_f32_16x16x32_bf16 v[112:115], v[32:35], a[192:195], 0
    v_cvt_pk_bf16_f32 v148, v128, v129
    v_cvt_pk_bf16_f32 v149, v130, v131
    v_mfma_f32_16x16x32_bf16 v[104:107], v[20:23], a[196:199], v[104:107]
    v_cvt_pk_bf16_f32 v150, v132, v133
    v_cvt_pk_bf16_f32 v151, v134, v135
    v_mfma_f32_16x16x32_bf16 v[112:115], v[36:39], a[196:199], v[112:115]
    v_permlane16_swap_b32 v48, v52
    v_mfma_f32_16x16x32_bf16 v[104:107], v[24:27], a[200:203], v[104:107]
    v_permlane16_swap_b32 v49, v53
    v_mfma_f32_16x16x32_bf16 v[112:115], v[40:43], a[200:203], v[112:115]
    v_permlane16_swap_b32 v50, v54
    v_mfma_f32_16x16x32_bf16 v[104:107], v[28:31], a[204:207], v[104:107]
    v_permlane16_swap_b32 v51, v55
    v_mfma_f32_16x16x32_bf16 v[112:115], v[44:47], a[204:207], v[112:115]
    v_permlane16_swap_b32 v56, v60
    v_mfma_f32_16x16x32_bf16 v[108:111], v[16:19], a[208:211], 0
    v_permlane16_swap_b32 v57, v61
    v_mfma_f32_16x16x32_bf16 v[116:119], v[32:35], a[208:211], 0
    v_permlane16_swap_b32 v58, v62
    v_mfma_f32_16x16x32_bf16 v[108:111], v[20:23], a[212:215], v[108:111]
    v_cvt_pk_bf16_f32 v136, v104, v105
    v_cvt_pk_bf16_f32 v137, v106, v107
    v_mfma_f32_16x16x32_bf16 v[116:119], v[36:39], a[212:215], v[116:119]
    v_cvt_pk_bf16_f32 v140, v112, v113
    v_cvt_pk_bf16_f32 v141, v114, v115
    v_mfma_f32_16x16x32_bf16 v[108:111], v[24:27], a[216:219], v[108:111]
    v_permlane16_swap_b32 v59, v63
    v_mfma_f32_16x16x32_bf16 v[116:119], v[40:43], a[216:219], v[116:119]
    v_xor_b32 v77, 512, v1
    v_xor_b32 v76, 64, v1
    v_mfma_f32_16x16x32_bf16 v[108:111], v[28:31], a[220:223], v[108:111]
    v_add_f32 v48, v48, v52
    v_add_f32 v49, v49, v53
    v_mfma_f32_16x16x32_bf16 v[116:119], v[44:47], a[220:223], v[116:119]
    v_add_f32 v50, v50, v54
    v_add_f32 v51, v51, v55
    v_mfma_f32_16x16x16_bf16 v[176:179], v[240:241], v[144:145], v[176:179]
    v_add_f32 v56, v56, v60
    v_add_f32 v57, v57, v61
    v_mfma_f32_16x16x16_bf16 v[180:183], v[240:241], v[146:147], v[180:183]
    v_cvt_pk_bf16_f32 v138, v108, v109
    v_cvt_pk_bf16_f32 v139, v110, v111
    v_mfma_f32_16x16x16_bf16 v[208:211], v[242:243], v[148:149], v[208:211]
    v_cvt_pk_bf16_f32 v142, v116, v117
    v_cvt_pk_bf16_f32 v143, v118, v119
    v_mfma_f32_16x16x16_bf16 v[212:215], v[242:243], v[150:151], v[212:215]
    v_add_f32 v58, v58, v62
    v_add_f32 v59, v59, v63
    v_mfma_f32_16x16x32_bf16 v[120:123], v[16:19], a[224:227], 0
    v_lshl_add_u32 v254, v254, 8, v7
    v_lshl_add_u32 v255, v255, 8, v7
    v_mfma_f32_16x16x32_bf16 v[128:131], v[32:35], a[224:227], 0
    v_cvt_pk_bf16_f32 v53, v48, v49
    v_cvt_pk_bf16_f32 v55, v50, v51
    v_mfma_f32_16x16x32_bf16 v[120:123], v[20:23], a[228:231], v[120:123]
    buffer_store_dword v53, v254, s[12:15], 0 offen offset:0 sc1
    v_cvt_pk_bf16_f32 v61, v56, v57
    v_cvt_pk_bf16_f32 v63, v58, v59
    v_mfma_f32_16x16x32_bf16 v[128:131], v[36:39], a[228:231], v[128:131]
    buffer_store_dword v55, v254, s[12:15], 0 offen offset:64 sc1
    buffer_store_dword v61, v255, s[12:15], 0 offen offset:0 sc1
    buffer_store_dword v63, v255, s[12:15], 0 offen offset:64 sc1
    v_mfma_f32_16x16x32_bf16 v[120:123], v[24:27], a[232:235], v[120:123]
    buffer_load_dwordx2 v[254:255], v3, s[8:11], s23 offen
    v_xor_b32 v79, 516, v1
    v_xor_b32 v78, 68, v1
    v_mfma_f32_16x16x32_bf16 v[128:131], v[40:43], a[232:235], v[128:131]
    s_lshl_b32 s23, s58, 4
    v_mul_f32 v48, v168, v168
    v_mul_f32 v49, v169, v169
    v_mfma_f32_16x16x32_bf16 v[120:123], v[28:31], a[236:239], v[120:123]
    s_add_u32 s23, s23, 131072
    v_mul_f32 v50, v170, v170
    v_mul_f32 v51, v171, v171
    v_mfma_f32_16x16x32_bf16 v[128:131], v[44:47], a[236:239], v[128:131]
    s_add_u32 s23, s23, s59
    v_mul_f32 v52, v200, v200
    v_mul_f32 v53, v201, v201
    v_mfma_f32_16x16x32_bf16 v[124:127], v[16:19], a[240:243], 0
    ds_read2st64_b32 v[16:17], v76 offset0:0 offset1:4
    v_cvt_pk_bf16_f32 v144, v120, v121
    v_cvt_pk_bf16_f32 v145, v122, v123
    v_mfma_f32_16x16x32_bf16 v[132:135], v[32:35], a[240:243], 0
    ds_read2st64_b32 v[18:19], v77 offset0:0 offset1:4
    v_cvt_pk_bf16_f32 v148, v128, v129
    v_cvt_pk_bf16_f32 v149, v130, v131
    v_mfma_f32_16x16x32_bf16 v[124:127], v[20:23], a[244:247], v[124:127]
    ds_read2st64_b32 v[32:33], v78 offset0:0 offset1:4
    ds_read2st64_b32 v[34:35], v79 offset0:0 offset1:4
    ds_read2st64_b32 v[20:21], v76 offset0:8 offset1:12
    v_mfma_f32_16x16x32_bf16 v[132:135], v[36:39], a[244:247], v[132:135]
    ds_read2st64_b32 v[22:23], v77 offset0:8 offset1:12
    ds_read2st64_b32 v[36:37], v78 offset0:8 offset1:12
    ds_read2st64_b32 v[38:39], v79 offset0:8 offset1:12
    v_mfma_f32_16x16x32_bf16 v[124:127], v[24:27], a[248:251], v[124:127]
    ds_read2st64_b32 v[24:25], v76 offset0:16 offset1:20
    ds_read2st64_b32 v[26:27], v77 offset0:16 offset1:20
    v_mul_f32 v54, v202, v202
    v_mfma_f32_16x16x32_bf16 v[132:135], v[40:43], a[248:251], v[132:135]
    ds_read2st64_b32 v[40:41], v78 offset0:16 offset1:20
    ds_read2st64_b32 v[42:43], v79 offset0:16 offset1:20
    v_mul_f32 v55, v203, v203
    v_mfma_f32_16x16x32_bf16 v[124:127], v[28:31], a[252:255], v[124:127]
    ds_read2st64_b32 v[28:29], v76 offset0:24 offset1:28
    ds_read2st64_b32 v[30:31], v77 offset0:24 offset1:28
    v_fmac_f32 v48, v172, v172
    v_mfma_f32_16x16x32_bf16 v[132:135], v[44:47], a[252:255], v[132:135]
    ds_read2st64_b32 v[44:45], v78 offset0:24 offset1:28
    ds_read2st64_b32 v[46:47], v79 offset0:24 offset1:28
    v_fmac_f32 v49, v173, v173
    v_mfma_f32_16x16x16_bf16 v[184:187], v[240:241], v[136:137], v[184:187]
    v_cvt_pk_bf16_f32 v146, v124, v125
    v_cvt_pk_bf16_f32 v147, v126, v127
    v_mfma_f32_16x16x16_bf16 v[188:191], v[240:241], v[138:139], v[188:191]
    v_fmac_f32 v50, v174, v174
    v_cvt_pk_bf16_f32 v150, v132, v133
    v_mfma_f32_16x16x16_bf16 v[216:219], v[242:243], v[140:141], v[216:219]
    v_cvt_pk_bf16_f32 v151, v134, v135
    v_fmac_f32 v51, v175, v175
    v_mfma_f32_16x16x16_bf16 v[220:223], v[242:243], v[142:143], v[220:223]
    v_fmac_f32 v52, v204, v204
    v_fmac_f32 v53, v205, v205
    v_mfma_f32_16x16x16_bf16 v[192:195], v[240:241], v[144:145], v[192:195]
    v_fmac_f32 v54, v206, v206
    v_fmac_f32 v55, v207, v207
    v_mfma_f32_16x16x16_bf16 v[196:199], v[240:241], v[146:147], v[196:199]
    v_fmac_f32 v48, v176, v176
    v_fmac_f32 v49, v177, v177
    v_mfma_f32_16x16x16_bf16 v[224:227], v[242:243], v[148:149], v[224:227]
    v_fmac_f32 v50, v178, v178
    v_fmac_f32 v51, v179, v179
    v_mfma_f32_16x16x16_bf16 v[228:231], v[242:243], v[150:151], v[228:231]
    s_waitcnt lgkmcnt(0) vmcnt(11)
    s_barrier
    s_cmp_eq_u32 s31, 0
    s_cbranch_scc0 K4_x
    v_fmac_f32 v52, v208, v208
    v_mfma_f32_16x16x32_bf16 v[104:107], a[0:3], v[16:19], 0
    v_fmac_f32 v53, v209, v209
    v_fmac_f32 v54, v210, v210
    v_mfma_f32_16x16x32_bf16 v[112:115], a[0:3], v[32:35], 0
    v_fmac_f32 v55, v211, v211
    v_fmac_f32 v48, v180, v180
    v_mfma_f32_16x16x32_bf16 v[104:107], a[4:7], v[20:23], v[104:107]
    v_fmac_f32 v49, v181, v181
    v_fmac_f32 v50, v182, v182
    v_mfma_f32_16x16x32_bf16 v[112:115], a[4:7], v[36:39], v[112:115]
    v_fmac_f32 v51, v183, v183
    v_fmac_f32 v52, v212, v212
    v_mfma_f32_16x16x32_bf16 v[104:107], a[8:11], v[24:27], v[104:107]
    v_fmac_f32 v53, v213, v213
    v_fmac_f32 v54, v214, v214
    v_mfma_f32_16x16x32_bf16 v[112:115], a[8:11], v[40:43], v[112:115]
    v_fmac_f32 v55, v215, v215
    v_fmac_f32 v48, v184, v184
    v_mfma_f32_16x16x32_bf16 v[104:107], a[12:15], v[28:31], v[104:107]
    v_fmac_f32 v49, v185, v185
    v_fmac_f32 v50, v186, v186
    v_mfma_f32_16x16x32_bf16 v[112:115], a[12:15], v[44:47], v[112:115]
    v_fmac_f32 v51, v187, v187
    v_fmac_f32 v52, v216, v216
    v_mfma_f32_16x16x32_bf16 v[108:111], a[16:19], v[16:19], 0
    v_fmac_f32 v53, v217, v217
    v_fmac_f32 v54, v218, v218
    v_mfma_f32_16x16x32_bf16 v[116:119], a[16:19], v[32:35], 0
    v_fmac_f32 v55, v219, v219
    v_fmac_f32 v48, v188, v188
    v_mfma_f32_16x16x32_bf16 v[108:111], a[20:23], v[20:23], v[108:111]
    v_fmac_f32 v49, v189, v189
    v_fmac_f32 v50, v190, v190
    v_mfma_f32_16x16x32_bf16 v[116:119], a[20:23], v[36:39], v[116:119]
    v_fmac_f32 v51, v191, v191
    v_fmac_f32 v52, v220, v220
    v_mfma_f32_16x16x32_bf16 v[108:111], a[24:27], v[24:27], v[108:111]
    v_fmac_f32 v53, v221, v221
    v_fmac_f32 v54, v222, v222
    v_mfma_f32_16x16x32_bf16 v[116:119], a[24:27], v[40:43], v[116:119]
    v_fmac_f32 v55, v223, v223
    v_fmac_f32 v48, v192, v192
    v_mfma_f32_16x16x32_bf16 v[108:111], a[28:31], v[28:31], v[108:111]
    v_fmac_f32 v49, v193, v193
    v_fmac_f32 v50, v194, v194
    v_mfma_f32_16x16x32_bf16 v[116:119], a[28:31], v[44:47], v[116:119]
    v_fmac_f32 v51, v195, v195
    v_fmac_f32 v52, v224, v224
    v_mfma_f32_16x16x32_bf16 v[120:123], v[16:19], v[16:19], 0
    v_fmac_f32 v53, v225, v225
    v_fmac_f32 v54, v226, v226
    v_mfma_f32_16x16x32_bf16 v[124:127], v[32:35], v[32:35], 0
    v_fmac_f32 v55, v227, v227
    v_fmac_f32 v48, v196, v196
    v_mfma_f32_16x16x32_bf16 v[120:123], v[20:23], v[20:23], v[120:123]
    v_fmac_f32 v49, v197, v197
    v_fmac_f32 v50, v198, v198
    v_mfma_f32_16x16x32_bf16 v[124:127], v[36:39], v[36:39], v[124:127]
    v_fmac_f32 v51, v199, v199
    v_fmac_f32 v52, v228, v228
    v_fmac_f32 v53, v229, v229
    v_fmac_f32 v54, v230, v230
    v_fmac_f32 v55, v231, v231
    v_cvt_pk_bf16_f32 v64, v48, v49
    v_cvt_pk_bf16_f32 v65, v50, v51
    v_cvt_pk_bf16_f32 v66, v52, v53
    v_cvt_pk_bf16_f32 v67, v54, v55
    v_mfma_f32_16x16x32_bf16 v[120:123], v[24:27], v[24:27], v[120:123]
    v_cndmask_b32_dpp v250, v98, v250, vcc row_ror:8 row_mask:0xf bank_mask:0xf
    v_cndmask_b32_dpp v251, v99, v251, vcc row_ror:8 row_mask:0xf bank_mask:0xf
    v_mfma_f32_16x16x32_bf16 v[68:71], v[64:67], v[88:91], 0
    ds_write_b32 v4, v250 offset:128
    ds_write_b32 v4, v251 offset:256
    ds_read_b128 v[160:163], v8 offset:128
    v_mfma_f32_16x16x32_bf16 v[72:75], v[64:67], v[92:95], 0
    ds_read_b128 v[164:167], v8 offset:256
    v_cndmask_b32_dpp v249, v97, v249, vcc row_ror:8 row_mask:0xf bank_mask:0xf
    v_cvt_pk_bf16_f32 v136, v104, v105
    v_mfma_f32_16x16x32_bf16 v[124:127], v[40:43], v[40:43], v[124:127]
    v_cvt_pk_bf16_f32 v137, v106, v107
    v_cvt_pk_bf16_f32 v138, v108, v109
    v_mfma_f32_16x16x32_bf16 v[120:123], v[28:31], v[28:31], v[120:123]
    v_cvt_pk_bf16_f32 v139, v110, v111
    v_cvt_pk_bf16_f32 v140, v112, v113
    v_mfma_f32_16x16x32_bf16 v[96:99], v[80:83], v[32:35], 0
    v_cvt_pk_bf16_f32 v141, v114, v115
    v_cvt_pk_bf16_f32 v142, v116, v117
    v_mfma_f32_16x16x32_bf16 v[124:127], v[44:47], v[44:47], v[124:127]
    v_cvt_pk_bf16_f32 v143, v118, v119
    v_add_f32 v68, v68, v69
    v_mfma_f32_16x16x32_bf16 v[96:99], v[84:87], v[36:39], v[96:99]
    v_cndmask_b32 v120, v120, v121, s[32:33]
    v_cndmask_b32 v120, v120, v122, s[34:35]
    v_mfma_f32_16x16x32_bf16 v[156:159], v[140:143], v[32:35], 0
    v_cndmask_b32 v120, v120, v123, s[36:37]
    s_waitcnt lgkmcnt(1)
    v_mul_f32 v13, v152, v160
    s_waitcnt lgkmcnt(0)
    v_mul_f32 v14, v152, v164
    v_fmac_f32 v13, v153, v161
    v_fmac_f32 v14, v153, v165
    v_fmac_f32 v13, v154, v162
    v_fmac_f32 v14, v154, v166
    v_fmac_f32 v13, v155, v163
    v_fmac_f32 v14, v155, v167
    v_mfma_f32_16x16x32_bf16 v[152:155], v[136:139], v[16:19], 0
    v_cndmask_b32 v124, v124, v125, s[32:33]
    v_permlane16_swap_b32 v13, v14
    v_add_f32 v13, v13, v14
    v_mov_b32 v14, v13
    v_mfma_f32_16x16x32_bf16 v[128:131], a[32:35], v[32:35], 0
    v_cndmask_b32 v124, v124, v126, s[34:35]
    v_permlane16_swap_b32 v13, v14
    v_add_f32 v13, v13, v248
    v_add_f32 v14, v14, v249
    v_mfma_f32_16x16x32_bf16 v[248:251], v[80:83], v[16:19], 0
    ds_read_b128 v[80:83], v15 offset:2048
    v_cndmask_b32 v124, v124, v127, s[36:37]
    v_cndmask_b32 v11, 0, v120, s[38:39]
    v_mfma_f32_16x16x32_bf16 v[248:251], v[84:87], v[20:23], v[248:251]
    ds_read_b128 v[84:87], v15 offset:3072
    v_cndmask_b32 v2, 0, v120, s[38:39]
    v_cndmask_b32 v122, 0, v124, s[38:39]
    v_mfma_f32_16x16x32_bf16 v[128:131], a[36:39], v[36:39], v[128:131]
    v_add_f32 v70, v70, v71
    v_mov_b32_dpp v11, v122 row_ror:8 row_mask:0xf bank_mask:0xc
    v_mfma_f32_16x16x32_bf16 v[128:131], a[40:43], v[40:43], v[128:131]
    v_mov_b32_dpp v2, v122 row_ror:8 row_mask:0xf bank_mask:0x3
    v_add_f32 v72, v72, v73
    v_mfma_f32_16x16x32_bf16 v[120:123], a[32:35], v[16:19], 0
    v_add_f32 v74, v74, v75
    v_add_f32 v68, v68, v70
    v_mfma_f32_16x16x32_bf16 v[120:123], a[36:39], v[20:23], v[120:123]
    v_add_f32 v72, v72, v74
    v_mul_f32 v13, s28, v13
    v_mfma_f32_16x16x32_bf16 v[120:123], a[40:43], v[24:27], v[120:123]
    v_permlane32_swap_b32 v68, v72
    v_mfma_f32_16x16x32_bf16 v[120:123], a[44:47], v[28:31], v[120:123]
    v_add_f32 v5, v68, v72
    v_mov_b32 v72, v5
    s_waitcnt lgkmcnt(1)
    v_mfma_f32_16x16x32_bf16 v[248:251], v[80:83], v[24:27], v[248:251]
    v_fma_f32 v14, -v13, s24, v14
    v_permlane16_swap_b32 v5, v72
    v_mfma_f32_16x16x32_bf16 v[96:99], v[80:83], v[40:43], v[96:99]
    v_add_f32 v5, v5, v72
    v_cvt_pk_bf16_f32 v144, v120, v121
    s_waitcnt lgkmcnt(0)
    v_mfma_f32_16x16x32_bf16 v[248:251], v[84:87], v[28:31], v[248:251]
    v_cvt_pk_bf16_f32 v145, v122, v123
    v_mul_f32 v13, v13, v13
    v_mfma_f32_16x16x32_bf16 v[96:99], v[84:87], v[44:47], v[96:99]
    v_fma_f32 v5, v5, s28, -v13
    v_mul_f32 v6, v100, v100
    v_mfma_f32_16x16x32_bf16 v[128:131], a[44:47], v[44:47], v[128:131]
    v_max_f32 v5, 0, v5
    v_fma_f32 v5, v5, v6, s29
    v_mfma_f32_16x16x32_bf16 v[124:127], a[48:51], v[16:19], 0
    v_rsq_f32 v5, v5
    v_mfma_f32_16x16x32_bf16 v[132:135], a[48:51], v[32:35], 0
    v_mul_f32 v14, s30, v14
    v_mul_f32 v14, v14, v100
    v_mfma_f32_16x16x32_bf16 v[124:127], a[52:55], v[20:23], v[124:127]
    v_cvt_pk_bf16_f32 v148, v128, v129
    v_cvt_pk_bf16_f32 v149, v130, v131
    v_mfma_f32_16x16x32_bf16 v[132:135], a[52:55], v[36:39], v[132:135]
    v_mul_f32 v5, v5, v14
    v_permlane32_swap_b32 v11, v2
    v_mfma_f32_16x16x32_bf16 v[124:127], a[56:59], v[24:27], v[124:127]
    v_max_f32_dpp v6, v5, v5 quad_perm:[1,0,3,2] row_mask:0xf bank_mask:0xf
    v_add_f32 v11, v11, v2
    v_mfma_f32_16x16x32_bf16 v[132:135], a[56:59], v[40:43], v[132:135]
    v_max_f32_dpp v6, v6, v6 quad_perm:[2,3,0,1] row_mask:0xf bank_mask:0xf
    v_mov_b32 v2, v11
    v_mfma_f32_16x16x32_bf16 v[124:127], a[60:63], v[28:31], v[124:127]
    v_max_f32_dpp v6, v6, v6 row_half_mirror row_mask:0xf bank_mask:0xf
    v_sub_f32 v5, v5, v6
    v_mfma_f32_16x16x32_bf16 v[132:135], a[60:63], v[44:47], v[132:135]
    v_exp_f32 v5, v5
    v_mfma_f32_16x16x32_bf16 v[104:107], a[64:67], v[16:19], 0
    v_permlane16_swap_b32 v11, v2
    v_mfma_f32_16x16x32_bf16 v[112:115], a[64:67], v[32:35], 0
    v_add_f32_dpp v6, v5, v5 quad_perm:[1,0,3,2] row_mask:0xf bank_mask:0xf
    v_cvt_pk_bf16_f32 v146, v124, v125
    v_mfma_f32_16x16x32_bf16 v[104:107], a[68:71], v[20:23], v[104:107]
    v_cvt_pk_bf16_f32 v147, v126, v127
    v_cvt_pk_bf16_f32 v150, v132, v133
    v_mfma_f32_16x16x32_bf16 v[112:115], a[68:71], v[36:39], v[112:115]
    v_cvt_pk_bf16_f32 v151, v134, v135
    v_mul_f32 v5, v5, v100
    v_mfma_f32_16x16x32_bf16 v[152:155], v[144:147], v[20:23], v[152:155]
    buffer_load_dword v100, v102, s[8:11], s23 offen
    v_add_f32_dpp v6, v6, v6 quad_perm:[2,3,0,1] row_mask:0xf bank_mask:0xf
    v_cndmask_b32_dpp v248, v96, v248, vcc row_ror:8 row_mask:0xf bank_mask:0xf
    v_mfma_f32_16x16x32_bf16 v[156:159], v[148:151], v[36:39], v[156:159]
    v_add_f32_dpp v6, v6, v6 row_half_mirror row_mask:0xf bank_mask:0xf
    v_rcp_f32 v6, v6
    v_mfma_f32_16x16x32_bf16 v[104:107], a[72:75], v[24:27], v[104:107]
    v_mul_f32 v5, v5, v6
    ds_write_b32 v4, v5 offset:512
    v_mfma_f32_16x16x32_bf16 v[112:115], a[72:75], v[40:43], v[112:115]
    ds_read_b128 v[64:67], v9 offset:512
    ds_read_b128 v[68:71], v9 offset:576
    v_add_f32 v11, v11, v2
    v_mfma_f32_16x16x32_bf16 v[104:107], a[76:79], v[28:31], v[104:107]
    v_mul_f32 v2, s28, v248
    s_waitcnt vmcnt(7)
    v_lshl_add_u32 v252, v252, 8, v7
    v_mfma_f32_16x16x32_bf16 v[112:115], a[76:79], v[44:47], v[112:115]
    v_lshl_add_u32 v253, v253, 8, v7
    v_mul_f32 v2, v2, v2
    v_mfma_f32_16x16x32_bf16 v[108:111], a[80:83], v[16:19], 0
    v_fma_f32 v11, v11, s28, -v2
    s_waitcnt vmcnt(6)
    v_mul_f32 v2, v101, v101
    v_mfma_f32_16x16x32_bf16 v[116:119], a[80:83], v[32:35], 0
    v_cvt_pk_bf16_f32 v136, v104, v105
    v_cvt_pk_bf16_f32 v137, v106, v107
    v_mfma_f32_16x16x32_bf16 v[108:111], a[84:87], v[20:23], v[108:111]
    v_cvt_pk_bf16_f32 v140, v112, v113
    v_cvt_pk_bf16_f32 v141, v114, v115
    v_mfma_f32_16x16x32_bf16 v[116:119], a[84:87], v[36:39], v[116:119]
    v_max_f32 v11, 0, v11
    v_fma_f32 v11, v11, v2, s29
    v_mfma_f32_16x16x32_bf16 v[108:111], a[88:91], v[24:27], v[108:111]
    s_waitcnt lgkmcnt(1)
    v_mul_f32 v48, v64, v168
    v_mfma_f32_16x16x32_bf16 v[116:119], a[88:91], v[40:43], v[116:119]
    v_fmac_f32 v48, v65, v169
    v_fmac_f32 v48, v66, v170
    v_mfma_f32_16x16x32_bf16 v[108:111], a[92:95], v[28:31], v[108:111]
    v_fmac_f32 v48, v67, v171
    v_mul_f32 v49, v64, v172
    v_mfma_f32_16x16x32_bf16 v[116:119], a[92:95], v[44:47], v[116:119]
    v_fmac_f32 v49, v65, v173
    v_fmac_f32 v49, v66, v174
    v_mfma_f32_16x16x32_bf16 v[120:123], a[96:99], v[16:19], 0
    v_fmac_f32 v49, v67, v175
    s_waitcnt lgkmcnt(0)
    v_mul_f32 v56, v68, v200
    v_mfma_f32_16x16x32_bf16 v[128:131], a[96:99], v[32:35], 0
    v_cvt_pk_bf16_f32 v138, v108, v109
    v_cvt_pk_bf16_f32 v139, v110, v111
    v_mfma_f32_16x16x32_bf16 v[120:123], a[100:103], v[20:23], v[120:123]
    v_cvt_pk_bf16_f32 v142, v116, v117
    v_cvt_pk_bf16_f32 v143, v118, v119
    v_mfma_f32_16x16x32_bf16 v[152:155], v[136:139], v[24:27], v[152:155]
    v_fmac_f32 v56, v69, v201
    v_fmac_f32 v56, v70, v202
    v_mfma_f32_16x16x32_bf16 v[156:159], v[140:143], v[40:43], v[156:159]
    v_fmac_f32 v56, v71, v203
    v_mul_f32 v57, v68, v204
    v_mfma_f32_16x16x32_bf16 v[128:131], a[100:103], v[36:39], v[128:131]
    v_fmac_f32 v57, v69, v205
    v_fmac_f32 v57, v70, v206
    v_mfma_f32_16x16x32_bf16 v[120:123], a[104:107], v[24:27], v[120:123]
    v_fmac_f32 v57, v71, v207
    v_mul_f32 v50, v64, v176
    v_mfma_f32_16x16x32_bf16 v[128:131], a[104:107], v[40:43], v[128:131]
    v_fmac_f32 v50, v65, v177
    v_fmac_f32 v50, v66, v178
    v_mfma_f32_16x16x32_bf16 v[120:123], a[108:111], v[28:31], v[120:123]
    v_fmac_f32 v50, v67, v179
    v_mul_f32 v51, v64, v180
    v_mfma_f32_16x16x32_bf16 v[128:131], a[108:111], v[44:47], v[128:131]
    v_fmac_f32 v51, v65, v181
    v_fmac_f32 v51, v66, v182
    v_mfma_f32_16x16x32_bf16 v[124:127], a[112:115], v[16:19], 0
    v_fmac_f32 v51, v67, v183
    v_mul_f32 v58, v68, v208
    v_mfma_f32_16x16x32_bf16 v[132:135], a[112:115], v[32:35], 0
    v_cvt_pk_bf16_f32 v144, v120, v121
    v_cvt_pk_bf16_f32 v145, v122, v123
    v_mfma_f32_16x16x32_bf16 v[124:127], a[116:119], v[20:23], v[124:127]
    v_cvt_pk_bf16_f32 v148, v128, v129
    v_cvt_pk_bf16_f32 v149, v130, v131
    v_mfma_f32_16x16x32_bf16 v[132:135], a[116:119], v[36:39], v[132:135]
    v_fmac_f32 v58, v69, v209
    v_fmac_f32 v58, v70, v210
    v_mfma_f32_16x16x32_bf16 v[124:127], a[120:123], v[24:27], v[124:127]
    v_fmac_f32 v58, v71, v211
    v_mul_f32 v59, v68, v212
    v_mfma_f32_16x16x32_bf16 v[132:135], a[120:123], v[40:43], v[132:135]
    v_fmac_f32 v59, v69, v213
    v_fmac_f32 v59, v70, v214
    v_mfma_f32_16x16x32_bf16 v[124:127], a[124:127], v[28:31], v[124:127]
    v_fmac_f32 v59, v71, v215
    v_mul_f32 v52, v64, v184
    v_mfma_f32_16x16x32_bf16 v[132:135], a[124:127], v[44:47], v[132:135]
    v_mul_f32 v53, v64, v188
    v_mul_f32 v54, v64, v192
    v_mfma_f32_16x16x32_bf16 v[104:107], v[16:19], a[128:131], 0
    v_mul_f32 v55, v64, v196
    v_mul_f32 v60, v68, v216
    v_mfma_f32_16x16x32_bf16 v[112:115], v[32:35], a[128:131], 0
    v_cvt_pk_bf16_f32 v146, v124, v125
    v_cvt_pk_bf16_f32 v147, v126, v127
    v_mfma_f32_16x16x32_bf16 v[104:107], v[20:23], a[132:135], v[104:107]
    v_cvt_pk_bf16_f32 v150, v132, v133
    v_cvt_pk_bf16_f32 v151, v134, v135
    v_mfma_f32_16x16x32_bf16 v[152:155], v[144:147], v[28:31], v[152:155]
    v_mul_f32 v61, v68, v220
    v_mul_f32 v62, v68, v224
    v_mfma_f32_16x16x32_bf16 v[156:159], v[148:151], v[44:47], v[156:159]
    v_mul_f32 v63, v68, v228
    v_fmac_f32 v52, v65, v185
    v_mfma_f32_16x16x32_bf16 v[112:115], v[36:39], a[132:135], v[112:115]
    v_fmac_f32 v53, v65, v189
    v_fmac_f32 v54, v65, v193
    v_mfma_f32_16x16x32_bf16 v[104:107], v[24:27], a[136:139], v[104:107]
    v_fmac_f32 v55, v65, v197
    v_fmac_f32 v60, v69, v217
    v_mfma_f32_16x16x32_bf16 v[112:115], v[40:43], a[136:139], v[112:115]
    v_fmac_f32 v61, v69, v221
    v_fmac_f32 v62, v69, v225
    v_mfma_f32_16x16x32_bf16 v[104:107], v[28:31], a[140:143], v[104:107]
    v_fmac_f32 v63, v69, v229
    v_fmac_f32 v52, v66, v186
    v_mfma_f32_16x16x32_bf16 v[112:115], v[44:47], a[140:143], v[112:115]
    v_fmac_f32 v53, v66, v190
    v_fmac_f32 v54, v66, v194
    v_mfma_f32_16x16x32_bf16 v[108:111], v[16:19], a[144:147], 0
    v_fmac_f32 v55, v66, v198
    v_fmac_f32 v60, v70, v218
    v_mfma_f32_16x16x32_bf16 v[116:119], v[32:35], a[144:147], 0
    v_fmac_f32 v61, v70, v222
    v_fmac_f32 v62, v70, v226
    v_mfma_f32_16x16x32_bf16 v[108:111], v[20:23], a[148:151], v[108:111]
    v_fmac_f32 v63, v70, v230
    v_fmac_f32 v52, v67, v187
    v_mfma_f32_16x16x32_bf16 v[116:119], v[36:39], a[148:151], v[116:119]
    v_fmac_f32 v53, v67, v191
    v_fmac_f32 v54, v67, v195
    v_mfma_f32_16x16x32_bf16 v[108:111], v[24:27], a[152:155], v[108:111]
    v_fmac_f32 v55, v67, v199
    v_fmac_f32 v60, v71, v219
    v_mfma_f32_16x16x32_bf16 v[116:119], v[40:43], a[152:155], v[116:119]
    v_fmac_f32 v61, v71, v223
    v_fmac_f32 v62, v71, v227
    v_mfma_f32_16x16x32_bf16 v[108:111], v[28:31], a[156:159], v[108:111]
    v_fmac_f32 v63, v71, v231
    v_permlane16_swap_b32 v48, v52
    v_mfma_f32_16x16x32_bf16 v[116:119], v[44:47], a[156:159], v[116:119]
    v_permlane16_swap_b32 v49, v53
    v_mfma_f32_16x16x32_bf16 v[168:171], v[16:19], v[232:235], 0
    v_permlane16_swap_b32 v50, v54
    v_mfma_f32_16x16x32_bf16 v[172:175], v[16:19], v[236:239], 0
    v_permlane16_swap_b32 v51, v55
    v_mfma_f32_16x16x32_bf16 v[200:203], v[32:35], v[232:235], 0
    v_permlane16_swap_b32 v56, v60
    v_mfma_f32_16x16x32_bf16 v[204:207], v[32:35], v[236:239], 0
    v_permlane16_swap_b32 v57, v61
    v_mfma_f32_16x16x32_bf16 v[176:179], v[20:23], v[232:235], 0
    v_permlane16_swap_b32 v58, v62
    v_mfma_f32_16x16x32_bf16 v[180:183], v[20:23], v[236:239], 0
    v_permlane16_swap_b32 v59, v63
    v_mfma_f32_16x16x32_bf16 v[208:211], v[36:39], v[232:235], 0
    v_add_f32 v48, v48, v52
    v_add_f32 v49, v49, v53
    v_mfma_f32_16x16x32_bf16 v[212:215], v[36:39], v[236:239], 0
    v_add_f32 v50, v50, v54
    v_add_f32 v51, v51, v55
    v_mfma_f32_16x16x32_bf16 v[120:123], v[16:19], a[160:163], 0
    v_add_f32 v56, v56, v60
    v_add_f32 v57, v57, v61
    v_mfma_f32_16x16x32_bf16 v[128:131], v[32:35], a[160:163], 0
    v_add_f32 v58, v58, v62
    v_add_f32 v59, v59, v63
    v_mfma_f32_16x16x32_bf16 v[120:123], v[20:23], a[164:167], v[120:123]
    v_cvt_pk_bf16_f32 v53, v48, v49
    v_cvt_pk_bf16_f32 v55, v50, v51
    v_mfma_f32_16x16x32_bf16 v[128:131], v[36:39], a[164:167], v[128:131]
    buffer_store_dword v53, v252, s[12:15], 0 offen offset:0 sc1
    v_cvt_pk_bf16_f32 v61, v56, v57
    v_cvt_pk_bf16_f32 v63, v58, v59
    v_mfma_f32_16x16x32_bf16 v[120:123], v[24:27], a[168:171], v[120:123]
    buffer_store_dword v55, v252, s[12:15], 0 offen offset:64 sc1
    buffer_store_dword v61, v253, s[12:15], 0 offen offset:0 sc1
    buffer_store_dword v63, v253, s[12:15], 0 offen offset:64 sc1
    v_mfma_f32_16x16x32_bf16 v[128:131], v[40:43], a[168:171], v[128:131]
    buffer_load_dwordx2 v[252:253], v3, s[8:11], s23 offen
    v_rsq_f32 v11, v11
    v_mfma_f32_16x16x32_bf16 v[120:123], v[28:31], a[172:175], v[120:123]
    v_mul_f32 v11, v11, v101
    ds_write_b32 v4, v11
    v_mfma_f32_16x16x32_bf16 v[128:131], v[44:47], a[172:175], v[128:131]
    ds_read_b128 v[244:247], v8
    v_cndmask_b32_dpp v152, v156, v152, vcc row_ror:8 row_mask:0xf bank_mask:0xf
    v_cndmask_b32_dpp v153, v157, v153, vcc row_ror:8 row_mask:0xf bank_mask:0xf
    v_mfma_f32_16x16x32_bf16 v[124:127], v[16:19], a[176:179], 0
    v_cndmask_b32_dpp v154, v158, v154, vcc row_ror:8 row_mask:0xf bank_mask:0xf
    v_cndmask_b32_dpp v155, v159, v155, vcc row_ror:8 row_mask:0xf bank_mask:0xf
    v_mfma_f32_16x16x32_bf16 v[132:135], v[32:35], a[176:179], 0
    v_cvt_pk_bf16_f32 v136, v104, v105
    v_cvt_pk_bf16_f32 v137, v106, v107
    v_mfma_f32_16x16x32_bf16 v[124:127], v[20:23], a[180:183], v[124:127]
    v_cvt_pk_bf16_f32 v138, v108, v109
    v_cvt_pk_bf16_f32 v139, v110, v111
    v_mfma_f32_16x16x32_bf16 v[132:135], v[36:39], a[180:183], v[132:135]
    v_cvt_pk_bf16_f32 v140, v112, v113
    v_cvt_pk_bf16_f32 v141, v114, v115
    v_mfma_f32_16x16x32_bf16 v[124:127], v[24:27], a[184:187], v[124:127]
    v_cvt_pk_bf16_f32 v142, v116, v117
    v_cvt_pk_bf16_f32 v143, v118, v119
    v_mfma_f32_16x16x32_bf16 v[132:135], v[40:43], a[184:187], v[132:135]
    v_cvt_pk_bf16_f32 v144, v120, v121
    v_cvt_pk_bf16_f32 v145, v122, v123
    v_mfma_f32_16x16x32_bf16 v[124:127], v[28:31], a[188:191], v[124:127]
    s_waitcnt lgkmcnt(0)
    v_mul_f32 v152, v152, v244
    v_mfma_f32_16x16x32_bf16 v[132:135], v[44:47], a[188:191], v[132:135]
    v_mul_f32 v153, v153, v245
    v_mul_f32 v154, v154, v246
    v_mfma_f32_16x16x32_bf16 v[184:187], v[24:27], v[232:235], 0
    v_max3_f32 v156, v152, v153, v154
    v_mul_f32 v155, v155, v247
    v_mfma_f32_16x16x32_bf16 v[188:191], v[24:27], v[236:239], 0
    v_max_f32 v156, v156, v155
    v_mov_b32 v157, v156
    v_mfma_f32_16x16x32_bf16 v[216:219], v[40:43], v[232:235], 0
    v_cvt_pk_bf16_f32 v146, v124, v125
    v_permlane16_swap_b32 v156, v157
    v_mfma_f32_16x16x32_bf16 v[220:223], v[40:43], v[236:239], 0
    v_max_f32 v156, v156, v157
    v_mul_f32 v156, v156, v11
    v_mfma_f32_16x16x32_bf16 v[192:195], v[28:31], v[232:235], 0
    v_fma_f32 v152, v152, v11, -v156
    v_fma_f32 v153, v153, v11, -v156
    v_mfma_f32_16x16x32_bf16 v[196:199], v[28:31], v[236:239], 0
    v_fma_f32 v154, v154, v11, -v156
    v_fma_f32 v155, v155, v11, -v156
    v_mfma_f32_16x16x32_bf16 v[224:227], v[44:47], v[232:235], 0
    v_exp_f32 v152, v152
    v_mfma_f32_16x16x32_bf16 v[228:231], v[44:47], v[236:239], 0
    v_exp_f32 v153, v153
    v_mfma_f32_16x16x32_bf16 v[104:107], v[16:19], a[192:195], 0
    v_exp_f32 v154, v154
    v_mfma_f32_16x16x32_bf16 v[112:115], v[32:35], a[192:195], 0
    v_exp_f32 v155, v155
    v_add_f32 v156, v152, v153
    v_add_f32 v157, v154, v155
    v_mfma_f32_16x16x32_bf16 v[104:107], v[20:23], a[196:199], v[104:107]
    v_add_f32 v156, v156, v157
    v_mov_b32 v157, v156
    v_mfma_f32_16x16x32_bf16 v[112:115], v[36:39], a[196:199], v[112:115]
    v_mul_f32 v152, v152, v244
    v_permlane16_swap_b32 v156, v157
    v_add_f32 v156, v156, v157
    v_mul_f32 v156, v156, v101
    v_rcp_f32 v156, v156
    v_mul_f32 v153, v153, v245
    v_mul_f32 v154, v154, v246
    v_mul_f32 v155, v155, v247
    v_mul_f32 v152, v152, v156
    v_mul_f32 v153, v153, v156
    v_mul_f32 v154, v154, v156
    v_mul_f32 v155, v155, v156
    v_mfma_f32_16x16x32_bf16 v[104:107], v[24:27], a[200:203], v[104:107]
    v_cvt_pk_bf16_f32 v158, v152, v153
    v_cvt_pk_bf16_f32 v159, v154, v155
    v_and_b32 v240, v158, v10
    v_and_b32 v241, v159, v10
    v_mfma_f32_16x16x32_bf16 v[112:115], v[40:43], a[200:203], v[112:115]
    v_and_b32_dpp v242, v158, v10 row_ror:8 row_mask:0xf bank_mask:0xf
    v_and_b32_dpp v243, v159, v10 row_ror:8 row_mask:0xf bank_mask:0xf
    v_mfma_f32_16x16x16_bf16 v[168:171], v[240:241], v[136:137], v[168:171]
    v_cvt_pk_bf16_f32 v147, v126, v127
    v_cvt_pk_bf16_f32 v148, v128, v129
    v_mfma_f32_16x16x16_bf16 v[172:175], v[240:241], v[138:139], v[172:175]
    v_cvt_pk_bf16_f32 v149, v130, v131
    v_cvt_pk_bf16_f32 v150, v132, v133
    v_mfma_f32_16x16x16_bf16 v[200:203], v[242:243], v[140:141], v[200:203]
    v_cvt_pk_bf16_f32 v151, v134, v135
    v_mfma_f32_16x16x16_bf16 v[204:207], v[242:243], v[142:143], v[204:207]
    v_mfma_f32_16x16x32_bf16 v[104:107], v[28:31], a[204:207], v[104:107]
    v_cndmask_b32_dpp v250, v98, v250, vcc row_ror:8 row_mask:0xf bank_mask:0xf
    v_cndmask_b32_dpp v251, v99, v251, vcc row_ror:8 row_mask:0xf bank_mask:0xf
    v_mfma_f32_16x16x32_bf16 v[112:115], v[44:47], a[204:207], v[112:115]
    ds_write_b32 v4, v250 offset:128
    ds_write_b32 v4, v251 offset:256
    ds_read_b128 v[160:163], v8 offset:128
    v_mfma_f32_16x16x32_bf16 v[108:111], v[16:19], a[208:211], 0
    ds_read_b128 v[164:167], v8 offset:256
    v_cvt_pk_bf16_f32 v136, v104, v105
    v_cvt_pk_bf16_f32 v137, v106, v107
    v_mfma_f32_16x16x32_bf16 v[116:119], v[32:35], a[208:211], 0
    v_cvt_pk_bf16_f32 v140, v112, v113
    v_cvt_pk_bf16_f32 v141, v114, v115
    v_mfma_f32_16x16x32_bf16 v[108:111], v[20:23], a[212:215], v[108:111]
    v_cndmask_b32_dpp v249, v97, v249, vcc row_ror:8 row_mask:0xf bank_mask:0xf
    v_mul_f32 v48, v168, v168
    v_mfma_f32_16x16x32_bf16 v[116:119], v[36:39], a[212:215], v[116:119]
    v_mul_f32 v49, v169, v169
    v_mul_f32 v50, v170, v170
    v_mfma_f32_16x16x32_bf16 v[108:111], v[24:27], a[216:219], v[108:111]
    v_mul_f32 v51, v171, v171
    v_mul_f32 v52, v200, v200
    v_mfma_f32_16x16x32_bf16 v[116:119], v[40:43], a[216:219], v[116:119]
    v_mul_f32 v53, v201, v201
    v_mul_f32 v54, v202, v202
    v_mfma_f32_16x16x32_bf16 v[108:111], v[28:31], a[220:223], v[108:111]
    v_mul_f32 v55, v203, v203
    s_waitcnt lgkmcnt(1)
    v_mul_f32 v13, v152, v160
    v_mfma_f32_16x16x32_bf16 v[116:119], v[44:47], a[220:223], v[116:119]
    s_waitcnt lgkmcnt(0)
    v_mul_f32 v14, v152, v164
    v_mfma_f32_16x16x16_bf16 v[176:179], v[240:241], v[144:145], v[176:179]
    v_fmac_f32 v13, v153, v161
    v_fmac_f32 v14, v153, v165
    v_mfma_f32_16x16x16_bf16 v[180:183], v[240:241], v[146:147], v[180:183]
    v_cvt_pk_bf16_f32 v138, v108, v109
    v_cvt_pk_bf16_f32 v139, v110, v111
    v_mfma_f32_16x16x16_bf16 v[208:211], v[242:243], v[148:149], v[208:211]
    v_cvt_pk_bf16_f32 v142, v116, v117
    v_cvt_pk_bf16_f32 v143, v118, v119
    v_mfma_f32_16x16x16_bf16 v[212:215], v[242:243], v[150:151], v[212:215]
    v_fmac_f32 v13, v154, v162
    v_fmac_f32 v14, v154, v166
    v_mfma_f32_16x16x32_bf16 v[120:123], v[16:19], a[224:227], 0
    v_fmac_f32 v13, v155, v163
    v_fmac_f32 v14, v155, v167
    v_mfma_f32_16x16x32_bf16 v[128:131], v[32:35], a[224:227], 0
    v_fmac_f32 v48, v172, v172
    v_permlane16_swap_b32 v13, v14
    v_mfma_f32_16x16x32_bf16 v[120:123], v[20:23], a[228:231], v[120:123]
    v_add_f32 v13, v13, v14
    v_mov_b32 v14, v13
    v_mfma_f32_16x16x32_bf16 v[128:131], v[36:39], a[228:231], v[128:131]
    v_fmac_f32 v49, v173, v173
    v_permlane16_swap_b32 v13, v14
    v_mfma_f32_16x16x32_bf16 v[120:123], v[24:27], a[232:235], v[120:123]
    v_add_f32 v13, v13, v248
    v_add_f32 v14, v14, v249
    v_mfma_f32_16x16x32_bf16 v[128:131], v[40:43], a[232:235], v[128:131]
    v_fmac_f32 v50, v174, v174
    v_fmac_f32 v51, v175, v175
    v_mfma_f32_16x16x32_bf16 v[120:123], v[28:31], a[236:239], v[120:123]
    v_fmac_f32 v52, v204, v204
    v_fmac_f32 v53, v205, v205
    v_mfma_f32_16x16x32_bf16 v[128:131], v[44:47], a[236:239], v[128:131]
    v_fmac_f32 v54, v206, v206
    v_fmac_f32 v55, v207, v207
    v_mfma_f32_16x16x32_bf16 v[124:127], v[16:19], a[240:243], 0
    s_nop 1
    v_cvt_pk_bf16_f32 v144, v120, v121
    v_mfma_f32_16x16x32_bf16 v[132:135], v[32:35], a[240:243], 0
    v_cvt_pk_bf16_f32 v145, v122, v123
    v_cvt_pk_bf16_f32 v148, v128, v129
    v_mfma_f32_16x16x32_bf16 v[124:127], v[20:23], a[244:247], v[124:127]
    v_cvt_pk_bf16_f32 v149, v130, v131
    v_mfma_f32_16x16x32_bf16 v[132:135], v[36:39], a[244:247], v[132:135]
    v_fmac_f32 v48, v176, v176
    v_fmac_f32 v49, v177, v177
    v_mfma_f32_16x16x32_bf16 v[124:127], v[24:27], a[248:251], v[124:127]
    v_fmac_f32 v50, v178, v178
    v_mfma_f32_16x16x32_bf16 v[132:135], v[40:43], a[248:251], v[132:135]
    v_fmac_f32 v51, v179, v179
    v_fmac_f32 v52, v208, v208
    v_mfma_f32_16x16x32_bf16 v[124:127], v[28:31], a[252:255], v[124:127]
    v_fmac_f32 v53, v209, v209
    v_mfma_f32_16x16x32_bf16 v[132:135], v[44:47], a[252:255], v[132:135]
    v_fmac_f32 v54, v210, v210
    v_fmac_f32 v55, v211, v211
    v_mfma_f32_16x16x16_bf16 v[184:187], v[240:241], v[136:137], v[184:187]
    v_fmac_f32 v48, v180, v180
    s_nop 1
    v_cvt_pk_bf16_f32 v146, v124, v125
    v_mfma_f32_16x16x16_bf16 v[188:191], v[240:241], v[138:139], v[188:191]
    v_cvt_pk_bf16_f32 v147, v126, v127
    v_fmac_f32 v49, v181, v181
    v_mfma_f32_16x16x16_bf16 v[216:219], v[242:243], v[140:141], v[216:219]
    v_cvt_pk_bf16_f32 v150, v132, v133
    v_cvt_pk_bf16_f32 v151, v134, v135
    v_mfma_f32_16x16x16_bf16 v[220:223], v[242:243], v[142:143], v[220:223]
    v_fmac_f32 v50, v182, v182
    v_fmac_f32 v51, v183, v183
    v_mfma_f32_16x16x16_bf16 v[192:195], v[240:241], v[144:145], v[192:195]
    v_fmac_f32 v52, v212, v212
    v_fmac_f32 v53, v213, v213
    v_mfma_f32_16x16x16_bf16 v[196:199], v[240:241], v[146:147], v[196:199]
    v_fmac_f32 v54, v214, v214
    v_fmac_f32 v55, v215, v215
    v_mfma_f32_16x16x16_bf16 v[224:227], v[242:243], v[148:149], v[224:227]
    v_fmac_f32 v48, v184, v184
    v_fmac_f32 v49, v185, v185
    v_mfma_f32_16x16x16_bf16 v[228:231], v[242:243], v[150:151], v[228:231]
    v_fmac_f32 v50, v186, v186
    v_fmac_f32 v51, v187, v187
    v_fmac_f32 v52, v216, v216
    v_fmac_f32 v53, v217, v217
    v_fmac_f32 v54, v218, v218
    v_fmac_f32 v55, v219, v219
    v_fmac_f32 v48, v188, v188
    v_fmac_f32 v49, v189, v189
    v_fmac_f32 v50, v190, v190
    v_fmac_f32 v51, v191, v191
    v_fmac_f32 v52, v220, v220
    v_fmac_f32 v53, v221, v221
    v_fmac_f32 v54, v222, v222
    v_fmac_f32 v55, v223, v223
    v_fmac_f32 v48, v192, v192
    v_fmac_f32 v49, v193, v193
    v_fmac_f32 v50, v194, v194
    v_fmac_f32 v51, v195, v195
    v_fmac_f32 v52, v224, v224
    v_fmac_f32 v53, v225, v225
    v_fmac_f32 v54, v226, v226
    v_fmac_f32 v55, v227, v227
    v_fmac_f32 v48, v196, v196
    v_fmac_f32 v49, v197, v197
    v_fmac_f32 v50, v198, v198
    v_fmac_f32 v51, v199, v199
    v_fmac_f32 v52, v228, v228
    v_fmac_f32 v53, v229, v229
    v_fmac_f32 v54, v230, v230
    v_fmac_f32 v55, v231, v231
    v_cvt_pk_bf16_f32 v64, v48, v49
    v_cvt_pk_bf16_f32 v65, v50, v51
    v_cvt_pk_bf16_f32 v66, v52, v53
    v_cvt_pk_bf16_f32 v67, v54, v55
    s_nop 1
    v_mfma_f32_16x16x32_bf16 v[68:71], v[64:67], v[88:91], 0
    v_mfma_f32_16x16x32_bf16 v[72:75], v[64:67], v[92:95], 0
    s_nop 6
    v_add_f32 v68, v68, v69
    v_add_f32 v70, v70, v71
    v_add_f32 v72, v72, v73
    v_add_f32 v74, v74, v75
    v_add_f32 v68, v68, v70
    v_add_f32 v72, v72, v74
    v_mul_f32 v13, s28, v13
    s_nop 0
    v_permlane32_swap_b32 v68, v72
    v_add_f32 v5, v68, v72
    v_mov_b32 v72, v5
    v_fma_f32 v14, -v13, s24, v14
    s_nop 0
    v_permlane16_swap_b32 v5, v72
    v_add_f32 v5, v5, v72
    v_mul_f32 v13, v13, v13
    v_fma_f32 v5, v5, s28, -v13
    v_mul_f32 v6, v101, v101
    v_max_f32 v5, 0, v5
    v_fma_f32 v5, v5, v6, s29
    v_rsq_f32 v5, v5
    v_mul_f32 v14, s30, v14
    v_mul_f32 v14, v14, v101
    v_mul_f32 v5, v5, v14
    s_nop 1
    v_max_f32_dpp v6, v5, v5 quad_perm:[1,0,3,2] row_mask:0xf bank_mask:0xf
    s_nop 1
    v_max_f32_dpp v6, v6, v6 quad_perm:[2,3,0,1] row_mask:0xf bank_mask:0xf
    s_nop 1
    v_max_f32_dpp v6, v6, v6 row_half_mirror row_mask:0xf bank_mask:0xf
    v_sub_f32 v5, v5, v6
    v_exp_f32 v5, v5
    s_nop 1
    v_add_f32_dpp v6, v5, v5 quad_perm:[1,0,3,2] row_mask:0xf bank_mask:0xf
    v_mul_f32 v5, v5, v101
    s_nop 0
    v_add_f32_dpp v6, v6, v6 quad_perm:[2,3,0,1] row_mask:0xf bank_mask:0xf
    s_nop 1
    v_add_f32_dpp v6, v6, v6 row_half_mirror row_mask:0xf bank_mask:0xf
    v_rcp_f32 v6, v6
    s_nop 0
    v_mul_f32 v5, v5, v6
    ds_write_b32 v4, v5 offset:512
    ds_read_b128 v[64:67], v9 offset:512
    ds_read_b128 v[68:71], v9 offset:576
    s_waitcnt lgkmcnt(1)
    v_mul_f32 v48, v64, v168
    v_fmac_f32 v48, v65, v169
    v_fmac_f32 v48, v66, v170
    v_fmac_f32 v48, v67, v171
    v_mul_f32 v49, v64, v172
    v_fmac_f32 v49, v65, v173
    v_fmac_f32 v49, v66, v174
    v_fmac_f32 v49, v67, v175
    v_mul_f32 v50, v64, v176
    v_fmac_f32 v50, v65, v177
    v_fmac_f32 v50, v66, v178
    v_fmac_f32 v50, v67, v179
    v_mul_f32 v51, v64, v180
    v_fmac_f32 v51, v65, v181
    v_fmac_f32 v51, v66, v182
    v_fmac_f32 v51, v67, v183
    v_mul_f32 v52, v64, v184
    v_fmac_f32 v52, v65, v185
    v_fmac_f32 v52, v66, v186
    v_fmac_f32 v52, v67, v187
    v_mul_f32 v53, v64, v188
    v_fmac_f32 v53, v65, v189
    v_fmac_f32 v53, v66, v190
    v_fmac_f32 v53, v67, v191
    v_mul_f32 v54, v64, v192
    v_fmac_f32 v54, v65, v193
    v_fmac_f32 v54, v66, v194
    v_fmac_f32 v54, v67, v195
    v_mul_f32 v55, v64, v196
    v_fmac_f32 v55, v65, v197
    v_fmac_f32 v55, v66, v198
    v_fmac_f32 v55, v67, v199
    v_permlane16_swap_b32 v48, v52
    v_permlane16_swap_b32 v49, v53
    v_permlane16_swap_b32 v50, v54
    v_permlane16_swap_b32 v51, v55
    v_add_f32 v48, v48, v52
    v_add_f32 v49, v49, v53
    v_add_f32 v50, v50, v54
    v_add_f32 v51, v51, v55
    v_cvt_pk_bf16_f32 v53, v48, v49
    v_cvt_pk_bf16_f32 v55, v50, v51
    s_waitcnt lgkmcnt(0)
    v_mul_f32 v56, v68, v200
    v_mul_f32 v60, v68, v216
    v_mul_f32 v57, v68, v204
    v_mul_f32 v61, v68, v220
    v_mul_f32 v58, v68, v208
    v_mul_f32 v62, v68, v224
    v_mul_f32 v59, v68, v212
    v_mul_f32 v63, v68, v228
    v_fmac_f32 v56, v69, v201
    v_fmac_f32 v60, v69, v217
    v_fmac_f32 v57, v69, v205
    v_fmac_f32 v61, v69, v221
    v_fmac_f32 v58, v69, v209
    v_fmac_f32 v62, v69, v225
    v_fmac_f32 v59, v69, v213
    v_fmac_f32 v63, v69, v229
    v_fmac_f32 v56, v70, v202
    v_fmac_f32 v60, v70, v218
    v_fmac_f32 v57, v70, v206
    v_fmac_f32 v61, v70, v222
    v_fmac_f32 v58, v70, v210
    v_fmac_f32 v62, v70, v226
    v_fmac_f32 v59, v70, v214
    v_fmac_f32 v63, v70, v230
    v_fmac_f32 v56, v71, v203
    v_fmac_f32 v60, v71, v219
    v_fmac_f32 v57, v71, v207
    v_fmac_f32 v61, v71, v223
    v_fmac_f32 v58, v71, v211
    v_fmac_f32 v62, v71, v227
    v_fmac_f32 v59, v71, v215
    v_fmac_f32 v63, v71, v231
    s_waitcnt vmcnt(6)
    v_lshl_add_u32 v254, v254, 8, v7
    buffer_store_dword v53, v254, s[12:15], 0 offen offset:0 sc1
    buffer_store_dword v55, v254, s[12:15], 0 offen offset:64 sc1
    v_permlane16_swap_b32 v56, v60
    v_permlane16_swap_b32 v57, v61
    v_permlane16_swap_b32 v58, v62
    v_permlane16_swap_b32 v59, v63
    v_add_f32 v56, v56, v60
    v_add_f32 v57, v57, v61
    v_add_f32 v58, v58, v62
    v_add_f32 v59, v59, v63
    v_lshl_add_u32 v255, v255, 8, v7
    v_cvt_pk_bf16_f32 v61, v56, v57
    v_cvt_pk_bf16_f32 v63, v58, v59
    buffer_store_dword v61, v255, s[12:15], 0 offen offset:0 sc1
    buffer_store_dword v63, v255, s[12:15], 0 offen offset:64 sc1
    s_branch K4_fin
K4_x:
    v_fmac_f32 v52, v208, v208
    v_mfma_f32_16x16x32_bf16 v[104:107], a[0:3], v[16:19], 0
    v_fmac_f32 v53, v209, v209
    v_fmac_f32 v54, v210, v210
    v_mfma_f32_16x16x32_bf16 v[112:115], a[0:3], v[32:35], 0
    v_fmac_f32 v55, v211, v211
    v_fmac_f32 v48, v180, v180
    v_mfma_f32_16x16x32_bf16 v[104:107], a[4:7], v[20:23], v[104:107]
    v_fmac_f32 v49, v181, v181
    v_fmac_f32 v50, v182, v182
    v_mfma_f32_16x16x32_bf16 v[112:115], a[4:7], v[36:39], v[112:115]
    v_fmac_f32 v51, v183, v183
    v_fmac_f32 v52, v212, v212
    v_mfma_f32_16x16x32_bf16 v[104:107], a[8:11], v[24:27], v[104:107]
    v_fmac_f32 v53, v213, v213
    v_fmac_f32 v54, v214, v214
    v_mfma_f32_16x16x32_bf16 v[112:115], a[8:11], v[40:43], v[112:115]
    v_fmac_f32 v55, v215, v215
    v_fmac_f32 v48, v184, v184
    v_mfma_f32_16x16x32_bf16 v[104:107], a[12:15], v[28:31], v[104:107]
    v_fmac_f32 v49, v185, v185
    v_fmac_f32 v50, v186, v186
    v_mfma_f32_16x16x32_bf16 v[112:115], a[12:15], v[44:47], v[112:115]
    v_fmac_f32 v51, v187, v187
    v_fmac_f32 v52, v216, v216
    v_mfma_f32_16x16x32_bf16 v[108:111], a[16:19], v[16:19], 0
    v_fmac_f32 v53, v217, v217
    v_fmac_f32 v54, v218, v218
    v_mfma_f32_16x16x32_bf16 v[116:119], a[16:19], v[32:35], 0
    v_fmac_f32 v55, v219, v219
    v_fmac_f32 v48, v188, v188
    v_mfma_f32_16x16x32_bf16 v[108:111], a[20:23], v[20:23], v[108:111]
    v_fmac_f32 v49, v189, v189
    v_fmac_f32 v50, v190, v190
    v_mfma_f32_16x16x32_bf16 v[116:119], a[20:23], v[36:39], v[116:119]
    v_fmac_f32 v51, v191, v191
    v_fmac_f32 v52, v220, v220
    v_mfma_f32_16x16x32_bf16 v[108:111], a[24:27], v[24:27], v[108:111]
    v_fmac_f32 v53, v221, v221
    v_fmac_f32 v54, v222, v222
    v_mfma_f32_16x16x32_bf16 v[116:119], a[24:27], v[40:43], v[116:119]
    v_fmac_f32 v55, v223, v223
    v_fmac_f32 v48, v192, v192
    v_mfma_f32_16x16x32_bf16 v[108:111], a[28:31], v[28:31], v[108:111]
    v_fmac_f32 v49, v193, v193
    v_fmac_f32 v50, v194, v194
    v_mfma_f32_16x16x32_bf16 v[116:119], a[28:31], v[44:47], v[116:119]
    v_fmac_f32 v51, v195, v195
    v_fmac_f32 v52, v224, v224
    v_mfma_f32_16x16x32_bf16 v[120:123], v[16:19], v[16:19], 0
    v_fmac_f32 v53, v225, v225
    v_fmac_f32 v54, v226, v226
    v_mfma_f32_16x16x32_bf16 v[124:127], v[32:35], v[32:35], 0
    v_fmac_f32 v55, v227, v227
    v_fmac_f32 v48, v196, v196
    v_mfma_f32_16x16x32_bf16 v[120:123], v[20:23], v[20:23], v[120:123]
    v_fmac_f32 v49, v197, v197
    v_fmac_f32 v50, v198, v198
    v_mfma_f32_16x16x32_bf16 v[124:127], v[36:39], v[36:39], v[124:127]
    v_fmac_f32 v51, v199, v199
    v_fmac_f32 v52, v228, v228
    v_fmac_f32 v53, v229, v229
    v_fmac_f32 v54, v230, v230
    v_fmac_f32 v55, v231, v231
    v_cvt_pk_bf16_f32 v64, v48, v49
    v_cvt_pk_bf16_f32 v65, v50, v51
    v_cvt_pk_bf16_f32 v66, v52, v53
    v_cvt_pk_bf16_f32 v67, v54, v55
    v_mfma_f32_16x16x32_bf16 v[120:123], v[24:27], v[24:27], v[120:123]
    v_cndmask_b32_dpp v250, v98, v250, vcc row_ror:8 row_mask:0xf bank_mask:0xf
    v_cndmask_b32_dpp v251, v99, v251, vcc row_ror:8 row_mask:0xf bank_mask:0xf
    v_mfma_f32_16x16x32_bf16 v[68:71], v[64:67], v[88:91], 0
    ds_write_b32 v4, v250 offset:128
    ds_write_b32 v4, v251 offset:256
    ds_read_b128 v[160:163], v8 offset:128
    v_mfma_f32_16x16x32_bf16 v[72:75], v[64:67], v[92:95], 0
    ds_read_b128 v[164:167], v8 offset:256
    v_cndmask_b32_dpp v249, v97, v249, vcc row_ror:8 row_mask:0xf bank_mask:0xf
    v_cvt_pk_bf16_f32 v136, v104, v105
    v_mfma_f32_16x16x32_bf16 v[124:127], v[40:43], v[40:43], v[124:127]
    v_cvt_pk_bf16_f32 v137, v106, v107
    v_cvt_pk_bf16_f32 v138, v108, v109
    v_mfma_f32_16x16x32_bf16 v[120:123], v[28:31], v[28:31], v[120:123]
    v_cvt_pk_bf16_f32 v139, v110, v111
    v_cvt_pk_bf16_f32 v140, v112, v113
    v_mfma_f32_16x16x32_bf16 v[96:99], v[80:83], v[32:35], 0
    v_cvt_pk_bf16_f32 v141, v114, v115
    v_cvt_pk_bf16_f32 v142, v116, v117
    v_mfma_f32_16x16x32_bf16 v[124:127], v[44:47], v[44:47], v[124:127]
    v_cvt_pk_bf16_f32 v143, v118, v119
    v_add_f32 v68, v68, v69
    v_mfma_f32_16x16x32_bf16 v[96:99], v[84:87], v[36:39], v[96:99]
    v_cndmask_b32 v120, v120, v121, s[32:33]
    v_cndmask_b32 v120, v120, v122, s[34:35]
    v_mfma_f32_16x16x32_bf16 v[156:159], v[140:143], v[32:35], 0
    v_cndmask_b32 v120, v120, v123, s[36:37]
    s_waitcnt lgkmcnt(1)
    v_mul_f32 v13, v152, v160
    s_waitcnt lgkmcnt(0)
    v_mul_f32 v14, v152, v164
    v_fmac_f32 v13, v153, v161
    v_fmac_f32 v14, v153, v165
    v_fmac_f32 v13, v154, v162
    v_fmac_f32 v14, v154, v166
    v_fmac_f32 v13, v155, v163
    v_fmac_f32 v14, v155, v167
    v_mfma_f32_16x16x32_bf16 v[152:155], v[136:139], v[16:19], 0
    v_cndmask_b32 v124, v124, v125, s[32:33]
    v_permlane16_swap_b32 v13, v14
    v_add_f32 v13, v13, v14
    v_mov_b32 v14, v13
    v_mfma_f32_16x16x32_bf16 v[128:131], a[32:35], v[32:35], 0
    v_cndmask_b32 v124, v124, v126, s[34:35]
    v_permlane16_swap_b32 v13, v14
    v_add_f32 v13, v13, v248
    v_add_f32 v14, v14, v249
    v_mfma_f32_16x16x32_bf16 v[248:251], v[80:83], v[16:19], 0
    ds_read_b128 v[80:83], v15 offset:2048
    v_cndmask_b32 v124, v124, v127, s[36:37]
    v_cndmask_b32 v11, 0, v120, s[38:39]
    v_mfma_f32_16x16x32_bf16 v[248:251], v[84:87], v[20:23], v[248:251]
    ds_read_b128 v[84:87], v15 offset:3072
    v_cndmask_b32 v2, 0, v120, s[38:39]
    v_cndmask_b32 v122, 0, v124, s[38:39]
    v_mfma_f32_16x16x32_bf16 v[128:131], a[36:39], v[36:39], v[128:131]
    v_add_f32 v70, v70, v71
    v_mov_b32_dpp v11, v122 row_ror:8 row_mask:0xf bank_mask:0xc
    v_mfma_f32_16x16x32_bf16 v[128:131], a[40:43], v[40:43], v[128:131]
    v_mov_b32_dpp v2, v122 row_ror:8 row_mask:0xf bank_mask:0x3
    v_add_f32 v72, v72, v73
    v_mfma_f32_16x16x32_bf16 v[120:123], a[32:35], v[16:19], 0
    v_add_f32 v74, v74, v75
    v_add_f32 v68, v68, v70
    v_mfma_f32_16x16x32_bf16 v[120:123], a[36:39], v[20:23], v[120:123]
    v_add_f32 v72, v72, v74
    v_mul_f32 v13, s28, v13
    v_mfma_f32_16x16x32_bf16 v[120:123], a[40:43], v[24:27], v[120:123]
    v_permlane32_swap_b32 v68, v72
    v_mfma_f32_16x16x32_bf16 v[120:123], a[44:47], v[28:31], v[120:123]
    v_add_f32 v5, v68, v72
    v_mov_b32 v72, v5
    s_waitcnt lgkmcnt(1)
    v_mfma_f32_16x16x32_bf16 v[248:251], v[80:83], v[24:27], v[248:251]
    v_fma_f32 v14, -v13, s24, v14
    v_permlane16_swap_b32 v5, v72
    v_mfma_f32_16x16x32_bf16 v[96:99], v[80:83], v[40:43], v[96:99]
    ds_read_b128 v[80:83], v15 offset:0
    v_add_f32 v5, v5, v72
    v_cvt_pk_bf16_f32 v144, v120, v121
    s_waitcnt lgkmcnt(1)
    v_mfma_f32_16x16x32_bf16 v[248:251], v[84:87], v[28:31], v[248:251]
    v_cvt_pk_bf16_f32 v145, v122, v123
    v_mul_f32 v13, v13, v13
    v_mfma_f32_16x16x32_bf16 v[96:99], v[84:87], v[44:47], v[96:99]
    ds_read_b128 v[84:87], v15 offset:1024
    v_fma_f32 v5, v5, s28, -v13
    v_mul_f32 v6, v100, v100
    v_mfma_f32_16x16x32_bf16 v[128:131], a[44:47], v[44:47], v[128:131]
    v_max_f32 v5, 0, v5
    v_fma_f32 v5, v5, v6, s29
    v_mfma_f32_16x16x32_bf16 v[124:127], a[48:51], v[16:19], 0
    v_rsq_f32 v5, v5
    v_mfma_f32_16x16x32_bf16 v[132:135], a[48:51], v[32:35], 0
    v_mul_f32 v14, s30, v14
    v_mul_f32 v14, v14, v100
    v_mfma_f32_16x16x32_bf16 v[124:127], a[52:55], v[20:23], v[124:127]
    v_cvt_pk_bf16_f32 v148, v128, v129
    v_cvt_pk_bf16_f32 v149, v130, v131
    v_mfma_f32_16x16x32_bf16 v[132:135], a[52:55], v[36:39], v[132:135]
    v_mul_f32 v5, v5, v14
    v_permlane32_swap_b32 v11, v2
    v_mfma_f32_16x16x32_bf16 v[124:127], a[56:59], v[24:27], v[124:127]
    v_max_f32_dpp v6, v5, v5 quad_perm:[1,0,3,2] row_mask:0xf bank_mask:0xf
    v_add_f32 v11, v11, v2
    v_mfma_f32_16x16x32_bf16 v[132:135], a[56:59], v[40:43], v[132:135]
    v_max_f32_dpp v6, v6, v6 quad_perm:[2,3,0,1] row_mask:0xf bank_mask:0xf
    v_mov_b32 v2, v11
    v_mfma_f32_16x16x32_bf16 v[124:127], a[60:63], v[28:31], v[124:127]
    v_max_f32_dpp v6, v6, v6 row_half_mirror row_mask:0xf bank_mask:0xf
    v_sub_f32 v5, v5, v6
    v_mfma_f32_16x16x32_bf16 v[132:135], a[60:63], v[44:47], v[132:135]
    v_exp_f32 v5, v5
    v_mfma_f32_16x16x32_bf16 v[104:107], a[64:67], v[16:19], 0
    v_permlane16_swap_b32 v11, v2
    v_mfma_f32_16x16x32_bf16 v[112:115], a[64:67], v[32:35], 0
    v_add_f32_dpp v6, v5, v5 quad_perm:[1,0,3,2] row_mask:0xf bank_mask:0xf
    v_cvt_pk_bf16_f32 v146, v124, v125
    v_mfma_f32_16x16x32_bf16 v[104:107], a[68:71], v[20:23], v[104:107]
    v_cvt_pk_bf16_f32 v147, v126, v127
    v_cvt_pk_bf16_f32 v150, v132, v133
    v_mfma_f32_16x16x32_bf16 v[112:115], a[68:71], v[36:39], v[112:115]
    v_cvt_pk_bf16_f32 v151, v134, v135
    v_mul_f32 v5, v5, v100
    v_mfma_f32_16x16x32_bf16 v[152:155], v[144:147], v[20:23], v[152:155]
    buffer_load_dword v100, v102, s[8:11], s23 offen
    v_add_f32_dpp v6, v6, v6 quad_perm:[2,3,0,1] row_mask:0xf bank_mask:0xf
    v_cndmask_b32_dpp v248, v96, v248, vcc row_ror:8 row_mask:0xf bank_mask:0xf
    v_mfma_f32_16x16x32_bf16 v[156:159], v[148:151], v[36:39], v[156:159]
    v_add_f32_dpp v6, v6, v6 row_half_mirror row_mask:0xf bank_mask:0xf
    v_rcp_f32 v6, v6
    v_mfma_f32_16x16x32_bf16 v[104:107], a[72:75], v[24:27], v[104:107]
    v_mul_f32 v5, v5, v6
    ds_write_b32 v4, v5 offset:512
    v_mfma_f32_16x16x32_bf16 v[112:115], a[72:75], v[40:43], v[112:115]
    ds_read_b128 v[64:67], v9 offset:512
    ds_read_b128 v[68:71], v9 offset:576
    v_add_f32 v11, v11, v2
    v_mfma_f32_16x16x32_bf16 v[104:107], a[76:79], v[28:31], v[104:107]
    v_mul_f32 v2, s28, v248
    s_waitcnt vmcnt(7)
    v_lshl_add_u32 v252, v252, 8, v7
    v_mfma_f32_16x16x32_bf16 v[112:115], a[76:79], v[44:47], v[112:115]
    v_lshl_add_u32 v253, v253, 8, v7
    v_mul_f32 v2, v2, v2
    v_mfma_f32_16x16x32_bf16 v[108:111], a[80:83], v[16:19], 0
    v_fma_f32 v11, v11, s28, -v2
    s_waitcnt vmcnt(6)
    v_mul_f32 v2, v101, v101
    v_mfma_f32_16x16x32_bf16 v[116:119], a[80:83], v[32:35], 0
    v_cvt_pk_bf16_f32 v136, v104, v105
    v_cvt_pk_bf16_f32 v137, v106, v107
    v_mfma_f32_16x16x32_bf16 v[108:111], a[84:87], v[20:23], v[108:111]
    v_cvt_pk_bf16_f32 v140, v112, v113
    v_cvt_pk_bf16_f32 v141, v114, v115
    v_mfma_f32_16x16x32_bf16 v[116:119], a[84:87], v[36:39], v[116:119]
    v_max_f32 v11, 0, v11
    v_fma_f32 v11, v11, v2, s29
    v_mfma_f32_16x16x32_bf16 v[108:111], a[88:91], v[24:27], v[108:111]
    s_waitcnt lgkmcnt(1)
    v_mul_f32 v48, v64, v168
    v_mfma_f32_16x16x32_bf16 v[116:119], a[88:91], v[40:43], v[116:119]
    v_fmac_f32 v48, v65, v169
    v_fmac_f32 v48, v66, v170
    v_mfma_f32_16x16x32_bf16 v[108:111], a[92:95], v[28:31], v[108:111]
    v_fmac_f32 v48, v67, v171
    v_mul_f32 v49, v64, v172
    v_mfma_f32_16x16x32_bf16 v[116:119], a[92:95], v[44:47], v[116:119]
    v_fmac_f32 v49, v65, v173
    v_fmac_f32 v49, v66, v174
    v_mfma_f32_16x16x32_bf16 v[120:123], a[96:99], v[16:19], 0
    v_fmac_f32 v49, v67, v175
    s_waitcnt lgkmcnt(0)
    v_mul_f32 v56, v68, v200
    v_mfma_f32_16x16x32_bf16 v[128:131], a[96:99], v[32:35], 0
    v_cvt_pk_bf16_f32 v138, v108, v109
    v_cvt_pk_bf16_f32 v139, v110, v111
    v_mfma_f32_16x16x32_bf16 v[120:123], a[100:103], v[20:23], v[120:123]
    v_cvt_pk_bf16_f32 v142, v116, v117
    v_cvt_pk_bf16_f32 v143, v118, v119
    v_mfma_f32_16x16x32_bf16 v[152:155], v[136:139], v[24:27], v[152:155]
    v_fmac_f32 v56, v69, v201
    v_fmac_f32 v56, v70, v202
    v_mfma_f32_16x16x32_bf16 v[156:159], v[140:143], v[40:43], v[156:159]
    v_fmac_f32 v56, v71, v203
    v_mul_f32 v57, v68, v204
    v_mfma_f32_16x16x32_bf16 v[128:131], a[100:103], v[36:39], v[128:131]
    v_fmac_f32 v57, v69, v205
    v_fmac_f32 v57, v70, v206
    v_mfma_f32_16x16x32_bf16 v[120:123], a[104:107], v[24:27], v[120:123]
    v_fmac_f32 v57, v71, v207
    v_mul_f32 v50, v64, v176
    v_mfma_f32_16x16x32_bf16 v[128:131], a[104:107], v[40:43], v[128:131]
    v_fmac_f32 v50, v65, v177
    v_fmac_f32 v50, v66, v178
    v_mfma_f32_16x16x32_bf16 v[120:123], a[108:111], v[28:31], v[120:123]
    v_fmac_f32 v50, v67, v179
    v_mul_f32 v51, v64, v180
    v_mfma_f32_16x16x32_bf16 v[128:131], a[108:111], v[44:47], v[128:131]
    v_fmac_f32 v51, v65, v181
    v_fmac_f32 v51, v66, v182
    v_mfma_f32_16x16x32_bf16 v[124:127], a[112:115], v[16:19], 0
    v_fmac_f32 v51, v67, v183
    v_mul_f32 v58, v68, v208
    v_mfma_f32_16x16x32_bf16 v[132:135], a[112:115], v[32:35], 0
    v_cvt_pk_bf16_f32 v144, v120, v121
    v_cvt_pk_bf16_f32 v145, v122, v123
    v_mfma_f32_16x16x32_bf16 v[124:127], a[116:119], v[20:23], v[124:127]
    v_cvt_pk_bf16_f32 v148, v128, v129
    v_cvt_pk_bf16_f32 v149, v130, v131
    v_mfma_f32_16x16x32_bf16 v[132:135], a[116:119], v[36:39], v[132:135]
    v_fmac_f32 v58, v69, v209
    v_fmac_f32 v58, v70, v210
    v_mfma_f32_16x16x32_bf16 v[124:127], a[120:123], v[24:27], v[124:127]
    v_fmac_f32 v58, v71, v211
    v_mul_f32 v59, v68, v212
    v_mfma_f32_16x16x32_bf16 v[132:135], a[120:123], v[40:43], v[132:135]
    v_fmac_f32 v59, v69, v213
    v_fmac_f32 v59, v70, v214
    v_mfma_f32_16x16x32_bf16 v[124:127], a[124:127], v[28:31], v[124:127]
    v_fmac_f32 v59, v71, v215
    v_mul_f32 v52, v64, v184
    v_mfma_f32_16x16x32_bf16 v[132:135], a[124:127], v[44:47], v[132:135]
    v_mul_f32 v53, v64, v188
    v_mul_f32 v54, v64, v192
    v_mfma_f32_16x16x32_bf16 v[104:107], v[16:19], a[128:131], 0
    v_mul_f32 v55, v64, v196
    v_mul_f32 v60, v68, v216
    v_mfma_f32_16x16x32_bf16 v[112:115], v[32:35], a[128:131], 0
    v_cvt_pk_bf16_f32 v146, v124, v125
    v_cvt_pk_bf16_f32 v147, v126, v127
    v_mfma_f32_16x16x32_bf16 v[104:107], v[20:23], a[132:135], v[104:107]
    v_cvt_pk_bf16_f32 v150, v132, v133
    v_cvt_pk_bf16_f32 v151, v134, v135
    v_mfma_f32_16x16x32_bf16 v[152:155], v[144:147], v[28:31], v[152:155]
    v_mul_f32 v61, v68, v220
    v_mul_f32 v62, v68, v224
    v_mfma_f32_16x16x32_bf16 v[156:159], v[148:151], v[44:47], v[156:159]
    v_mul_f32 v63, v68, v228
    v_fmac_f32 v52, v65, v185
    v_mfma_f32_16x16x32_bf16 v[112:115], v[36:39], a[132:135], v[112:115]
    v_fmac_f32 v53, v65, v189
    v_fmac_f32 v54, v65, v193
    v_mfma_f32_16x16x32_bf16 v[104:107], v[24:27], a[136:139], v[104:107]
    v_fmac_f32 v55, v65, v197
    v_fmac_f32 v60, v69, v217
    v_mfma_f32_16x16x32_bf16 v[112:115], v[40:43], a[136:139], v[112:115]
    v_fmac_f32 v61, v69, v221
    v_fmac_f32 v62, v69, v225
    v_mfma_f32_16x16x32_bf16 v[104:107], v[28:31], a[140:143], v[104:107]
    v_fmac_f32 v63, v69, v229
    v_fmac_f32 v52, v66, v186
    v_mfma_f32_16x16x32_bf16 v[112:115], v[44:47], a[140:143], v[112:115]
    v_fmac_f32 v53, v66, v190
    v_fmac_f32 v54, v66, v194
    v_mfma_f32_16x16x32_bf16 v[108:111], v[16:19], a[144:147], 0
    v_fmac_f32 v55, v66, v198
    v_fmac_f32 v60, v70, v218
    v_mfma_f32_16x16x32_bf16 v[116:119], v[32:35], a[144:147], 0
    v_fmac_f32 v61, v70, v222
    v_fmac_f32 v62, v70, v226
    v_mfma_f32_16x16x32_bf16 v[108:111], v[20:23], a[148:151], v[108:111]
    v_fmac_f32 v63, v70, v230
    v_fmac_f32 v52, v67, v187
    v_mfma_f32_16x16x32_bf16 v[116:119], v[36:39], a[148:151], v[116:119]
    v_fmac_f32 v53, v67, v191
    v_fmac_f32 v54, v67, v195
    v_mfma_f32_16x16x32_bf16 v[108:111], v[24:27], a[152:155], v[108:111]
    v_fmac_f32 v55, v67, v199
    v_fmac_f32 v60, v71, v219
    v_mfma_f32_16x16x32_bf16 v[116:119], v[40:43], a[152:155], v[116:119]
    v_fmac_f32 v61, v71, v223
    v_fmac_f32 v62, v71, v227
    v_mfma_f32_16x16x32_bf16 v[108:111], v[28:31], a[156:159], v[108:111]
    v_fmac_f32 v63, v71, v231
    v_permlane16_swap_b32 v48, v52
    v_mfma_f32_16x16x32_bf16 v[116:119], v[44:47], a[156:159], v[116:119]
    v_permlane16_swap_b32 v49, v53
    v_mfma_f32_16x16x32_bf16 v[168:171], v[16:19], v[232:235], 0
    v_permlane16_swap_b32 v50, v54
    v_mfma_f32_16x16x32_bf16 v[172:175], v[16:19], v[236:239], 0
    v_permlane16_swap_b32 v51, v55
    v_mfma_f32_16x16x32_bf16 v[200:203], v[32:35], v[232:235], 0
    v_permlane16_swap_b32 v56, v60
    v_mfma_f32_16x16x32_bf16 v[204:207], v[32:35], v[236:239], 0
    v_permlane16_swap_b32 v57, v61
    v_mfma_f32_16x16x32_bf16 v[176:179], v[20:23], v[232:235], 0
    v_permlane16_swap_b32 v58, v62
    v_mfma_f32_16x16x32_bf16 v[180:183], v[20:23], v[236:239], 0
    v_permlane16_swap_b32 v59, v63
    v_mfma_f32_16x16x32_bf16 v[208:211], v[36:39], v[232:235], 0
    v_add_f32 v48, v48, v52
    v_add_f32 v49, v49, v53
    v_mfma_f32_16x16x32_bf16 v[212:215], v[36:39], v[236:239], 0
    v_add_f32 v50, v50, v54
    v_add_f32 v51, v51, v55
    v_mfma_f32_16x16x32_bf16 v[120:123], v[16:19], a[160:163], 0
    v_add_f32 v56, v56, v60
    v_add_f32 v57, v57, v61
    v_mfma_f32_16x16x32_bf16 v[128:131], v[32:35], a[160:163], 0
    v_add_f32 v58, v58, v62
    v_add_f32 v59, v59, v63
    v_mfma_f32_16x16x32_bf16 v[120:123], v[20:23], a[164:167], v[120:123]
    v_cvt_pk_bf16_f32 v53, v48, v49
    v_cvt_pk_bf16_f32 v55, v50, v51
    v_mfma_f32_16x16x32_bf16 v[128:131], v[36:39], a[164:167], v[128:131]
    buffer_store_dword v53, v252, s[12:15], 0 offen offset:0 sc1
    v_cvt_pk_bf16_f32 v61, v56, v57
    v_cvt_pk_bf16_f32 v63, v58, v59
    v_mfma_f32_16x16x32_bf16 v[120:123], v[24:27], a[168:171], v[120:123]
    buffer_store_dword v55, v252, s[12:15], 0 offen offset:64 sc1
    buffer_store_dword v61, v253, s[12:15], 0 offen offset:0 sc1
    buffer_store_dword v63, v253, s[12:15], 0 offen offset:64 sc1
    v_mfma_f32_16x16x32_bf16 v[128:131], v[40:43], a[168:171], v[128:131]
    buffer_load_dwordx2 v[252:253], v3, s[8:11], s23 offen
    v_rsq_f32 v11, v11
    v_mfma_f32_16x16x32_bf16 v[120:123], v[28:31], a[172:175], v[120:123]
    v_mul_f32 v11, v11, v101
    ds_write_b32 v4, v11
    v_mfma_f32_16x16x32_bf16 v[128:131], v[44:47], a[172:175], v[128:131]
    ds_read_b128 v[244:247], v8
    v_cndmask_b32_dpp v152, v156, v152, vcc row_ror:8 row_mask:0xf bank_mask:0xf
    v_cndmask_b32_dpp v153, v157, v153, vcc row_ror:8 row_mask:0xf bank_mask:0xf
    v_mfma_f32_16x16x32_bf16 v[124:127], v[16:19], a[176:179], 0
    v_cndmask_b32_dpp v154, v158, v154, vcc row_ror:8 row_mask:0xf bank_mask:0xf
    v_cndmask_b32_dpp v155, v159, v155, vcc row_ror:8 row_mask:0xf bank_mask:0xf
    v_mfma_f32_16x16x32_bf16 v[132:135], v[32:35], a[176:179], 0
    v_cvt_pk_bf16_f32 v136, v104, v105
    v_cvt_pk_bf16_f32 v137, v106, v107
    v_mfma_f32_16x16x32_bf16 v[124:127], v[20:23], a[180:183], v[124:127]
    v_cvt_pk_bf16_f32 v138, v108, v109
    v_cvt_pk_bf16_f32 v139, v110, v111
    v_mfma_f32_16x16x32_bf16 v[132:135], v[36:39], a[180:183], v[132:135]
    v_cvt_pk_bf16_f32 v140, v112, v113
    v_cvt_pk_bf16_f32 v141, v114, v115
    v_mfma_f32_16x16x32_bf16 v[124:127], v[24:27], a[184:187], v[124:127]
    v_cvt_pk_bf16_f32 v142, v116, v117
    v_cvt_pk_bf16_f32 v143, v118, v119
    v_mfma_f32_16x16x32_bf16 v[132:135], v[40:43], a[184:187], v[132:135]
    v_cvt_pk_bf16_f32 v144, v120, v121
    v_cvt_pk_bf16_f32 v145, v122, v123
    v_mfma_f32_16x16x32_bf16 v[124:127], v[28:31], a[188:191], v[124:127]
    s_waitcnt lgkmcnt(0)
    v_mul_f32 v152, v152, v244
    v_mfma_f32_16x16x32_bf16 v[132:135], v[44:47], a[188:191], v[132:135]
    v_mul_f32 v153, v153, v245
    v_mul_f32 v154, v154, v246
    v_mfma_f32_16x16x32_bf16 v[184:187], v[24:27], v[232:235], 0
    v_max3_f32 v156, v152, v153, v154
    v_mul_f32 v155, v155, v247
    v_mfma_f32_16x16x32_bf16 v[188:191], v[24:27], v[236:239], 0
    v_max_f32 v156, v156, v155
    v_mov_b32 v157, v156
    v_mfma_f32_16x16x32_bf16 v[216:219], v[40:43], v[232:235], 0
    v_cvt_pk_bf16_f32 v146, v124, v125
    v_permlane16_swap_b32 v156, v157
    v_mfma_f32_16x16x32_bf16 v[220:223], v[40:43], v[236:239], 0
    v_max_f32 v156, v156, v157
    v_mul_f32 v156, v156, v11
    v_mfma_f32_16x16x32_bf16 v[192:195], v[28:31], v[232:235], 0
    v_fma_f32 v152, v152, v11, -v156
    v_fma_f32 v153, v153, v11, -v156
    v_mfma_f32_16x16x32_bf16 v[196:199], v[28:31], v[236:239], 0
    v_fma_f32 v154, v154, v11, -v156
    v_fma_f32 v155, v155, v11, -v156
    v_mfma_f32_16x16x32_bf16 v[224:227], v[44:47], v[232:235], 0
    v_exp_f32 v152, v152
    v_mfma_f32_16x16x32_bf16 v[228:231], v[44:47], v[236:239], 0
    v_exp_f32 v153, v153
    v_mfma_f32_16x16x32_bf16 v[104:107], v[16:19], a[192:195], 0
    v_exp_f32 v154, v154
    v_mfma_f32_16x16x32_bf16 v[112:115], v[32:35], a[192:195], 0
    v_exp_f32 v155, v155
    v_add_f32 v156, v152, v153
    v_add_f32 v157, v154, v155
    v_mfma_f32_16x16x32_bf16 v[104:107], v[20:23], a[196:199], v[104:107]
    v_add_f32 v156, v156, v157
    v_mov_b32 v157, v156
    v_mfma_f32_16x16x32_bf16 v[112:115], v[36:39], a[196:199], v[112:115]
    v_mul_f32 v152, v152, v244
    v_permlane16_swap_b32 v156, v157
    v_add_f32 v156, v156, v157
    v_mul_f32 v156, v156, v101
    v_rcp_f32 v156, v156
    v_mul_f32 v153, v153, v245
    v_mul_f32 v154, v154, v246
    v_mul_f32 v155, v155, v247
    v_mul_f32 v152, v152, v156
    v_mul_f32 v153, v153, v156
    v_mul_f32 v154, v154, v156
    v_mul_f32 v155, v155, v156
    v_mfma_f32_16x16x32_bf16 v[104:107], v[24:27], a[200:203], v[104:107]
    v_cvt_pk_bf16_f32 v158, v152, v153
    v_cvt_pk_bf16_f32 v159, v154, v155
    v_and_b32 v240, v158, v10
    v_and_b32 v241, v159, v10
    v_mfma_f32_16x16x32_bf16 v[112:115], v[40:43], a[200:203], v[112:115]
    v_and_b32_dpp v242, v158, v10 row_ror:8 row_mask:0xf bank_mask:0xf
    v_and_b32_dpp v243, v159, v10 row_ror:8 row_mask:0xf bank_mask:0xf
    v_mfma_f32_16x16x16_bf16 v[168:171], v[240:241], v[136:137], v[168:171]
    v_cvt_pk_bf16_f32 v147, v126, v127
    v_cvt_pk_bf16_f32 v148, v128, v129
    v_mfma_f32_16x16x16_bf16 v[172:175], v[240:241], v[138:139], v[172:175]
    v_cvt_pk_bf16_f32 v149, v130, v131
    v_cvt_pk_bf16_f32 v150, v132, v133
    v_mfma_f32_16x16x16_bf16 v[200:203], v[242:243], v[140:141], v[200:203]
    v_cvt_pk_bf16_f32 v151, v134, v135
    v_xor_b32 v1, s49, v1
    v_mfma_f32_16x16x16_bf16 v[204:207], v[242:243], v[142:143], v[204:207]
    v_xor_b32 v76, 65536, v1
    v_xor_b32 v77, 66112, v1
    v_mfma_f32_16x16x32_bf16 v[104:107], v[28:31], a[204:207], v[104:107]
    v_cndmask_b32_dpp v250, v98, v250, vcc row_ror:8 row_mask:0xf bank_mask:0xf
    v_cndmask_b32_dpp v251, v99, v251, vcc row_ror:8 row_mask:0xf bank_mask:0xf
    v_mfma_f32_16x16x32_bf16 v[112:115], v[44:47], a[204:207], v[112:115]
    ds_write_b32 v4, v250 offset:128
    ds_write_b32 v4, v251 offset:256
    ds_read_b128 v[160:163], v8 offset:128
    v_mfma_f32_16x16x32_bf16 v[108:111], v[16:19], a[208:211], 0
    ds_read_b128 v[164:167], v8 offset:256
    v_cvt_pk_bf16_f32 v136, v104, v105
    v_cvt_pk_bf16_f32 v137, v106, v107
    v_mfma_f32_16x16x32_bf16 v[116:119], v[32:35], a[208:211], 0
    v_cvt_pk_bf16_f32 v140, v112, v113
    v_cvt_pk_bf16_f32 v141, v114, v115
    v_mfma_f32_16x16x32_bf16 v[108:111], v[20:23], a[212:215], v[108:111]
    v_cndmask_b32_dpp v249, v97, v249, vcc row_ror:8 row_mask:0xf bank_mask:0xf
    v_mul_f32 v48, v168, v168
    v_mfma_f32_16x16x32_bf16 v[116:119], v[36:39], a[212:215], v[116:119]
    v_mul_f32 v49, v169, v169
    v_mul_f32 v50, v170, v170
    v_mfma_f32_16x16x32_bf16 v[108:111], v[24:27], a[216:219], v[108:111]
    v_mul_f32 v51, v171, v171
    v_mul_f32 v52, v200, v200
    v_mfma_f32_16x16x32_bf16 v[116:119], v[40:43], a[216:219], v[116:119]
    v_mul_f32 v53, v201, v201
    v_mul_f32 v54, v202, v202
    v_mfma_f32_16x16x32_bf16 v[108:111], v[28:31], a[220:223], v[108:111]
    v_mul_f32 v55, v203, v203
    s_waitcnt lgkmcnt(1)
    v_mul_f32 v13, v152, v160
    v_mfma_f32_16x16x32_bf16 v[116:119], v[44:47], a[220:223], v[116:119]
    s_waitcnt lgkmcnt(0)
    v_mul_f32 v14, v152, v164
    v_mfma_f32_16x16x16_bf16 v[176:179], v[240:241], v[144:145], v[176:179]
    v_fmac_f32 v13, v153, v161
    v_fmac_f32 v14, v153, v165
    v_mfma_f32_16x16x16_bf16 v[180:183], v[240:241], v[146:147], v[180:183]
    v_cvt_pk_bf16_f32 v138, v108, v109
    v_cvt_pk_bf16_f32 v139, v110, v111
    v_mfma_f32_16x16x16_bf16 v[208:211], v[242:243], v[148:149], v[208:211]
    v_cvt_pk_bf16_f32 v142, v116, v117
    v_cvt_pk_bf16_f32 v143, v118, v119
    v_mfma_f32_16x16x16_bf16 v[212:215], v[242:243], v[150:151], v[212:215]
    v_fmac_f32 v13, v154, v162
    v_fmac_f32 v14, v154, v166
    v_mfma_f32_16x16x32_bf16 v[120:123], v[16:19], a[224:227], 0
    v_fmac_f32 v13, v155, v163
    v_fmac_f32 v14, v155, v167
    v_mfma_f32_16x16x32_bf16 v[128:131], v[32:35], a[224:227], 0
    v_fmac_f32 v48, v172, v172
    v_permlane16_swap_b32 v13, v14
    v_mfma_f32_16x16x32_bf16 v[120:123], v[20:23], a[228:231], v[120:123]
    v_add_f32 v13, v13, v14
    v_mov_b32 v14, v13
    v_mfma_f32_16x16x32_bf16 v[128:131], v[36:39], a[228:231], v[128:131]
    v_fmac_f32 v49, v173, v173
    v_permlane16_swap_b32 v13, v14
    v_mfma_f32_16x16x32_bf16 v[120:123], v[24:27], a[232:235], v[120:123]
    v_add_f32 v13, v13, v248
    v_add_f32 v14, v14, v249
    v_mfma_f32_16x16x32_bf16 v[128:131], v[40:43], a[232:235], v[128:131]
    v_fmac_f32 v50, v174, v174
    v_fmac_f32 v51, v175, v175
    v_mfma_f32_16x16x32_bf16 v[120:123], v[28:31], a[236:239], v[120:123]
    v_fmac_f32 v52, v204, v204
    v_fmac_f32 v53, v205, v205
    v_mfma_f32_16x16x32_bf16 v[128:131], v[44:47], a[236:239], v[128:131]
    v_fmac_f32 v54, v206, v206
    v_fmac_f32 v55, v207, v207
    v_mfma_f32_16x16x32_bf16 v[124:127], v[16:19], a[240:243], 0
    ds_read2st64_b32 v[16:17], v76 offset0:0 offset1:4
    ds_read2st64_b32 v[18:19], v77 offset0:0 offset1:4
    v_cvt_pk_bf16_f32 v144, v120, v121
    v_mfma_f32_16x16x32_bf16 v[132:135], v[32:35], a[240:243], 0
    v_cvt_pk_bf16_f32 v145, v122, v123
    v_cvt_pk_bf16_f32 v148, v128, v129
    v_mfma_f32_16x16x32_bf16 v[124:127], v[20:23], a[244:247], v[124:127]
    ds_read2st64_b32 v[20:21], v76 offset0:8 offset1:12
    v_cvt_pk_bf16_f32 v149, v130, v131
    ds_read2st64_b32 v[22:23], v77 offset0:8 offset1:12
    v_mfma_f32_16x16x32_bf16 v[132:135], v[36:39], a[244:247], v[132:135]
    v_fmac_f32 v48, v176, v176
    v_fmac_f32 v49, v177, v177
    v_mfma_f32_16x16x32_bf16 v[124:127], v[24:27], a[248:251], v[124:127]
    ds_read2st64_b32 v[24:25], v76 offset0:16 offset1:20
    ds_read2st64_b32 v[26:27], v77 offset0:16 offset1:20
    v_fmac_f32 v50, v178, v178
    v_mfma_f32_16x16x32_bf16 v[132:135], v[40:43], a[248:251], v[132:135]
    v_fmac_f32 v51, v179, v179
    v_fmac_f32 v52, v208, v208
    v_mfma_f32_16x16x32_bf16 v[124:127], v[28:31], a[252:255], v[124:127]
    ds_read2st64_b32 v[28:29], v76 offset0:24 offset1:28
    ds_read2st64_b32 v[30:31], v77 offset0:24 offset1:28
    v_fmac_f32 v53, v209, v209
    v_mfma_f32_16x16x32_bf16 v[132:135], v[44:47], a[252:255], v[132:135]
    v_fmac_f32 v54, v210, v210
    v_fmac_f32 v55, v211, v211
    v_mfma_f32_16x16x16_bf16 v[184:187], v[240:241], v[136:137], v[184:187]
    v_fmac_f32 v48, v180, v180
    v_cvt_pk_bf16_f32 v146, v124, v125
    v_mfma_f32_16x16x16_bf16 v[188:191], v[240:241], v[138:139], v[188:191]
    v_cvt_pk_bf16_f32 v147, v126, v127
    v_fmac_f32 v49, v181, v181
    v_mfma_f32_16x16x16_bf16 v[216:219], v[242:243], v[140:141], v[216:219]
    v_cvt_pk_bf16_f32 v150, v132, v133
    v_cvt_pk_bf16_f32 v151, v134, v135
    v_mfma_f32_16x16x16_bf16 v[220:223], v[242:243], v[142:143], v[220:223]
    v_fmac_f32 v50, v182, v182
    v_fmac_f32 v51, v183, v183
    v_mfma_f32_16x16x16_bf16 v[192:195], v[240:241], v[144:145], v[192:195]
    v_fmac_f32 v52, v212, v212
    v_fmac_f32 v53, v213, v213
    v_mfma_f32_16x16x16_bf16 v[196:199], v[240:241], v[146:147], v[196:199]
    v_fmac_f32 v54, v214, v214
    v_fmac_f32 v55, v215, v215
    v_mfma_f32_16x16x16_bf16 v[224:227], v[242:243], v[148:149], v[224:227]
    v_fmac_f32 v48, v184, v184
    v_fmac_f32 v49, v185, v185
    v_mfma_f32_16x16x16_bf16 v[228:231], v[242:243], v[150:151], v[228:231]
    v_fmac_f32 v50, v186, v186
    v_fmac_f32 v51, v187, v187
    s_waitcnt lgkmcnt(6)
    v_mfma_f32_16x16x32_bf16 v[104:107], a[0:3], v[16:19], 0
    v_fmac_f32 v52, v216, v216
    v_fmac_f32 v53, v217, v217
    s_waitcnt lgkmcnt(4)
    v_mfma_f32_16x16x32_bf16 v[104:107], a[4:7], v[20:23], v[104:107]
    v_fmac_f32 v54, v218, v218
    v_fmac_f32 v55, v219, v219
    s_waitcnt lgkmcnt(2)
    v_mfma_f32_16x16x32_bf16 v[104:107], a[8:11], v[24:27], v[104:107]
    v_fmac_f32 v48, v188, v188
    v_fmac_f32 v49, v189, v189
    s_waitcnt lgkmcnt(0)
    v_mfma_f32_16x16x32_bf16 v[104:107], a[12:15], v[28:31], v[104:107]
    v_fmac_f32 v50, v190, v190
    v_fmac_f32 v51, v191, v191
    v_mfma_f32_16x16x32_bf16 v[108:111], a[16:19], v[16:19], 0
    v_fmac_f32 v52, v220, v220
    v_fmac_f32 v53, v221, v221
    v_mfma_f32_16x16x32_bf16 v[108:111], a[20:23], v[20:23], v[108:111]
    v_fmac_f32 v54, v222, v222
    v_fmac_f32 v55, v223, v223
    v_mfma_f32_16x16x32_bf16 v[108:111], a[24:27], v[24:27], v[108:111]
    v_fmac_f32 v48, v192, v192
    v_fmac_f32 v49, v193, v193
    v_mfma_f32_16x16x32_bf16 v[108:111], a[28:31], v[28:31], v[108:111]
    v_fmac_f32 v50, v194, v194
    v_fmac_f32 v51, v195, v195
    v_mfma_f32_16x16x32_bf16 v[120:123], v[16:19], v[16:19], 0
    v_fmac_f32 v52, v224, v224
    v_fmac_f32 v53, v225, v225
    v_mfma_f32_16x16x32_bf16 v[248:251], v[80:83], v[16:19], 0
    ds_read_b128 v[80:83], v15 offset:2048
    v_fmac_f32 v54, v226, v226
    v_fmac_f32 v55, v227, v227
    v_mfma_f32_16x16x32_bf16 v[120:123], v[20:23], v[20:23], v[120:123]
    v_fmac_f32 v48, v196, v196
    v_fmac_f32 v49, v197, v197
    v_mfma_f32_16x16x32_bf16 v[248:251], v[84:87], v[20:23], v[248:251]
    ds_read_b128 v[84:87], v15 offset:3072
    v_fmac_f32 v50, v198, v198
    v_fmac_f32 v51, v199, v199
    v_mfma_f32_16x16x32_bf16 v[120:123], v[24:27], v[24:27], v[120:123]
    v_fmac_f32 v52, v228, v228
    v_fmac_f32 v53, v229, v229
    v_mfma_f32_16x16x32_bf16 v[120:123], v[28:31], v[28:31], v[120:123]
    v_fmac_f32 v54, v230, v230
    v_fmac_f32 v55, v231, v231
    v_cvt_pk_bf16_f32 v64, v48, v49
    v_cvt_pk_bf16_f32 v65, v50, v51
    v_cvt_pk_bf16_f32 v66, v52, v53
    v_cvt_pk_bf16_f32 v67, v54, v55
    v_cvt_pk_bf16_f32 v136, v104, v105
    v_cvt_pk_bf16_f32 v137, v106, v107
    v_mfma_f32_16x16x32_bf16 v[68:71], v[64:67], v[88:91], 0
    v_cvt_pk_bf16_f32 v138, v108, v109
    v_cvt_pk_bf16_f32 v139, v110, v111
    v_mfma_f32_16x16x32_bf16 v[72:75], v[64:67], v[92:95], 0
    v_cndmask_b32 v120, v120, v121, s[32:33]
    v_cndmask_b32 v120, v120, v122, s[34:35]
    s_waitcnt lgkmcnt(1)
    v_mfma_f32_16x16x32_bf16 v[248:251], v[80:83], v[24:27], v[248:251]
    v_cndmask_b32 v120, v120, v123, s[36:37]
    v_cndmask_b32 v11, 0, v120, s[38:39]
    s_waitcnt lgkmcnt(0)
    v_mfma_f32_16x16x32_bf16 v[248:251], v[84:87], v[28:31], v[248:251]
    v_cndmask_b32 v2, 0, v120, s[38:39]
    v_cndmask_b32 v122, 0, v124, s[38:39]
    v_mfma_f32_16x16x32_bf16 v[152:155], v[136:139], v[16:19], 0
    v_add_f32 v68, v68, v69
    v_mov_b32_dpp v11, v122 row_ror:8 row_mask:0xf bank_mask:0xc
    v_mfma_f32_16x16x32_bf16 v[124:127], a[48:51], v[16:19], 0
    v_mov_b32_dpp v2, v122 row_ror:8 row_mask:0xf bank_mask:0x3
    v_add_f32 v70, v70, v71
    v_mfma_f32_16x16x32_bf16 v[120:123], a[32:35], v[16:19], 0
    v_add_f32 v72, v72, v73
    v_add_f32 v74, v74, v75
    v_mfma_f32_16x16x32_bf16 v[120:123], a[36:39], v[20:23], v[120:123]
    v_add_f32 v68, v68, v70
    v_add_f32 v72, v72, v74
    v_mfma_f32_16x16x32_bf16 v[120:123], a[40:43], v[24:27], v[120:123]
    v_mul_f32 v13, s28, v13
    v_permlane32_swap_b32 v68, v72
    v_mfma_f32_16x16x32_bf16 v[120:123], a[44:47], v[28:31], v[120:123]
    v_add_f32 v5, v68, v72
    v_mov_b32 v72, v5
    v_mfma_f32_16x16x32_bf16 v[124:127], a[52:55], v[20:23], v[124:127]
    v_fma_f32 v14, -v13, s24, v14
    v_permlane16_swap_b32 v5, v72
    v_mfma_f32_16x16x32_bf16 v[124:127], a[56:59], v[24:27], v[124:127]
    v_add_f32 v5, v5, v72
    v_mul_f32 v13, v13, v13
    v_mfma_f32_16x16x32_bf16 v[124:127], a[60:63], v[28:31], v[124:127]
    v_cvt_pk_bf16_f32 v144, v120, v121
    v_cvt_pk_bf16_f32 v145, v122, v123
    v_mfma_f32_16x16x32_bf16 v[104:107], a[64:67], v[16:19], 0
    v_fma_f32 v5, v5, s28, -v13
    v_mul_f32 v6, v101, v101
    v_mfma_f32_16x16x32_bf16 v[104:107], a[68:71], v[20:23], v[104:107]
    v_max_f32 v5, 0, v5
    v_fma_f32 v5, v5, v6, s29
    v_mfma_f32_16x16x32_bf16 v[104:107], a[72:75], v[24:27], v[104:107]
    v_cvt_pk_bf16_f32 v146, v124, v125
    v_cvt_pk_bf16_f32 v147, v126, v127
    v_mfma_f32_16x16x32_bf16 v[104:107], a[76:79], v[28:31], v[104:107]
    v_rsq_f32 v5, v5
    v_mfma_f32_16x16x32_bf16 v[152:155], v[144:147], v[20:23], v[152:155]
    v_mul_f32 v14, s30, v14
    v_mul_f32 v14, v14, v101
    v_mfma_f32_16x16x32_bf16 v[108:111], a[80:83], v[16:19], 0
    v_mul_f32 v5, v5, v14
    v_permlane32_swap_b32 v11, v2
    v_mfma_f32_16x16x32_bf16 v[108:111], a[84:87], v[20:23], v[108:111]
    v_cvt_pk_bf16_f32 v136, v104, v105
    v_cvt_pk_bf16_f32 v137, v106, v107
    v_mfma_f32_16x16x32_bf16 v[108:111], a[88:91], v[24:27], v[108:111]
    v_max_f32_dpp v6, v5, v5 quad_perm:[1,0,3,2] row_mask:0xf bank_mask:0xf
    v_add_f32 v11, v11, v2
    v_mfma_f32_16x16x32_bf16 v[108:111], a[92:95], v[28:31], v[108:111]
    v_max_f32_dpp v6, v6, v6 quad_perm:[2,3,0,1] row_mask:0xf bank_mask:0xf
    v_mov_b32 v2, v11
    v_mfma_f32_16x16x32_bf16 v[120:123], a[96:99], v[16:19], 0
    v_max_f32_dpp v6, v6, v6 row_half_mirror row_mask:0xf bank_mask:0xf
    v_sub_f32 v5, v5, v6
    v_mfma_f32_16x16x32_bf16 v[120:123], a[100:103], v[20:23], v[120:123]
    v_exp_f32 v5, v5
    v_mfma_f32_16x16x32_bf16 v[120:123], a[104:107], v[24:27], v[120:123]
    v_cvt_pk_bf16_f32 v138, v108, v109
    v_cvt_pk_bf16_f32 v139, v110, v111
    v_mfma_f32_16x16x32_bf16 v[120:123], a[108:111], v[28:31], v[120:123]
    v_add_f32_dpp v6, v5, v5 quad_perm:[1,0,3,2] row_mask:0xf bank_mask:0xf
    v_mul_f32 v5, v5, v101
    v_mfma_f32_16x16x32_bf16 v[152:155], v[136:139], v[24:27], v[152:155]
    v_add_f32_dpp v6, v6, v6 quad_perm:[2,3,0,1] row_mask:0xf bank_mask:0xf
    v_permlane16_swap_b32 v11, v2
    v_mfma_f32_16x16x32_bf16 v[124:127], a[112:115], v[16:19], 0
    v_add_f32_dpp v6, v6, v6 row_half_mirror row_mask:0xf bank_mask:0xf
    v_rcp_f32 v6, v6
    v_mfma_f32_16x16x32_bf16 v[124:127], a[116:119], v[20:23], v[124:127]
    v_cvt_pk_bf16_f32 v144, v120, v121
    v_cvt_pk_bf16_f32 v145, v122, v123
    v_mfma_f32_16x16x32_bf16 v[124:127], a[120:123], v[24:27], v[124:127]
    v_mul_f32 v5, v5, v6
    ds_write_b32 v4, v5 offset:512
    v_mfma_f32_16x16x32_bf16 v[124:127], a[124:127], v[28:31], v[124:127]
    ds_read_b128 v[64:67], v9 offset:512
    v_cndmask_b32_dpp v248, v96, v248, vcc row_ror:8 row_mask:0xf bank_mask:0xf
    v_add_f32 v11, v11, v2
    v_mfma_f32_16x16x32_bf16 v[104:107], v[16:19], a[128:131], 0
    ds_read_b128 v[68:71], v9 offset:576
    v_mul_f32 v2, s28, v248
    v_mul_f32 v2, v2, v2
    v_mfma_f32_16x16x32_bf16 v[104:107], v[20:23], a[132:135], v[104:107]
    v_cvt_pk_bf16_f32 v146, v124, v125
    v_cvt_pk_bf16_f32 v147, v126, v127
    v_mfma_f32_16x16x32_bf16 v[104:107], v[24:27], a[136:139], v[104:107]
    v_fma_f32 v11, v11, s28, -v2
    s_waitcnt vmcnt(5)
    v_mul_f32 v2, v100, v100
    v_mfma_f32_16x16x32_bf16 v[152:155], v[144:147], v[28:31], v[152:155]
    v_max_f32 v11, 0, v11
    v_fma_f32 v11, v11, v2, s29
    v_mfma_f32_16x16x32_bf16 v[104:107], v[28:31], a[140:143], v[104:107]
    v_rsq_f32 v11, v11
    v_mfma_f32_16x16x32_bf16 v[108:111], v[16:19], a[144:147], 0
    v_mul_f32 v11, v11, v100
    ds_write_b32 v4, v11
    v_mfma_f32_16x16x32_bf16 v[108:111], v[20:23], a[148:151], v[108:111]
    ds_read_b128 v[244:247], v8
    s_waitcnt lgkmcnt(3)
    v_mul_f32 v48, v64, v168
    v_mfma_f32_16x16x32_bf16 v[108:111], v[24:27], a[152:155], v[108:111]
    v_fmac_f32 v48, v65, v169
    v_fmac_f32 v48, v66, v170
    v_mfma_f32_16x16x32_bf16 v[108:111], v[28:31], a[156:159], v[108:111]
    v_fmac_f32 v48, v67, v171
    v_mul_f32 v49, v64, v172
    v_mfma_f32_16x16x32_bf16 v[168:171], v[16:19], v[232:235], 0
    v_fmac_f32 v49, v65, v173
    v_fmac_f32 v49, v66, v174
    v_mfma_f32_16x16x32_bf16 v[120:123], v[16:19], a[160:163], 0
    v_fmac_f32 v49, v67, v175
    v_mul_f32 v50, v64, v176
    v_mfma_f32_16x16x32_bf16 v[172:175], v[16:19], v[236:239], 0
    v_fmac_f32 v50, v65, v177
    v_fmac_f32 v50, v66, v178
    v_mfma_f32_16x16x32_bf16 v[120:123], v[20:23], a[164:167], v[120:123]
    v_fmac_f32 v50, v67, v179
    v_mul_f32 v51, v64, v180
    v_mfma_f32_16x16x32_bf16 v[176:179], v[20:23], v[232:235], 0
    v_fmac_f32 v51, v65, v181
    v_fmac_f32 v51, v66, v182
    v_mfma_f32_16x16x32_bf16 v[120:123], v[24:27], a[168:171], v[120:123]
    v_fmac_f32 v51, v67, v183
    v_cndmask_b32_dpp v152, v156, v152, vcc row_ror:8 row_mask:0xf bank_mask:0xf
    v_mfma_f32_16x16x32_bf16 v[180:183], v[20:23], v[236:239], 0
    v_cndmask_b32_dpp v153, v157, v153, vcc row_ror:8 row_mask:0xf bank_mask:0xf
    v_cndmask_b32_dpp v154, v158, v154, vcc row_ror:8 row_mask:0xf bank_mask:0xf
    v_mfma_f32_16x16x32_bf16 v[120:123], v[28:31], a[172:175], v[120:123]
    v_cndmask_b32_dpp v155, v159, v155, vcc row_ror:8 row_mask:0xf bank_mask:0xf
    s_waitcnt lgkmcnt(0)
    v_mul_f32 v152, v152, v244
    v_mfma_f32_16x16x32_bf16 v[124:127], v[16:19], a[176:179], 0
    v_mul_f32 v153, v153, v245
    v_mul_f32 v154, v154, v246
    v_mfma_f32_16x16x32_bf16 v[124:127], v[20:23], a[180:183], v[124:127]
    v_max3_f32 v156, v152, v153, v154
    v_mul_f32 v155, v155, v247
    v_mfma_f32_16x16x32_bf16 v[124:127], v[24:27], a[184:187], v[124:127]
    v_max_f32 v156, v156, v155
    v_mov_b32 v157, v156
    v_mfma_f32_16x16x32_bf16 v[124:127], v[28:31], a[188:191], v[124:127]
    v_mul_f32 v52, v64, v184
    v_permlane16_swap_b32 v156, v157
    v_fmac_f32 v52, v65, v185
    v_fmac_f32 v52, v66, v186
    v_max_f32 v156, v156, v157
    v_fmac_f32 v52, v67, v187
    v_mfma_f32_16x16x32_bf16 v[184:187], v[24:27], v[232:235], 0
    v_mul_f32 v156, v156, v11
    v_fma_f32 v152, v152, v11, -v156
    v_fma_f32 v153, v153, v11, -v156
    v_fma_f32 v154, v154, v11, -v156
    v_fma_f32 v155, v155, v11, -v156
    v_mul_f32 v53, v64, v188
    v_exp_f32 v152, v152
    v_exp_f32 v153, v153
    v_exp_f32 v154, v154
    v_exp_f32 v155, v155
    v_fmac_f32 v53, v65, v189
    v_fmac_f32 v53, v66, v190
    v_fmac_f32 v53, v67, v191
    v_mfma_f32_16x16x32_bf16 v[188:191], v[24:27], v[236:239], 0
    v_add_f32 v156, v152, v153
    v_add_f32 v157, v154, v155
    v_add_f32 v156, v156, v157
    v_mov_b32 v157, v156
    v_mul_f32 v54, v64, v192
    v_fmac_f32 v54, v65, v193
    v_fmac_f32 v54, v66, v194
    v_permlane16_swap_b32 v156, v157
    v_fmac_f32 v54, v67, v195
    v_mfma_f32_16x16x32_bf16 v[192:195], v[28:31], v[232:235], 0
    v_add_f32 v156, v156, v157
    v_mul_f32 v55, v64, v196
    v_mul_f32 v156, v156, v100
    v_fmac_f32 v55, v65, v197
    v_rcp_f32 v156, v156
    v_fmac_f32 v55, v66, v198
    v_fmac_f32 v55, v67, v199
    v_mfma_f32_16x16x32_bf16 v[196:199], v[28:31], v[236:239], 0
    v_mul_f32 v152, v152, v244
    v_mul_f32 v153, v153, v245
    v_mul_f32 v154, v154, v246
    v_mul_f32 v155, v155, v247
    v_mul_f32 v152, v152, v156
    v_mul_f32 v153, v153, v156
    v_mul_f32 v154, v154, v156
    v_mul_f32 v155, v155, v156
    v_cvt_pk_bf16_f32 v158, v152, v153
    v_cvt_pk_bf16_f32 v159, v154, v155
    v_cvt_pk_bf16_f32 v136, v104, v105
    v_cvt_pk_bf16_f32 v137, v106, v107
    v_mfma_f32_16x16x32_bf16 v[104:107], v[16:19], a[192:195], 0
    v_and_b32 v240, v158, v10
    v_and_b32 v241, v159, v10
    v_mfma_f32_16x16x32_bf16 v[104:107], v[20:23], a[196:199], v[104:107]
    v_cvt_pk_bf16_f32 v138, v108, v109
    v_cvt_pk_bf16_f32 v139, v110, v111
    v_mfma_f32_16x16x16_bf16 v[168:171], v[240:241], v[136:137], v[168:171]
    v_cvt_pk_bf16_f32 v144, v120, v121
    v_cvt_pk_bf16_f32 v145, v122, v123
    v_mfma_f32_16x16x16_bf16 v[172:175], v[240:241], v[138:139], v[172:175]
    v_cvt_pk_bf16_f32 v146, v124, v125
    v_cvt_pk_bf16_f32 v147, v126, v127
    v_mfma_f32_16x16x32_bf16 v[108:111], v[16:19], a[208:211], 0
    v_cndmask_b32_dpp v250, v98, v250, vcc row_ror:8 row_mask:0xf bank_mask:0xf
    v_cndmask_b32_dpp v251, v99, v251, vcc row_ror:8 row_mask:0xf bank_mask:0xf
    v_mfma_f32_16x16x32_bf16 v[120:123], v[16:19], a[224:227], 0
    ds_write_b32 v4, v250 offset:128
    ds_write_b32 v4, v251 offset:256
    ds_read_b128 v[160:163], v8 offset:128
    v_mfma_f32_16x16x32_bf16 v[124:127], v[16:19], a[240:243], 0
    ds_read_b128 v[164:167], v8 offset:256
    v_permlane16_swap_b32 v48, v52
    v_mfma_f32_16x16x32_bf16 v[108:111], v[20:23], a[212:215], v[108:111]
    v_permlane16_swap_b32 v49, v53
    v_mfma_f32_16x16x32_bf16 v[120:123], v[20:23], a[228:231], v[120:123]
    v_permlane16_swap_b32 v50, v54
    v_mfma_f32_16x16x32_bf16 v[124:127], v[20:23], a[244:247], v[124:127]
    v_permlane16_swap_b32 v51, v55
    v_mfma_f32_16x16x32_bf16 v[104:107], v[24:27], a[200:203], v[104:107]
    v_add_f32 v48, v48, v52
    v_add_f32 v49, v49, v53
    v_mfma_f32_16x16x32_bf16 v[108:111], v[24:27], a[216:219], v[108:111]
    v_add_f32 v50, v50, v54
    v_add_f32 v51, v51, v55
    v_mfma_f32_16x16x32_bf16 v[120:123], v[24:27], a[232:235], v[120:123]
    v_cvt_pk_bf16_f32 v53, v48, v49
    v_cvt_pk_bf16_f32 v55, v50, v51
    v_mfma_f32_16x16x32_bf16 v[124:127], v[24:27], a[248:251], v[124:127]
    v_mul_f32 v48, v168, v168
    v_mul_f32 v49, v169, v169
    v_mfma_f32_16x16x32_bf16 v[104:107], v[28:31], a[204:207], v[104:107]
    v_mul_f32 v50, v170, v170
    v_mul_f32 v51, v171, v171
    v_mfma_f32_16x16x32_bf16 v[108:111], v[28:31], a[220:223], v[108:111]
    v_fmac_f32 v48, v172, v172
    v_fmac_f32 v49, v173, v173
    v_mfma_f32_16x16x32_bf16 v[120:123], v[28:31], a[236:239], v[120:123]
    v_fmac_f32 v50, v174, v174
    v_fmac_f32 v51, v175, v175
    v_mfma_f32_16x16x32_bf16 v[124:127], v[28:31], a[252:255], v[124:127]
    v_cvt_pk_bf16_f32 v136, v104, v105
    v_cvt_pk_bf16_f32 v137, v106, v107
    v_mfma_f32_16x16x16_bf16 v[176:179], v[240:241], v[144:145], v[176:179]
    v_cvt_pk_bf16_f32 v138, v108, v109
    v_cvt_pk_bf16_f32 v139, v110, v111
    v_mfma_f32_16x16x16_bf16 v[180:183], v[240:241], v[146:147], v[180:183]
    v_cvt_pk_bf16_f32 v144, v120, v121
    v_cvt_pk_bf16_f32 v145, v122, v123
    v_mfma_f32_16x16x16_bf16 v[184:187], v[240:241], v[136:137], v[184:187]
    v_cvt_pk_bf16_f32 v146, v124, v125
    v_cvt_pk_bf16_f32 v147, v126, v127
    v_mfma_f32_16x16x16_bf16 v[188:191], v[240:241], v[138:139], v[188:191]
    v_fmac_f32 v48, v176, v176
    v_fmac_f32 v49, v177, v177
    v_mfma_f32_16x16x16_bf16 v[192:195], v[240:241], v[144:145], v[192:195]
    v_fmac_f32 v50, v178, v178
    v_fmac_f32 v51, v179, v179
    v_mfma_f32_16x16x16_bf16 v[196:199], v[240:241], v[146:147], v[196:199]
    v_fmac_f32 v48, v180, v180
    v_fmac_f32 v49, v181, v181
    v_fmac_f32 v50, v182, v182
    v_fmac_f32 v51, v183, v183
    v_fmac_f32 v48, v184, v184
    v_fmac_f32 v49, v185, v185
    v_fmac_f32 v50, v186, v186
    v_fmac_f32 v51, v187, v187
    v_fmac_f32 v48, v188, v188
    v_fmac_f32 v49, v189, v189
    v_fmac_f32 v50, v190, v190
    v_fmac_f32 v51, v191, v191
    v_fmac_f32 v48, v192, v192
    v_fmac_f32 v49, v193, v193
    v_fmac_f32 v50, v194, v194
    v_fmac_f32 v51, v195, v195
    v_fmac_f32 v48, v196, v196
    v_fmac_f32 v49, v197, v197
    v_fmac_f32 v50, v198, v198
    v_fmac_f32 v51, v199, v199
    v_mul_f32 v56, v68, v200
    v_mul_f32 v60, v68, v216
    v_mul_f32 v57, v68, v204
    v_mul_f32 v61, v68, v220
    v_mul_f32 v58, v68, v208
    v_mul_f32 v62, v68, v224
    v_mul_f32 v59, v68, v212
    v_mul_f32 v63, v68, v228
    v_cvt_pk_bf16_f32 v64, v48, v49
    v_cvt_pk_bf16_f32 v65, v50, v51
    v_fmac_f32 v56, v69, v201
    v_fmac_f32 v60, v69, v217
    v_fmac_f32 v57, v69, v205
    v_fmac_f32 v61, v69, v221
    v_fmac_f32 v58, v69, v209
    v_fmac_f32 v62, v69, v225
    v_fmac_f32 v59, v69, v213
    v_fmac_f32 v63, v69, v229
    v_mov_b32 v66, 0
    v_mov_b32 v67, 0
    v_fmac_f32 v56, v70, v202
    v_fmac_f32 v60, v70, v218
    v_mfma_f32_16x16x32_bf16 v[72:75], v[64:67], v[92:95], 0
    v_fmac_f32 v57, v70, v206
    v_fmac_f32 v61, v70, v222
    v_fmac_f32 v58, v70, v210
    v_fmac_f32 v62, v70, v226
    v_fmac_f32 v59, v70, v214
    v_fmac_f32 v63, v70, v230
    v_fmac_f32 v56, v71, v203
    v_fmac_f32 v60, v71, v219
    v_fmac_f32 v57, v71, v207
    v_fmac_f32 v61, v71, v223
    v_fmac_f32 v58, v71, v211
    v_fmac_f32 v62, v71, v227
    v_fmac_f32 v59, v71, v215
    v_fmac_f32 v63, v71, v231
    v_mfma_f32_16x16x32_bf16 v[68:71], v[64:67], v[88:91], 0
    s_waitcnt lgkmcnt(1)
    v_mul_f32 v13, v152, v160
    s_waitcnt lgkmcnt(0)
    v_mul_f32 v14, v152, v164
    v_fmac_f32 v13, v153, v161
    v_fmac_f32 v14, v153, v165
    v_fmac_f32 v13, v154, v162
    v_fmac_f32 v14, v154, v166
    v_fmac_f32 v13, v155, v163
    v_fmac_f32 v14, v155, v167
    v_add_f32 v68, v68, v69
    v_add_f32 v70, v70, v71
    v_add_f32 v72, v72, v73
    v_add_f32 v74, v74, v75
    v_permlane16_swap_b32 v13, v14
    v_add_f32 v68, v68, v70
    v_add_f32 v72, v72, v74
    v_add_f32 v13, v13, v14
    v_mov_b32 v14, v13
    v_permlane32_swap_b32 v68, v72
    v_add_f32 v5, v68, v72
    v_permlane16_swap_b32 v13, v14
    v_mov_b32 v72, v5
    v_cndmask_b32_dpp v249, v97, v249, vcc row_ror:8 row_mask:0xf bank_mask:0xf
    v_add_f32 v13, v13, v248
    v_add_f32 v14, v14, v249
    v_mul_f32 v13, s28, v13
    v_permlane16_swap_b32 v5, v72
    v_fma_f32 v14, -v13, s24, v14
    v_add_f32 v5, v5, v72
    v_mul_f32 v13, v13, v13
    v_fma_f32 v5, v5, s28, -v13
    v_mul_f32 v6, v100, v100
    v_max_f32 v5, 0, v5
    v_fma_f32 v5, v5, v6, s29
    v_rsq_f32 v5, v5
    v_mul_f32 v14, s30, v14
    v_mul_f32 v14, v14, v100
    v_mul_f32 v5, v5, v14
    v_lshl_add_u32 v254, v254, 8, v7
    buffer_store_dword v53, v254, s[12:15], 0 offen offset:0 sc1
    v_max_f32_dpp v6, v5, v5 quad_perm:[1,0,3,2] row_mask:0xf bank_mask:0xf
    buffer_store_dword v55, v254, s[12:15], 0 offen offset:64 sc1
    v_permlane16_swap_b32 v56, v60
    v_max_f32_dpp v6, v6, v6 quad_perm:[2,3,0,1] row_mask:0xf bank_mask:0xf
    v_permlane16_swap_b32 v57, v61
    v_permlane16_swap_b32 v58, v62
    v_max_f32_dpp v6, v6, v6 row_half_mirror row_mask:0xf bank_mask:0xf
    v_sub_f32 v5, v5, v6
    v_exp_f32 v5, v5
    v_permlane16_swap_b32 v59, v63
    v_add_f32 v56, v56, v60
    v_add_f32_dpp v6, v5, v5 quad_perm:[1,0,3,2] row_mask:0xf bank_mask:0xf
    v_mul_f32 v5, v5, v100
    v_add_f32 v57, v57, v61
    v_add_f32_dpp v6, v6, v6 quad_perm:[2,3,0,1] row_mask:0xf bank_mask:0xf
    v_add_f32 v58, v58, v62
    v_add_f32 v59, v59, v63
    v_add_f32_dpp v6, v6, v6 row_half_mirror row_mask:0xf bank_mask:0xf
    v_rcp_f32 v6, v6
    v_lshl_add_u32 v255, v255, 8, v7
    v_mul_f32 v5, v5, v6
    ds_write_b32 v4, v5 offset:512
    ds_read_b128 v[64:67], v9 offset:512
    v_cvt_pk_bf16_f32 v61, v56, v57
    v_cvt_pk_bf16_f32 v63, v58, v59
    s_waitcnt vmcnt(2)
    v_lshl_add_u32 v252, v252, 8, v7
    buffer_store_dword v61, v255, s[12:15], 0 offen offset:0 sc1
    buffer_store_dword v63, v255, s[12:15], 0 offen offset:64 sc1
    v_lshl_add_u32 v253, v253, 8, v7
    s_waitcnt lgkmcnt(0)
    v_mul_f32 v48, v64, v168
    v_mul_f32 v52, v64, v184
    v_mul_f32 v49, v64, v172
    v_mul_f32 v53, v64, v188
    v_mul_f32 v50, v64, v176
    v_mul_f32 v54, v64, v192
    v_mul_f32 v51, v64, v180
    v_mul_f32 v55, v64, v196
    v_fmac_f32 v48, v65, v169
    v_fmac_f32 v52, v65, v185
    v_fmac_f32 v49, v65, v173
    v_fmac_f32 v53, v65, v189
    v_fmac_f32 v50, v65, v177
    v_fmac_f32 v54, v65, v193
    v_fmac_f32 v51, v65, v181
    v_fmac_f32 v55, v65, v197
    v_fmac_f32 v48, v66, v170
    v_fmac_f32 v52, v66, v186
    v_fmac_f32 v49, v66, v174
    v_fmac_f32 v53, v66, v190
    v_fmac_f32 v50, v66, v178
    v_fmac_f32 v54, v66, v194
    v_fmac_f32 v51, v66, v182
    v_fmac_f32 v55, v66, v198
    v_fmac_f32 v48, v67, v171
    v_fmac_f32 v52, v67, v187
    v_fmac_f32 v49, v67, v175
    v_fmac_f32 v53, v67, v191
    v_fmac_f32 v50, v67, v179
    v_fmac_f32 v54, v67, v195
    v_fmac_f32 v51, v67, v183
    v_fmac_f32 v55, v67, v199
    v_permlane16_swap_b32 v48, v52
    v_permlane16_swap_b32 v49, v53
    v_permlane16_swap_b32 v50, v54
    v_permlane16_swap_b32 v51, v55
    v_add_f32 v48, v48, v52
    v_add_f32 v49, v49, v53
    v_add_f32 v50, v50, v54
    v_add_f32 v51, v51, v55
    v_cvt_pk_bf16_f32 v53, v48, v49
    v_cvt_pk_bf16_f32 v55, v50, v51
    buffer_store_dword v53, v252, s[12:15], 0 offen offset:0 sc1
    buffer_store_dword v55, v252, s[12:15], 0 offen offset:64 sc1
K4_fin:
K4_end:
    s_endpgm
.section .rodata,"a"
.p2align 6
.amdhsa_kernel p1_kernel
  .amdhsa_next_free_vgpr 64
  .amdhsa_next_free_sgpr 64
  .amdhsa_accum_offset 64
  .amdhsa_group_segment_fixed_size 0
  .amdhsa_kernarg_size 96
  .amdhsa_user_sgpr_count 2
  .amdhsa_user_sgpr_kernarg_segment_ptr 1
  .amdhsa_system_sgpr_workgroup_id_x 1
  .amdhsa_float_denorm_mode_32 3
.end_amdhsa_kernel
.p2align 6
.amdhsa_kernel hop_kernel
  .amdhsa_next_free_vgpr 128
  .amdhsa_next_free_sgpr 102
  .amdhsa_accum_offset 128
  .amdhsa_group_segment_fixed_size 0
  .amdhsa_kernarg_size 96
  .amdhsa_user_sgpr_count 2
  .amdhsa_user_sgpr_kernarg_segment_ptr 1
  .amdhsa_system_sgpr_workgroup_id_x 1
  .amdhsa_float_denorm_mode_32 3
.end_amdhsa_kernel
.p2align 6
.amdhsa_kernel att_kernel
  .amdhsa_next_free_vgpr 512
  .amdhsa_next_free_sgpr 102
  .amdhsa_accum_offset 256
  .amdhsa_group_segment_fixed_size 0
  .amdhsa_kernarg_size 96
  .amdhsa_user_sgpr_count 2
  .amdhsa_user_sgpr_kernarg_segment_ptr 1
  .amdhsa_system_sgpr_workgroup_id_x 1
  .amdhsa_float_denorm_mode_32 3
.end_amdhsa_kernel
```
